```python
import torch

def _softmax(x, axis=-1):
    return torch.softmax(x, dim=axis)
def _gelu(x):
    return torch.nn.functional.gelu(x, approximate="tanh")
def _silu(x):
    return torch.nn.functional.silu(x)
def _sigmoid(x):
    return torch.sigmoid(x)
def _layernorm(x, axis=-1, eps=1e-5):
    m = x.mean(dim=axis, keepdim=True)
    v = x.var(dim=axis, keepdim=True, unbiased=False)
    return (x - m) / torch.sqrt(v + eps)
def _scatter_add(tgt, idx, src, axis=0):
    return tgt.clone().index_add_(axis, idx, src)
def _segment_sum(src, seg, n):
    out = torch.zeros((n,) + src.shape[1:], dtype=src.dtype)
    return out.index_add_(0, seg, src)
def _pad(x, pw):
    flat = tuple(v for pair in reversed(pw) for v in pair)
    return torch.nn.functional.pad(x, flat)

kernel_name = 'sequential_preLN__sliding_local_dilated__mixer_s_mlp__prompt'

def setup_inputs():

    _w = (lambda a: (lambda t: t.to(torch.bfloat16) if t.is_floating_point() else t)(torch.as_tensor(a)))
    def _A_setup():
        B, S, D = 1, 2048, 640
        return {
            "x": _w((lambda *s: torch.randn(*s, dtype=torch.bfloat16) * 0.05)(B, S, D)),
            "wqkv": _w((lambda *s: torch.randn(*s, dtype=torch.bfloat16) * 0.05)(D, 3 * D)),
            "wo": _w((lambda *s: torch.randn(*s, dtype=torch.bfloat16) * 0.05)(D, D)),
        }
    _A_in = _A_setup()

    def _B_setup():
        B, S, D, F = 1, 2048, 640, 1728
        return {
            "x":  _w((lambda *s: torch.randn(*s, dtype=torch.bfloat16) * 0.05)(B, S, D)),
            "w1": _w((lambda *s: torch.randn(*s, dtype=torch.bfloat16) * 3.2)(D, D) * (D ** -0.5)),
            "w2": _w((lambda *s: torch.randn(*s, dtype=torch.bfloat16) * 3.2)(D, D) * (D ** -0.5)),
            "w3": _w((lambda *s: torch.randn(*s, dtype=torch.bfloat16) * 3.2)(D, F) * (D ** -0.5)),
            "w4": _w((lambda *s: torch.randn(*s, dtype=torch.bfloat16) * 1.6)(F, D) * (F ** -0.5)),
        }
    _B_in = _B_setup()

    return {
        "A_x": _A_in["x"],
        "A_wqkv": _A_in["wqkv"],
        "A_wo": _A_in["wo"],
        "B_x": _B_in["x"],
        "B_w1": _B_in["w1"],
        "B_w2": _B_in["w2"],
        "B_w3": _B_in["w3"],
        "B_w4": _B_in["w4"],
    }

def reference(A_x, A_wqkv, A_wo, B_x, B_w1, B_w2, B_w3, B_w4):
    def _A_ref(x, wqkv, wo):
        B, S, D = x.shape
        H = 32; Dh = D // H
        W, dil = 8, 2
        qkv = (lambda x, *d: x.permute(*d))((x @ wqkv).reshape(B, S, 3, H, Dh), 2, 0, 3, 1, 4)
        q, k, v = qkv[0], qkv[1], qkv[2]
        scale = Dh ** -0.5
        pos = torch.arange(S)
        off = torch.arange(W) * dil
        idx = pos[:, None] - off[None, :]
        mask = idx >= 0
        idx_c = torch.where(mask, idx, 0).reshape(-1)
        kg = k[:, :, idx_c, :].reshape(B, H, S, W, Dh)
        vg = v[:, :, idx_c, :].reshape(B, H, S, W, Dh)
        logits = torch.einsum("bhsd,bhswd->bhsw", q, kg) * scale
        logits = torch.where(mask[None, None, :, :], logits, -1e9)
        attn = _softmax(logits, axis=-1)
        o = torch.einsum("bhsw,bhswd->bhsd", attn, vg)
        return (lambda x, *d: x.permute(*d))(o, 0, 2, 1, 3).reshape(B, S, D) @ wo

    def _B_ref(x, w1, w2, w3, w4):
        B, S, D = x.shape
        h = _gelu(_layernorm(x, axis=-1) @ w1)
        c = D // 4
        g0 = _pad(h[:, :, 0*c:1*c], ((0, 0), (1, 0), (0, 0)))[:, :S, :]
        g1 = _pad(h[:, :, 1*c:2*c], ((0, 0), (0, 1), (0, 0)))[:, 1:, :]
        g2 = _pad(h[:, :, 2*c:3*c], ((0, 0), (2, 0), (0, 0)))[:, :S, :]
        g3 = _pad(h[:, :, 3*c:   ], ((0, 0), (0, 2), (0, 0)))[:, 2:, :]
        hs = torch.concatenate([g0, g1, g2, g3], axis=-1) @ w2
        x1 = x + hs
        h2 = _gelu(_layernorm(x1, axis=-1) @ w3) @ w4
        return x1 + h2

    x = A_x
    h = x + _A_ref(_layernorm(x, axis=-1), A_wqkv, A_wo)
    h2 = h + _B_ref(_layernorm(h, axis=-1), B_w1, B_w2, B_w3, B_w4)
    return h2
```

```asm
; @launch grid=(256,1,1) block=(512,1,1) lds=163840
.amdgcn_target "amdgcn-amd-amdhsa--gfx950"
.text
.globl sequential_preLN__sliding_local_dilated__mixer_s_mlp__prompt_kernel
.p2align 8
.type sequential_preLN__sliding_local_dilated__mixer_s_mlp__prompt_kernel,@function
.set CODE_KB, (L_end - L_pc + 1023) / 1024
sequential_preLN__sliding_local_dilated__mixer_s_mlp__prompt_kernel:
    s_cmp_ge_u32 s2, 256
    s_cbranch_scc1 L_done
    s_load_dwordx16 s[4:19], s[0:1], 0
    s_load_dwordx4 s[20:23], s[0:1], 64
    s_load_dwordx2 s[24:25], s[0:1], 80
    s_getpc_b64 s[26:27]
L_pc:
    s_lshr_b32 s3, s2, 3
    s_lshl_b32 s3, s3, 13
    v_lshl_add_u32 v1, v0, 4, s3
    v_min_u32 v1, CODE_KB*1024-16, v1
    global_load_dwordx4 a[0:3], v1, s[26:27]
    v_lshrrev_b32 v9, 6, v0
    v_and_b32 v1, 63, v0
    v_readfirstlane_b32 s3, v9
    v_lshlrev_b32 v2, 4, v1
    v_and_b32 v5, 15, v1
    v_lshrrev_b32 v6, 4, v1
    s_and_b32 s40, s3, 3
    s_lshr_b32 s47, s3, 2
    s_and_b32 s41, s2, 7
    s_lshr_b32 s42, s2, 3
    s_lshr_b32 s60, s42, 3
    s_lshl_b32 s43, s41, 2
    s_add_u32 s43, s43, s60
    s_and_b32 s44, s42, 7
    s_lshr_b32 s60, s42, 4
    s_lshl_b32 s45, s41, 1
    s_add_u32 s45, s45, s60
    s_and_b32 s46, s42, 15
    v_mov_b32 v47, 0x2300000
    v_mov_b32 v39, 162816
    s_lshl_b32 s60, s3, 2
    s_add_u32 s60, s60, 162816
    v_mov_b32 v45, s60
    s_movk_i32 s76, 4096
    s_waitcnt lgkmcnt(0)
    s_mov_b32 s28, s24
    s_mov_b32 s29, s25
    s_mov_b32 s30, 0x2400000
    s_mov_b32 s31, 0x20000
    s_mov_b32 s35, 0x20000
    s_mov_b32 s39, 0x20000
    buffer_load_dword v3, v47, s[28:31], 0 offen sc1
    s_cmp_lg_u32 s47, 0
    s_cbranch_scc1 L1
    s_setprio 1
    s_cmp_lt_u32 s2, 80
    s_cbranch_scc0 L2
    s_mov_b32 s32, s6
    s_mov_b32 s33, s7
    s_mov_b32 s34, 2457600
    s_and_b32 s64, s41, 1
    s_lshl_b32 s64, s64, 1
    s_and_b32 s60, s42, 1
    s_add_u32 s64, s64, s60
    s_lshr_b32 s66, s42, 1
    s_lshl_b32 s66, s66, 2
    s_lshr_b32 s60, s41, 1
    s_add_u32 s66, s66, s60
    s_lshl_b32 s60, s66, 2
    s_add_u32 s60, s60, s40
    s_mul_i32 s60, s60, 30720
    s_mul_i32 s61, s64, 320
    s_add_u32 s60, s60, s61
    s_and_b32 s61, s40, 1
    s_lshl_b32 s61, s61, 3
    v_xor_b32 v48, s61, v1
    v_mov_b32 v51, 0x80000000
    s_lshl_b32 m0, s40, 13
    v_xor_b32 v49, 0, v48
    v_mul_u32_u24 v50, 205, v49
    v_lshrrev_b32_e64 v50, 12, v50
    v_mul_u32_u24 v55, 960, v50
    v_lshl_add_u32 v55, v49, 4, v55
    v_add_u32 v55, s60, v55
    v_cmp_gt_u32 vcc, 60, v49
    s_nop 1
    v_cndmask_b32_e64 v56, v51, v55, vcc
    buffer_load_dwordx4 v56, s[32:35], 0 offen nt lds
    s_add_u32 s60, s60, 3840
    s_add_u32 m0, m0, 1024
    v_xor_b32 v49, 2, v48
    v_mul_u32_u24 v50, 205, v49
    v_lshrrev_b32_e64 v50, 12, v50
    v_mul_u32_u24 v55, 960, v50
    v_lshl_add_u32 v55, v49, 4, v55
    v_add_u32 v55, s60, v55
    v_cmp_gt_u32 vcc, 60, v49
    s_nop 1
    v_cndmask_b32_e64 v57, v51, v55, vcc
    buffer_load_dwordx4 v57, s[32:35], 0 offen nt lds
    s_add_u32 s60, s60, 3840
    s_add_u32 m0, m0, 1024
    v_xor_b32 v49, 4, v48
    v_mul_u32_u24 v50, 205, v49
    v_lshrrev_b32_e64 v50, 12, v50
    v_mul_u32_u24 v55, 960, v50
    v_lshl_add_u32 v55, v49, 4, v55
    v_add_u32 v55, s60, v55
    v_cmp_gt_u32 vcc, 60, v49
    s_nop 1
    v_cndmask_b32_e64 v58, v51, v55, vcc
    buffer_load_dwordx4 v58, s[32:35], 0 offen nt lds
    s_add_u32 s60, s60, 3840
    s_add_u32 m0, m0, 1024
    v_xor_b32 v49, 6, v48
    v_mul_u32_u24 v50, 205, v49
    v_lshrrev_b32_e64 v50, 12, v50
    v_mul_u32_u24 v55, 960, v50
    v_lshl_add_u32 v55, v49, 4, v55
    v_add_u32 v55, s60, v55
    v_cmp_gt_u32 vcc, 60, v49
    s_nop 1
    v_cndmask_b32_e64 v59, v51, v55, vcc
    buffer_load_dwordx4 v59, s[32:35], 0 offen nt lds
    s_add_u32 s60, s60, 3840
    s_add_u32 m0, m0, 1024
    s_movk_i32 s61, 15360
    buffer_load_dwordx4 v56, s[32:35], s61 offen nt lds
    s_add_u32 m0, m0, 1024
    s_nop 0
    buffer_load_dwordx4 v57, s[32:35], s61 offen nt lds
    s_add_u32 m0, m0, 1024
    s_nop 0
    buffer_load_dwordx4 v58, s[32:35], s61 offen nt lds
    s_add_u32 m0, m0, 1024
    s_nop 0
    buffer_load_dwordx4 v59, s[32:35], s61 offen nt lds
    s_add_u32 m0, m0, 1024
    s_branch L3
L2:
    s_cmp_lt_u32 s2, 128
    s_cbranch_scc1 L3
    s_sub_u32 s64, s2, 128
    s_mov_b32 s32, s4
    s_mov_b32 s33, s5
    s_mov_b32 s34, 2621440
    s_lshl_b32 s62, s40, 2
    v_add_u32 v47, s62, v6
    v_xor_b32 v48, v47, v5
    v_mul_u32_u24 v50, 1280, v47
    v_lshl_add_u32 v50, v48, 4, v50
    s_mul_i32 s60, s64, 20480
    v_add_u32_e64 v50, s60, v50
    s_mul_i32 m0, s40, 5120
    s_nop 0
    buffer_load_dwordx4 v50, s[32:35], 0 offen nt lds
    v_add_u32 v50, 256, v50
    s_add_u32 m0, m0, 1024
    s_nop 0
    buffer_load_dwordx4 v50, s[32:35], 0 offen nt lds
    v_add_u32 v50, 256, v50
    s_add_u32 m0, m0, 1024
    s_nop 0
    buffer_load_dwordx4 v50, s[32:35], 0 offen nt lds
    v_add_u32 v50, 256, v50
    s_add_u32 m0, m0, 1024
    s_nop 0
    buffer_load_dwordx4 v50, s[32:35], 0 offen nt lds
    v_add_u32 v50, 256, v50
    s_add_u32 m0, m0, 1024
    s_nop 0
    buffer_load_dwordx4 v50, s[32:35], 0 offen nt lds
L3:
    v_add_u32 v7, 0x10000, v2
    v_add_u32 v8, 0x20000, v2
    s_and_b32 s60, s45, 0
    s_lshl_b32 s60, s60, 1
    s_add_u32 s60, s60, s46
    s_mul_i32 s61, s60, 52
    s_lshr_b32 s61, s61, 8
    s_mul_i32 s61, s61, 5
    s_sub_u32 s60, s60, s61
    s_lshl_b32 s81, s60, 12
    s_add_u32 s82, s81, 4096
    s_cmp_eq_u32 s82, 20480
    s_cselect_b32 s82, 0, s82
    s_add_u32 s83, s82, 4096
    s_cmp_eq_u32 s83, 20480
    s_cselect_b32 s83, 0, s83
    s_add_u32 s84, s83, 4096
    s_cmp_eq_u32 s84, 20480
    s_cselect_b32 s84, 0, s84
    s_add_u32 s85, s84, 4096
    s_cmp_eq_u32 s85, 20480
    s_cselect_b32 s85, 0, s85
    s_bitcmp1_b32 s43, 1
    s_cselect_b32 s77, 0, 1
    s_cselect_b32 s78, 2, 3
    s_cselect_b32 s79, 1, 0
    s_cselect_b32 s80, 3, 2
    s_lshl_b32 s77, s77, 12
    s_lshl_b32 s78, s78, 12
    s_lshl_b32 s79, s79, 12
    s_lshl_b32 s80, s80, 12
    s_mov_b32 s60, 0
    s_and_b32 s60, s60, 3
    s_mul_i32 s60, s60, 3
    s_lshl_b32 s86, s60, 12
    s_add_u32 s87, s86, 4096
    s_cmp_eq_u32 s87, 53248
    s_cselect_b32 s87, 0, s87
    s_add_u32 s88, s87, 4096
    s_cmp_eq_u32 s88, 53248
    s_cselect_b32 s88, 0, s88
    s_add_u32 s89, s88, 4096
    s_cmp_eq_u32 s89, 53248
    s_cselect_b32 s89, 0, s89
    s_add_u32 s90, s89, 4096
    s_cmp_eq_u32 s90, 53248
    s_cselect_b32 s90, 0, s90
    s_add_u32 s91, s90, 4096
    s_cmp_eq_u32 s91, 53248
    s_cselect_b32 s91, 0, s91
    s_add_u32 s92, s91, 4096
    s_cmp_eq_u32 s92, 53248
    s_cselect_b32 s92, 0, s92
    s_add_u32 s93, s92, 4096
    s_cmp_eq_u32 s93, 53248
    s_cselect_b32 s93, 0, s93
    s_add_u32 s94, s93, 4096
    s_cmp_eq_u32 s94, 53248
    s_cselect_b32 s94, 0, s94
    s_add_u32 s95, s94, 4096
    s_cmp_eq_u32 s95, 53248
    s_cselect_b32 s95, 0, s95
    s_add_u32 s96, s95, 4096
    s_cmp_eq_u32 s96, 53248
    s_cselect_b32 s96, 0, s96
    s_add_u32 s97, s96, 4096
    s_cmp_eq_u32 s97, 53248
    s_cselect_b32 s97, 0, s97
    s_add_u32 s98, s97, 4096
    s_cmp_eq_u32 s98, 53248
    s_cselect_b32 s98, 0, s98
    v_lshrrev_b32 v62, 2, v5
    v_and_b32 v60, 3, v1
    v_and_b32 v61, 1, v6
    v_lshlrev_b32 v61, 2, v61
    v_or_b32 v61, v61, v62
    v_lshlrev_b32 v61, 5, v61
    v_lshl_add_u32 v62, v6, 3, v62
    v_and_b32 v48, 1, v6
    v_lshrrev_b32 v49, 1, v6
    v_lshl_add_u32 v36, v48, 1, v49
    s_lshl_b32 s63, s43, 2
    s_add_u32 s63, s63, s40
    s_mul_i32 s65, s63, 20480
    s_mul_i32 s61, s44, 160
    s_add_u32 s60, s65, s61
    v_mul_u32_u24 v50, 1280, v5
    v_add_u32 v50, s60, v50
    v_lshl_add_u32 v37, v36, 4, v50
    v_lshl_add_u32 v50, v49, 4, v50
    v_add_u32 v50, 128, v50
    v_cmp_eq_u32 vcc, 0, v48
    v_mov_b32 v51, 0x80000000
    s_nop 0
    v_cndmask_b32_e64 v38, v51, v50, vcc
    v_lshlrev_b32_e64 v36, 8, v36
    v_lshl_add_u32 v36, v5, 4, v36
    s_lshr_b32 s60, s77, 2
    s_mul_i32 s60, s60, 5
    s_add_u32 s12, s60, s65
    s_lshr_b32 s60, s78, 2
    s_mul_i32 s60, s60, 5
    s_add_u32 s13, s60, s65
    s_lshr_b32 s60, s79, 2
    s_mul_i32 s60, s60, 5
    s_add_u32 s14, s60, s65
    s_lshr_b32 s60, s80, 2
    s_mul_i32 s60, s60, 5
    s_add_u32 s15, s60, s65
    s_waitcnt vmcnt(0)
    s_barrier
    s_mov_b32 s60, 0x9E3779B1
    v_mul_lo_u32 v3, v3, s60
    v_add_u32 v3, 0x7F4A7C15, v3
    s_cmp_lt_u32 s2, 128
    s_cbranch_scc0 L4
    s_cmp_lt_u32 s2, 80
    s_cbranch_scc0 L5
    s_mul_i32 s60, s40, 80
    v_lshl_add_u32 v50, v60, 3, s60
    v_lshlrev_b32 v51, 10, v62
    v_and_b32 v52, 1, v60
    v_mul_u32_u24 v52, 320, v52
    v_lshrrev_b32 v53, 1, v60
    v_mul_u32_u24 v53, 40, v53
    s_add_u32 s60, s60, 32
    v_add3_u32 v52, v52, v53, s60
    v_xor_b32 v53, v50, v61
    v_add_u32_e64 v53, v53, v51
    ds_read_b64_tr_b16 v[64:65], v53
    ds_read_b64_tr_b16 v[66:67], v53 offset:4096
    v_add_u32 v53, 40, v50
    v_xor_b32 v53, v53, v61
    v_add_u32_e64 v53, v53, v51
    ds_read_b64_tr_b16 v[68:69], v53
    ds_read_b64_tr_b16 v[70:71], v53 offset:4096
    v_add_u32 v53, 320, v50
    v_xor_b32 v53, v53, v61
    v_add_u32 v53, v53, v51
    ds_read_b64_tr_b16 v[72:73], v53
    ds_read_b64_tr_b16 v[74:75], v53 offset:4096
    v_add_u32 v53, 360, v50
    v_xor_b32 v53, v53, v61
    v_add_u32 v53, v53, v51
    ds_read_b64_tr_b16 v[76:77], v53
    ds_read_b64_tr_b16 v[78:79], v53 offset:4096
    v_xor_b32 v53, v52, v61
    v_add_u32 v53, v53, v51
    ds_read_b64_tr_b16 v[80:81], v53
    ds_read_b64_tr_b16 v[82:83], v53 offset:4096
    v_add_u32 v53, 640, v50
    v_xor_b32 v53, v53, v61
    v_add_u32 v53, v53, v51
    ds_read_b64_tr_b16 v[84:85], v53
    ds_read_b64_tr_b16 v[86:87], v53 offset:4096
    v_add_u32 v53, 672, v50
    v_xor_b32 v53, v53, v61
    v_add_u32 v53, v53, v51
    ds_read_b64_tr_b16 v[88:89], v53
    ds_read_b64_tr_b16 v[90:91], v53 offset:4096
    v_add_u32 v53, 704, v50
    v_xor_b32 v53, v53, v61
    v_add_u32 v53, v53, v51
    s_waitcnt lgkmcnt(12)
    ds_read_b64_tr_b16 v[92:93], v53
    ds_read_b64_tr_b16 v[94:95], v53 offset:4096
    s_lshl_b32 s60, s64, 2
    s_add_u32 s60, s60, s40
    s_mul_i32 s60, s60, 153600
    s_mul_i32 s61, s66, 7680
    s_add_u32 s60, s60, s61
    s_add_u32 s60, s60, 0x1600000
    v_add_u32 v52, s60, v2
    v_and_b32 v56, 7, v5
    v_lshl_add_u32 v56, v6, 3, v56
    v_lshl_add_u32 v56, v56, 4, s60
    v_cmp_gt_u32 vcc, 8, v5
    v_mov_b32 v55, 0x80000000
    s_nop 0
    v_cndmask_b32_e64 v56, v55, v56, vcc
    s_waitcnt lgkmcnt(14)
    buffer_store_dwordx4 v[64:67], v52, s[28:31], 0 offen offset:0 sc1
    s_waitcnt lgkmcnt(12)
    buffer_store_dwordx4 v[68:71], v52, s[28:31], 0 offen offset:1024 sc1
    s_waitcnt lgkmcnt(10)
    buffer_store_dwordx4 v[72:75], v52, s[28:31], 0 offen offset:2048 sc1
    s_waitcnt lgkmcnt(8)
    buffer_store_dwordx4 v[76:79], v52, s[28:31], 0 offen offset:3072 sc1
    s_waitcnt lgkmcnt(6)
    buffer_store_dwordx4 v[80:83], v52, s[28:31], s76 offen offset:0 sc1
    s_waitcnt lgkmcnt(4)
    buffer_store_dwordx4 v[84:87], v52, s[28:31], s76 offen offset:1024 sc1
    s_waitcnt lgkmcnt(2)
    buffer_store_dwordx4 v[88:91], v52, s[28:31], s76 offen offset:2048 sc1
    s_waitcnt lgkmcnt(0)
    buffer_store_dwordx4 v[92:95], v56, s[28:31], s76 offen offset:3072 sc1
    s_branch L5
L4:
    s_mul_i32 s60, s40, 20
    v_add_u32 v50, s60, v6
    v_lshrrev_b32 v51, 2, v5
    v_mul_u32_u24 v51, 5120, v51
    v_and_b32_e64 v52, 3, v5
    v_lshl_add_u32 v51, v52, 8, v51
    v_add_u32 v52, 0, v50
    v_lshrrev_b32 v53, 4, v52
    v_and_b32 v52, 15, v52
    v_xor_b32 v52, v52, v5
    v_lshl_add_u32 v53, v53, 10, v51
    v_lshl_add_u32 v53, v52, 4, v53
    ds_read_b128 v[64:67], v53
    v_add_u32 v52, 4, v50
    v_lshrrev_b32 v53, 4, v52
    v_and_b32 v52, 15, v52
    v_xor_b32 v52, v52, v5
    v_lshl_add_u32 v53, v53, 10, v51
    v_lshl_add_u32 v53, v52, 4, v53
    ds_read_b128 v[68:71], v53
    v_add_u32 v52, 8, v50
    v_lshrrev_b32 v53, 4, v52
    v_and_b32 v52, 15, v52
    v_xor_b32 v52, v52, v5
    v_lshl_add_u32 v53, v53, 10, v51
    v_lshl_add_u32 v53, v52, 4, v53
    ds_read_b128 v[72:75], v53
    v_add_u32 v52, 12, v50
    v_lshrrev_b32 v53, 4, v52
    v_and_b32 v52, 15, v52
    v_xor_b32 v52, v52, v5
    v_lshl_add_u32 v53, v53, 10, v51
    v_lshl_add_u32 v53, v52, 4, v53
    ds_read_b128 v[76:79], v53
    v_add_u32 v52, 16, v50
    v_lshrrev_b32 v53, 4, v52
    v_and_b32 v52, 15, v52
    v_xor_b32 v52, v52, v5
    v_lshl_add_u32 v53, v53, 10, v51
    v_lshl_add_u32 v53, v52, 4, v53
    ds_read_b128 v[80:83], v53
    s_mul_i32 s60, s64, 20480
    s_mul_i32 s61, s40, 5120
    s_add_u32 s60, s60, s61
    v_add_u32 v52, s60, v2
    s_lshr_b32 s60, s64, 3
    s_mul_i32 s60, s60, 20480
    s_add_u32 s60, s60, s61
    s_add_u32 s60, s60, 0x280000
    v_add_u32_e64 v53, s60, v2
    s_mov_b32 s60, 0x3f803f80
    v_mov_b32 v56, 0
    v_mov_b32 v57, 0
    v_mov_b32 v58, 0
    v_mov_b32 v59, 0
    s_waitcnt lgkmcnt(4)
    v_dot2c_f32_bf16 v56, s60, v64
    v_dot2c_f32_bf16 v58, v64, v64
    v_dot2c_f32_bf16 v57, s60, v65
    v_dot2c_f32_bf16 v59, v65, v65
    v_dot2c_f32_bf16 v56, s60, v66
    v_dot2c_f32_bf16 v58, v66, v66
    v_dot2c_f32_bf16 v57, s60, v67
    v_dot2c_f32_bf16 v59, v67, v67
    s_waitcnt lgkmcnt(3)
    v_dot2c_f32_bf16 v56, s60, v68
    v_dot2c_f32_bf16 v58, v68, v68
    v_dot2c_f32_bf16 v57, s60, v69
    v_dot2c_f32_bf16 v59, v69, v69
    v_dot2c_f32_bf16 v56, s60, v70
    v_dot2c_f32_bf16 v58, v70, v70
    v_dot2c_f32_bf16 v57, s60, v71
    v_dot2c_f32_bf16 v59, v71, v71
    s_waitcnt lgkmcnt(2)
    v_dot2c_f32_bf16 v56, s60, v72
    v_dot2c_f32_bf16 v58, v72, v72
    v_dot2c_f32_bf16 v57, s60, v73
    v_dot2c_f32_bf16 v59, v73, v73
    v_dot2c_f32_bf16 v56, s60, v74
    v_dot2c_f32_bf16 v58, v74, v74
    v_dot2c_f32_bf16 v57, s60, v75
    v_dot2c_f32_bf16 v59, v75, v75
    s_waitcnt lgkmcnt(1)
    v_dot2c_f32_bf16 v56, s60, v76
    v_dot2c_f32_bf16 v58, v76, v76
    v_dot2c_f32_bf16 v57, s60, v77
    v_dot2c_f32_bf16 v59, v77, v77
    v_dot2c_f32_bf16 v56, s60, v78
    v_dot2c_f32_bf16 v58, v78, v78
    v_dot2c_f32_bf16 v57, s60, v79
    v_dot2c_f32_bf16 v59, v79, v79
    s_waitcnt lgkmcnt(0)
    v_dot2c_f32_bf16 v56, s60, v80
    v_dot2c_f32_bf16 v58, v80, v80
    v_dot2c_f32_bf16 v57, s60, v81
    v_dot2c_f32_bf16 v59, v81, v81
    v_dot2c_f32_bf16 v56, s60, v82
    v_dot2c_f32_bf16 v58, v82, v82
    v_dot2c_f32_bf16 v57, s60, v83
    v_dot2c_f32_bf16 v59, v83, v83
    s_nop 1
    v_add_f32 v56, v56, v57
    v_add_f32 v57, v58, v59
    v_mov_b32 v58, v56
    v_mov_b32 v59, v57
    s_nop 0
    v_permlane32_swap_b32 v56, v58
    v_permlane32_swap_b32 v57, v59
    v_add_f32 v56, v56, v58
    v_add_f32 v57, v57, v59
    v_mov_b32 v58, v56
    v_mov_b32 v59, v57
    s_nop 0
    v_permlane16_swap_b32 v56, v58
    v_permlane16_swap_b32 v57, v59
    v_add_f32 v56, v56, v58
    v_add_f32 v57, v57, v59
    s_lshl_b32 s61, s40, 7
    s_add_u32 s61, s61, 24576
    v_lshl_add_u32 v58, v5, 3, s61
    ds_write_b64 v58, v[56:57]
    v_mov_b32 v0, 1
    ds_write_b32 v45, v0
    v_lshlrev_b32 v58, 3, v5
    v_lshlrev_b32 v100, 16, v64
    v_and_b32 v101, 0xffff0000, v64
    v_lshlrev_b32_e64 v102, 16, v65
    v_and_b32 v103, 0xffff0000, v65
    v_lshlrev_b32_e64 v104, 16, v66
    v_and_b32 v105, 0xffff0000, v66
    v_lshlrev_b32_e64 v106, 16, v67
    v_and_b32 v107, 0xffff0000, v67
    v_lshlrev_b32_e64 v108, 16, v68
    v_and_b32 v109, 0xffff0000, v68
    v_lshlrev_b32_e64 v110, 16, v69
    v_and_b32 v111, 0xffff0000, v69
    s_mov_b32 s60, 0
L6:
    ds_read_b128 v[188:191], v39 offset:0
    s_waitcnt lgkmcnt(0)
    v_min_u32_e64 v188, v188, v189
    v_min3_u32 v46, v188, v190, v191
    v_cmp_gt_u32 vcc, 1, v46
    s_cbranch_vccz L7
    s_add_u32 s60, s60, 1
    s_cmp_lt_u32 s60, 3200000
    s_cbranch_scc1 L6
L7:
    ds_read_b64 v[84:85], v58 offset:24576
    ds_read_b64 v[86:87], v58 offset:24704
    ds_read_b64 v[88:89], v58 offset:24832
    ds_read_b64 v[90:91], v58 offset:24960
    v_lshlrev_b32_e64 v112, 16, v70
    v_and_b32 v113, 0xffff0000, v70
    v_lshlrev_b32_e64 v114, 16, v71
    v_and_b32 v115, 0xffff0000, v71
    v_lshlrev_b32_e64 v116, 16, v72
    v_and_b32 v117, 0xffff0000, v72
    v_lshlrev_b32_e64 v118, 16, v73
    v_and_b32 v119, 0xffff0000, v73
    v_lshlrev_b32_e64 v120, 16, v74
    v_and_b32 v121, 0xffff0000, v74
    v_lshlrev_b32_e64 v122, 16, v75
    v_and_b32 v123, 0xffff0000, v75
    v_lshlrev_b32_e64 v124, 16, v76
    v_and_b32 v125, 0xffff0000, v76
    v_lshlrev_b32_e64 v126, 16, v77
    v_and_b32 v127, 0xffff0000, v77
    v_lshlrev_b32_e64 v128, 16, v78
    v_and_b32 v129, 0xffff0000, v78
    v_lshlrev_b32_e64 v130, 16, v79
    v_and_b32 v131, 0xffff0000, v79
    v_lshlrev_b32_e64 v132, 16, v80
    v_and_b32 v133, 0xffff0000, v80
    v_lshlrev_b32_e64 v134, 16, v81
    v_and_b32 v135, 0xffff0000, v81
    v_lshlrev_b32_e64 v136, 16, v82
    v_and_b32 v137, 0xffff0000, v82
    v_lshlrev_b32_e64 v138, 16, v83
    v_and_b32 v139, 0xffff0000, v83
    s_mov_b32 s60, 0x3acccccd
    s_waitcnt lgkmcnt(0)
    v_pk_add_f32 v[84:85], v[84:85], v[86:87]
    v_pk_add_f32 v[88:89], v[88:89], v[90:91]
    v_pk_add_f32 v[84:85], v[84:85], v[88:89]
    v_mul_f32 v84, s60, v84
    v_mul_f32_e64 v85, s60, v85
    v_fma_f32 v85, -v84, v84, v85
    v_max_f32_e64 v85, 0, v85
    v_add_f32 v85, 0x3727c5ac, v85
    v_rsq_f32 v86, v85
    s_nop 0
    v_mul_f32_e64 v88, -v84, v86
    v_pk_fma_f32 v[100:101], v[100:101], v[86:87], v[88:89] op_sel_hi:[1,0,0]
    v_pk_fma_f32 v[102:103], v[102:103], v[86:87], v[88:89] op_sel_hi:[1,0,0]
    v_pk_fma_f32 v[104:105], v[104:105], v[86:87], v[88:89] op_sel_hi:[1,0,0]
    v_pk_fma_f32 v[106:107], v[106:107], v[86:87], v[88:89] op_sel_hi:[1,0,0]
    v_cvt_pk_bf16_f32 v64, v100, v101
    v_cvt_pk_bf16_f32 v65, v102, v103
    v_cvt_pk_bf16_f32 v66, v104, v105
    v_cvt_pk_bf16_f32 v67, v106, v107
    buffer_store_dwordx4 v[64:67], v52, s[28:31], 0 offen offset:0 sc1
    v_pk_fma_f32 v[108:109], v[108:109], v[86:87], v[88:89] op_sel_hi:[1,0,0]
    v_pk_fma_f32 v[110:111], v[110:111], v[86:87], v[88:89] op_sel_hi:[1,0,0]
    v_pk_fma_f32 v[112:113], v[112:113], v[86:87], v[88:89] op_sel_hi:[1,0,0]
    v_pk_fma_f32 v[114:115], v[114:115], v[86:87], v[88:89] op_sel_hi:[1,0,0]
    v_cvt_pk_bf16_f32 v68, v108, v109
    v_cvt_pk_bf16_f32 v69, v110, v111
    v_cvt_pk_bf16_f32 v70, v112, v113
    v_cvt_pk_bf16_f32 v71, v114, v115
    buffer_store_dwordx4 v[68:71], v52, s[28:31], 0 offen offset:1024 sc1
    v_pk_fma_f32 v[116:117], v[116:117], v[86:87], v[88:89] op_sel_hi:[1,0,0]
    v_pk_fma_f32 v[118:119], v[118:119], v[86:87], v[88:89] op_sel_hi:[1,0,0]
    v_pk_fma_f32 v[120:121], v[120:121], v[86:87], v[88:89] op_sel_hi:[1,0,0]
    v_pk_fma_f32 v[122:123], v[122:123], v[86:87], v[88:89] op_sel_hi:[1,0,0]
    v_cvt_pk_bf16_f32 v72, v116, v117
    v_cvt_pk_bf16_f32 v73, v118, v119
    v_cvt_pk_bf16_f32 v74, v120, v121
    v_cvt_pk_bf16_f32 v75, v122, v123
    buffer_store_dwordx4 v[72:75], v52, s[28:31], 0 offen offset:2048 sc1
    v_pk_fma_f32 v[124:125], v[124:125], v[86:87], v[88:89] op_sel_hi:[1,0,0]
    v_pk_fma_f32 v[126:127], v[126:127], v[86:87], v[88:89] op_sel_hi:[1,0,0]
    v_pk_fma_f32 v[128:129], v[128:129], v[86:87], v[88:89] op_sel_hi:[1,0,0]
    v_pk_fma_f32 v[130:131], v[130:131], v[86:87], v[88:89] op_sel_hi:[1,0,0]
    v_cvt_pk_bf16_f32 v76, v124, v125
    v_cvt_pk_bf16_f32 v77, v126, v127
    v_cvt_pk_bf16_f32 v78, v128, v129
    v_cvt_pk_bf16_f32 v79, v130, v131
    buffer_store_dwordx4 v[76:79], v52, s[28:31], 0 offen offset:3072 sc1
    v_pk_fma_f32 v[132:133], v[132:133], v[86:87], v[88:89] op_sel_hi:[1,0,0]
    v_pk_fma_f32 v[134:135], v[134:135], v[86:87], v[88:89] op_sel_hi:[1,0,0]
    v_pk_fma_f32 v[136:137], v[136:137], v[86:87], v[88:89] op_sel_hi:[1,0,0]
    v_pk_fma_f32 v[138:139], v[138:139], v[86:87], v[88:89] op_sel_hi:[1,0,0]
    v_cvt_pk_bf16_f32 v80, v132, v133
    v_cvt_pk_bf16_f32 v81, v134, v135
    v_cvt_pk_bf16_f32 v82, v136, v137
    v_cvt_pk_bf16_f32 v83, v138, v139
    buffer_store_dwordx4 v[80:83], v52, s[28:31], s76 offen offset:0 sc1
    s_and_b32 s61, s64, 7
    s_cmp_eq_u32 s61, 7
    s_cbranch_scc0 L5
    buffer_store_dwordx4 v[64:67], v53, s[28:31], 0 offen offset:0 sc1
    buffer_store_dwordx4 v[68:71], v53, s[28:31], 0 offen offset:1024 sc1
    buffer_store_dwordx4 v[72:75], v53, s[28:31], 0 offen offset:2048 sc1
    buffer_store_dwordx4 v[76:79], v53, s[28:31], 0 offen offset:3072 sc1
    buffer_store_dwordx4 v[80:83], v53, s[28:31], s76 offen offset:0 sc1
L5:
    v_mov_b32 v0, 2
    ds_write_b32 v45, v0
    s_lshl_b32 s64, s45, 3
    s_lshl_b32 s60, s40, 1
    s_add_u32 s64, s64, s60
    s_mul_i32 s60, s64, 20480
    v_add_u32 v22, s60, v2
    v_add_u32 v23, 20480, v22
    s_mul_i32 s60, s45, 20480
    s_lshl_b32 s61, s40, 10
    s_add_u32 s60, s60, s61
    s_add_u32 s60, s60, 2600960
    s_cmp_eq_u32 s45, 0
    s_cselect_b32 s60, 0x80000000, s60
    v_add_u32 v24, s60, v2
    v_and_b32_e64 v25, 7, v5
    v_lshl_add_u32 v25, v6, 3, v25
    v_lshlrev_b32_e64 v25, 4, v25
    v_add_u32 v26, 0x10000, v25
    v_add_u32 v27, 0x20000, v25
    s_mov_b32 s32, s4
    s_mov_b32 s33, s5
    s_mov_b32 s34, 2621440
    v_and_b32_e64 v55, 1, v5
    v_cmp_eq_u32 s[48:49], 1, v55
    v_lshl_add_u32 v54, v6, 2, v55
    v_cmp_le_u32 s[50:51], v54, v5
    v_add_u32_e64 v54, 2, v54
    v_cmp_le_u32 s[52:53], v54, v5
    v_cmp_eq_u32 s[54:55], 0, v6
    v_cmp_eq_u32 s[56:57], 1, v6
    v_cmp_eq_u32 s[58:59], 3, v6
    v_mov_b32 v54, 0x0c0c0100
    v_mov_b32 v55, 0x01000c0c
    v_cndmask_b32_e64 v54, v54, v55, s[48:49]
    v_mov_b32 v55, 0x0c0c0302
    v_mov_b32 v56, 0x03020c0c
    v_cndmask_b32_e64 v55, v55, v56, s[48:49]
    v_mov_b32 v56, 0x0c0c0c0c
    v_cndmask_b32_e64 v28, v54, v56, s[50:51]
    v_cndmask_b32_e64 v29, v55, v56, s[52:53]
    v_cndmask_b32_e64 v30, v56, v54, s[50:51]
    v_cndmask_b32_e64 v31, v56, v55, s[52:53]
    s_mov_b32 s66, 0x7f800000
    s_cmp_eq_u32 s64, 0
    s_cselect_b32 s66, 0xf149f2ca, s66
    s_mul_i32 s60, s40, 6144
    s_add_u32 s60, s60, 61440
    v_add_u32 v32, s60, v2
    s_mul_i32 s60, s40, 3072
    s_add_u32 s60, s60, 86016
    v_lshl_add_u32 v33, v1, 3, s60
    s_mul_i32 s60, s64, 20480
    s_mul_i32 s61, s46, 1280
    s_add_u32 s60, s60, s61
    s_add_u32 s60, s60, 0x500000
    v_add_u32 v40, s60, v36
    v_add_u32 v41, 20480, v40
    s_add_u32 s60, s60, 1024
    v_mul_u32_u24 v42, 20480, v6
    v_lshl_add_u32 v42, v5, 4, v42
    v_add_u32 v42, s60, v42
    v_cmp_gt_u32 vcc, 2, v6
    v_mov_b32 v43, 0x80000000
    s_nop 0
    v_cndmask_b32_e64 v42, v43, v42, vcc
    s_lshr_b32 s60, s64, 1
    s_lshl_b32 s60, s60, 7
    s_lshl_b32 s61, s46, 2
    s_add_u32 s60, s60, s61
    s_add_u32 s60, s60, 0x2208000
    v_mov_b32 v43, s60
    s_mov_b32 s67, 0x3ea52b5c
    s_waitcnt vmcnt(0)
    v_mov_b32 v0, 3
    ds_write_b32 v45, v0
    s_mov_b32 s60, 0
L8:
    ds_read_b64 v[46:47], v39 offset:16
    s_waitcnt lgkmcnt(0)
    v_min_u32 v46, v46, v47
    v_cmp_gt_u32 vcc, 2, v46
    s_cbranch_vccz L9
    s_add_u32 s60, s60, 1
    s_cmp_lt_u32 s60, 3200000
    s_cbranch_scc1 L8
L9:
    buffer_load_dwordx4 v[136:139], v22, s[28:31], s81 offen offset:0 sc1
    buffer_load_dwordx4 v[140:143], v23, s[28:31], s81 offen offset:0 sc1
    buffer_load_dwordx4 v[184:187], v24, s[28:31], s81 offen offset:0 sc1
    buffer_load_dwordx4 v[144:147], v22, s[28:31], s81 offen offset:1024 sc1
    buffer_load_dwordx4 v[148:151], v23, s[28:31], s81 offen offset:1024 sc1
    buffer_load_dwordx4 v[152:155], v22, s[28:31], s81 offen offset:2048 sc1
    buffer_load_dwordx4 v[156:159], v23, s[28:31], s81 offen offset:2048 sc1
    buffer_load_dwordx4 v[160:163], v22, s[28:31], s81 offen offset:3072 sc1
    buffer_load_dwordx4 v[164:167], v23, s[28:31], s81 offen offset:3072 sc1
    buffer_load_dwordx4 v[168:171], v22, s[28:31], s82 offen offset:0 sc1
    s_mov_b32 s60, 0
L10:
    ds_read_b64 v[46:47], v39 offset:16
    s_waitcnt lgkmcnt(0)
    v_min_u32 v46, v46, v47
    v_cmp_gt_u32 vcc, 3, v46
    s_cbranch_vccz L11
    s_add_u32 s60, s60, 1
    s_cmp_lt_u32 s60, 3200000
    s_cbranch_scc1 L10
L11:
    ds_read_b128 a[0:3], v2 offset:0
    ds_read_b128 a[4:7], v2 offset:1024
    ds_read_b128 a[8:11], v2 offset:2048
    ds_read_b128 a[12:15], v2 offset:3072
    ds_read_b128 a[16:19], v2 offset:4096
    ds_read_b128 a[20:23], v2 offset:5120
    ds_read_b128 a[24:27], v2 offset:6144
    ds_read_b128 a[28:31], v25 offset:7168
    s_waitcnt vmcnt(7) lgkmcnt(0)
    v_mfma_f32_16x16x32_bf16 v[48:51], a[0:3], v[136:139], 0
    ds_read_b128 a[32:35], v2 offset:7680
    v_mfma_f32_16x16x32_bf16 v[80:83], a[0:3], v[140:143], 0
    ds_read_b128 a[36:39], v2 offset:8704
    v_mfma_f32_16x16x32_bf16 v[52:55], a[4:7], v[136:139], 0
    ds_read_b128 a[40:43], v2 offset:9728
    v_mfma_f32_16x16x32_bf16 v[84:87], a[4:7], v[140:143], 0
    ds_read_b128 a[44:47], v2 offset:10752
    v_mfma_f32_16x16x32_bf16 v[56:59], a[8:11], v[136:139], 0
    ds_read_b128 a[48:51], v2 offset:11776
    v_mfma_f32_16x16x32_bf16 v[88:91], a[8:11], v[140:143], 0
    ds_read_b128 a[52:55], v2 offset:12800
    v_mfma_f32_16x16x32_bf16 v[60:63], a[12:15], v[136:139], 0
    ds_read_b128 a[56:59], v2 offset:13824
    v_mfma_f32_16x16x32_bf16 v[92:95], a[12:15], v[140:143], 0
    ds_read_b128 a[60:63], v25 offset:14848
    v_mfma_f32_16x16x32_bf16 v[64:67], a[16:19], v[136:139], 0
    buffer_load_dwordx4 v[172:175], v23, s[28:31], s82 offen offset:0 sc1
    v_mfma_f32_16x16x32_bf16 v[96:99], a[16:19], v[140:143], 0
    v_mfma_f32_16x16x32_bf16 v[68:71], v[136:139], a[20:23], 0
    v_mfma_f32_16x16x32_bf16 v[100:103], v[140:143], a[20:23], 0
    buffer_load_dwordx4 v[188:191], v24, s[28:31], s82 offen offset:0 sc1
    v_mfma_f32_16x16x32_bf16 v[72:75], v[136:139], a[24:27], 0
    v_mfma_f32_16x16x32_bf16 v[104:107], v[140:143], a[24:27], 0
    v_mfma_f32_16x16x32_bf16 v[76:79], v[136:139], a[28:31], 0
    buffer_load_dwordx4 v[176:179], v22, s[28:31], s82 offen offset:1024 sc1
    v_mfma_f32_16x16x32_bf16 v[108:111], v[140:143], a[28:31], 0
    s_cmp_lg_u32 s40, 0
    s_cbranch_scc1 L12
    v_mfma_f32_16x16x32_bf16 v[112:115], a[8:11], v[184:187], 0
    v_mfma_f32_16x16x32_bf16 v[116:119], a[16:19], v[184:187], 0
    v_mfma_f32_16x16x32_bf16 v[120:123], a[12:15], v[184:187], 0
    v_mfma_f32_16x16x32_bf16 v[124:127], v[184:187], a[20:23], 0
    v_mfma_f32_16x16x32_bf16 v[128:131], v[184:187], a[24:27], 0
    v_mfma_f32_16x16x32_bf16 v[132:135], v[184:187], a[28:31], 0
L12:
    s_waitcnt vmcnt(8) lgkmcnt(0)
    v_mfma_f32_16x16x32_bf16 v[48:51], a[32:35], v[144:147], v[48:51]
    ds_read_b128 a[0:3], v2 offset:15360
    v_mfma_f32_16x16x32_bf16 v[80:83], a[32:35], v[148:151], v[80:83]
    ds_read_b128 a[4:7], v2 offset:16384
    v_mfma_f32_16x16x32_bf16 v[52:55], a[36:39], v[144:147], v[52:55]
    ds_read_b128 a[8:11], v2 offset:17408
    v_mfma_f32_16x16x32_bf16 v[84:87], a[36:39], v[148:151], v[84:87]
    ds_read_b128 a[12:15], v2 offset:18432
    v_mfma_f32_16x16x32_bf16 v[56:59], a[40:43], v[144:147], v[56:59]
    ds_read_b128 a[16:19], v2 offset:19456
    v_mfma_f32_16x16x32_bf16 v[88:91], a[40:43], v[148:151], v[88:91]
    ds_read_b128 a[20:23], v2 offset:20480
    v_mfma_f32_16x16x32_bf16 v[60:63], a[44:47], v[144:147], v[60:63]
    ds_read_b128 a[24:27], v2 offset:21504
    v_mfma_f32_16x16x32_bf16 v[92:95], a[44:47], v[148:151], v[92:95]
    ds_read_b128 a[28:31], v25 offset:22528
    v_mfma_f32_16x16x32_bf16 v[64:67], a[48:51], v[144:147], v[64:67]
    v_mfma_f32_16x16x32_bf16 v[96:99], a[48:51], v[148:151], v[96:99]
    buffer_load_dwordx4 v[180:183], v23, s[28:31], s82 offen offset:1024 sc1
    v_mfma_f32_16x16x32_bf16 v[68:71], v[144:147], a[52:55], v[68:71]
    v_mfma_f32_16x16x32_bf16 v[100:103], v[148:151], a[52:55], v[100:103]
    v_mfma_f32_16x16x32_bf16 v[72:75], v[144:147], a[56:59], v[72:75]
    v_mfma_f32_16x16x32_bf16 v[104:107], v[148:151], a[56:59], v[104:107]
    buffer_load_dwordx4 v[136:139], v22, s[28:31], s82 offen offset:2048 sc1
    v_mfma_f32_16x16x32_bf16 v[76:79], v[144:147], a[60:63], v[76:79]
    v_mfma_f32_16x16x32_bf16 v[108:111], v[148:151], a[60:63], v[108:111]
    s_cmp_lg_u32 s40, 1
    s_cbranch_scc1 L13
    v_mfma_f32_16x16x32_bf16 v[112:115], a[40:43], v[184:187], 0
    v_mfma_f32_16x16x32_bf16 v[116:119], a[48:51], v[184:187], 0
    v_mfma_f32_16x16x32_bf16 v[120:123], a[44:47], v[184:187], 0
    v_mfma_f32_16x16x32_bf16 v[124:127], v[184:187], a[52:55], 0
    v_mfma_f32_16x16x32_bf16 v[128:131], v[184:187], a[56:59], 0
    v_mfma_f32_16x16x32_bf16 v[132:135], v[184:187], a[60:63], 0
L13:
    s_waitcnt vmcnt(8) lgkmcnt(0)
    ds_read_b64 v[46:47], v39 offset:16
    v_mfma_f32_16x16x32_bf16 v[48:51], a[0:3], v[152:155], v[48:51]
    ds_read_b128 a[32:35], v2 offset:23040
    v_mfma_f32_16x16x32_bf16 v[80:83], a[0:3], v[156:159], v[80:83]
    ds_read_b128 a[36:39], v2 offset:24064
    v_mfma_f32_16x16x32_bf16 v[52:55], a[4:7], v[152:155], v[52:55]
    ds_read_b128 a[40:43], v2 offset:25088
    v_mfma_f32_16x16x32_bf16 v[84:87], a[4:7], v[156:159], v[84:87]
    ds_read_b128 a[44:47], v2 offset:26112
    v_mfma_f32_16x16x32_bf16 v[56:59], a[8:11], v[152:155], v[56:59]
    ds_read_b128 a[48:51], v2 offset:27136
    v_mfma_f32_16x16x32_bf16 v[88:91], a[8:11], v[156:159], v[88:91]
    ds_read_b128 a[52:55], v2 offset:28160
    v_mfma_f32_16x16x32_bf16 v[60:63], a[12:15], v[152:155], v[60:63]
    ds_read_b128 a[56:59], v2 offset:29184
    v_mfma_f32_16x16x32_bf16 v[92:95], a[12:15], v[156:159], v[92:95]
    ds_read_b128 a[60:63], v25 offset:30208
    v_mfma_f32_16x16x32_bf16 v[64:67], a[16:19], v[152:155], v[64:67]
    v_mfma_f32_16x16x32_bf16 v[96:99], a[16:19], v[156:159], v[96:99]
    buffer_load_dwordx4 v[140:143], v23, s[28:31], s82 offen offset:2048 sc1
    v_mfma_f32_16x16x32_bf16 v[68:71], v[152:155], a[20:23], v[68:71]
    v_mfma_f32_16x16x32_bf16 v[100:103], v[156:159], a[20:23], v[100:103]
    v_mfma_f32_16x16x32_bf16 v[72:75], v[152:155], a[24:27], v[72:75]
    v_mfma_f32_16x16x32_bf16 v[104:107], v[156:159], a[24:27], v[104:107]
    buffer_load_dwordx4 v[144:147], v22, s[28:31], s82 offen offset:3072 sc1
    v_mfma_f32_16x16x32_bf16 v[76:79], v[152:155], a[28:31], v[76:79]
    v_mfma_f32_16x16x32_bf16 v[108:111], v[156:159], a[28:31], v[108:111]
    s_cmp_lg_u32 s40, 2
    s_cbranch_scc1 L14
    v_mfma_f32_16x16x32_bf16 v[112:115], a[8:11], v[184:187], 0
    v_mfma_f32_16x16x32_bf16 v[116:119], a[16:19], v[184:187], 0
    v_mfma_f32_16x16x32_bf16 v[120:123], a[12:15], v[184:187], 0
    v_mfma_f32_16x16x32_bf16 v[124:127], v[184:187], a[20:23], 0
    v_mfma_f32_16x16x32_bf16 v[128:131], v[184:187], a[24:27], 0
    v_mfma_f32_16x16x32_bf16 v[132:135], v[184:187], a[28:31], 0
L14:
    s_waitcnt vmcnt(8) lgkmcnt(0)
    v_min_u32 v46, v46, v47
    v_cmp_gt_u32 vcc, 4, v46
    s_cbranch_vccz L16
    s_mov_b32 s60, 0
L15:
    ds_read_b64 v[46:47], v39 offset:16
    s_waitcnt lgkmcnt(0)
    v_min_u32 v46, v46, v47
    v_cmp_gt_u32 vcc, 4, v46
    s_cbranch_vccz L16
    s_add_u32 s60, s60, 1
    s_cmp_lt_u32 s60, 3200000
    s_cbranch_scc1 L15
L16:
    v_mfma_f32_16x16x32_bf16 v[48:51], a[32:35], v[160:163], v[48:51]
    ds_read_b128 a[0:3], v2 offset:30720
    v_mfma_f32_16x16x32_bf16 v[80:83], a[32:35], v[164:167], v[80:83]
    ds_read_b128 a[4:7], v2 offset:31744
    v_mfma_f32_16x16x32_bf16 v[52:55], a[36:39], v[160:163], v[52:55]
    ds_read_b128 a[8:11], v2 offset:32768
    v_mfma_f32_16x16x32_bf16 v[84:87], a[36:39], v[164:167], v[84:87]
    ds_read_b128 a[12:15], v2 offset:33792
    v_mfma_f32_16x16x32_bf16 v[56:59], a[40:43], v[160:163], v[56:59]
    ds_read_b128 a[16:19], v2 offset:34816
    v_mfma_f32_16x16x32_bf16 v[88:91], a[40:43], v[164:167], v[88:91]
    ds_read_b128 a[20:23], v2 offset:35840
    v_mfma_f32_16x16x32_bf16 v[60:63], a[44:47], v[160:163], v[60:63]
    ds_read_b128 a[24:27], v2 offset:36864
    v_mfma_f32_16x16x32_bf16 v[92:95], a[44:47], v[164:167], v[92:95]
    ds_read_b128 a[28:31], v25 offset:37888
    v_mfma_f32_16x16x32_bf16 v[64:67], a[48:51], v[160:163], v[64:67]
    v_mfma_f32_16x16x32_bf16 v[96:99], a[48:51], v[164:167], v[96:99]
    buffer_load_dwordx4 v[148:151], v23, s[28:31], s82 offen offset:3072 sc1
    v_mfma_f32_16x16x32_bf16 v[68:71], v[160:163], a[52:55], v[68:71]
    v_mfma_f32_16x16x32_bf16 v[100:103], v[164:167], a[52:55], v[100:103]
    v_mfma_f32_16x16x32_bf16 v[72:75], v[160:163], a[56:59], v[72:75]
    v_mfma_f32_16x16x32_bf16 v[104:107], v[164:167], a[56:59], v[104:107]
    buffer_load_dwordx4 v[152:155], v22, s[28:31], s83 offen offset:0 sc1
    v_mfma_f32_16x16x32_bf16 v[76:79], v[160:163], a[60:63], v[76:79]
    v_mfma_f32_16x16x32_bf16 v[108:111], v[164:167], a[60:63], v[108:111]
    s_cmp_lg_u32 s40, 3
    s_cbranch_scc1 L17
    v_mfma_f32_16x16x32_bf16 v[112:115], a[40:43], v[184:187], 0
    v_mfma_f32_16x16x32_bf16 v[116:119], a[48:51], v[184:187], 0
    v_mfma_f32_16x16x32_bf16 v[120:123], a[44:47], v[184:187], 0
    v_mfma_f32_16x16x32_bf16 v[124:127], v[184:187], a[52:55], 0
    v_mfma_f32_16x16x32_bf16 v[128:131], v[184:187], a[56:59], 0
    v_mfma_f32_16x16x32_bf16 v[132:135], v[184:187], a[60:63], 0
L17:
    s_waitcnt vmcnt(7) lgkmcnt(0)
    v_mfma_f32_16x16x32_bf16 v[48:51], a[0:3], v[168:171], v[48:51]
    ds_read_b128 a[32:35], v2 offset:38400
    v_mfma_f32_16x16x32_bf16 v[80:83], a[0:3], v[172:175], v[80:83]
    ds_read_b128 a[36:39], v2 offset:39424
    v_mfma_f32_16x16x32_bf16 v[52:55], a[4:7], v[168:171], v[52:55]
    ds_read_b128 a[40:43], v2 offset:40448
    v_mfma_f32_16x16x32_bf16 v[84:87], a[4:7], v[172:175], v[84:87]
    ds_read_b128 a[44:47], v2 offset:41472
    v_mfma_f32_16x16x32_bf16 v[56:59], a[8:11], v[168:171], v[56:59]
    ds_read_b128 a[48:51], v2 offset:42496
    v_mfma_f32_16x16x32_bf16 v[88:91], a[8:11], v[172:175], v[88:91]
    ds_read_b128 a[52:55], v2 offset:43520
    v_mfma_f32_16x16x32_bf16 v[60:63], a[12:15], v[168:171], v[60:63]
    ds_read_b128 a[56:59], v2 offset:44544
    v_mfma_f32_16x16x32_bf16 v[92:95], a[12:15], v[172:175], v[92:95]
    ds_read_b128 a[60:63], v25 offset:45568
    v_mfma_f32_16x16x32_bf16 v[64:67], a[16:19], v[168:171], v[64:67]
    buffer_load_dwordx4 v[156:159], v23, s[28:31], s83 offen offset:0 sc1
    v_mfma_f32_16x16x32_bf16 v[96:99], a[16:19], v[172:175], v[96:99]
    v_mfma_f32_16x16x32_bf16 v[68:71], v[168:171], a[20:23], v[68:71]
    v_mfma_f32_16x16x32_bf16 v[100:103], v[172:175], a[20:23], v[100:103]
    buffer_load_dwordx4 v[184:187], v24, s[28:31], s83 offen offset:0 sc1
    v_mfma_f32_16x16x32_bf16 v[72:75], v[168:171], a[24:27], v[72:75]
    v_mfma_f32_16x16x32_bf16 v[104:107], v[172:175], a[24:27], v[104:107]
    v_mfma_f32_16x16x32_bf16 v[76:79], v[168:171], a[28:31], v[76:79]
    buffer_load_dwordx4 v[160:163], v22, s[28:31], s83 offen offset:1024 sc1
    v_mfma_f32_16x16x32_bf16 v[108:111], v[172:175], a[28:31], v[108:111]
    s_cmp_lg_u32 s40, 0
    s_cbranch_scc1 L18
    v_mfma_f32_16x16x32_bf16 v[112:115], a[8:11], v[188:191], v[112:115]
    v_mfma_f32_16x16x32_bf16 v[116:119], a[16:19], v[188:191], v[116:119]
    v_mfma_f32_16x16x32_bf16 v[120:123], a[12:15], v[188:191], v[120:123]
    v_mfma_f32_16x16x32_bf16 v[124:127], v[188:191], a[20:23], v[124:127]
    v_mfma_f32_16x16x32_bf16 v[128:131], v[188:191], a[24:27], v[128:131]
    v_mfma_f32_16x16x32_bf16 v[132:135], v[188:191], a[28:31], v[132:135]
L18:
    s_waitcnt vmcnt(8) lgkmcnt(0)
    v_mfma_f32_16x16x32_bf16 v[48:51], a[32:35], v[176:179], v[48:51]
    ds_read_b128 a[0:3], v2 offset:46080
    v_mfma_f32_16x16x32_bf16 v[80:83], a[32:35], v[180:183], v[80:83]
    ds_read_b128 a[4:7], v2 offset:47104
    v_mfma_f32_16x16x32_bf16 v[52:55], a[36:39], v[176:179], v[52:55]
    ds_read_b128 a[8:11], v2 offset:48128
    v_mfma_f32_16x16x32_bf16 v[84:87], a[36:39], v[180:183], v[84:87]
    ds_read_b128 a[12:15], v2 offset:49152
    v_mfma_f32_16x16x32_bf16 v[56:59], a[40:43], v[176:179], v[56:59]
    ds_read_b128 a[16:19], v2 offset:50176
    v_mfma_f32_16x16x32_bf16 v[88:91], a[40:43], v[180:183], v[88:91]
    ds_read_b128 a[20:23], v2 offset:51200
    v_mfma_f32_16x16x32_bf16 v[60:63], a[44:47], v[176:179], v[60:63]
    ds_read_b128 a[24:27], v2 offset:52224
    v_mfma_f32_16x16x32_bf16 v[92:95], a[44:47], v[180:183], v[92:95]
    ds_read_b128 a[28:31], v25 offset:53248
    v_mfma_f32_16x16x32_bf16 v[64:67], a[48:51], v[176:179], v[64:67]
    v_mfma_f32_16x16x32_bf16 v[96:99], a[48:51], v[180:183], v[96:99]
    buffer_load_dwordx4 v[164:167], v23, s[28:31], s83 offen offset:1024 sc1
    v_mfma_f32_16x16x32_bf16 v[68:71], v[176:179], a[52:55], v[68:71]
    v_mfma_f32_16x16x32_bf16 v[100:103], v[180:183], a[52:55], v[100:103]
    v_mfma_f32_16x16x32_bf16 v[72:75], v[176:179], a[56:59], v[72:75]
    v_mfma_f32_16x16x32_bf16 v[104:107], v[180:183], a[56:59], v[104:107]
    buffer_load_dwordx4 v[168:171], v22, s[28:31], s83 offen offset:2048 sc1
    v_mfma_f32_16x16x32_bf16 v[76:79], v[176:179], a[60:63], v[76:79]
    v_mfma_f32_16x16x32_bf16 v[108:111], v[180:183], a[60:63], v[108:111]
    s_cmp_lg_u32 s40, 1
    s_cbranch_scc1 L19
    v_mfma_f32_16x16x32_bf16 v[112:115], a[40:43], v[188:191], v[112:115]
    v_mfma_f32_16x16x32_bf16 v[116:119], a[48:51], v[188:191], v[116:119]
    v_mfma_f32_16x16x32_bf16 v[120:123], a[44:47], v[188:191], v[120:123]
    v_mfma_f32_16x16x32_bf16 v[124:127], v[188:191], a[52:55], v[124:127]
    v_mfma_f32_16x16x32_bf16 v[128:131], v[188:191], a[56:59], v[128:131]
    v_mfma_f32_16x16x32_bf16 v[132:135], v[188:191], a[60:63], v[132:135]
L19:
    s_waitcnt vmcnt(8) lgkmcnt(0)
    ds_read_b64 v[46:47], v39 offset:16
    v_mfma_f32_16x16x32_bf16 v[48:51], a[0:3], v[136:139], v[48:51]
    ds_read_b128 a[32:35], v2 offset:53760
    v_mfma_f32_16x16x32_bf16 v[80:83], a[0:3], v[140:143], v[80:83]
    ds_read_b128 a[36:39], v2 offset:54784
    v_mfma_f32_16x16x32_bf16 v[52:55], a[4:7], v[136:139], v[52:55]
    ds_read_b128 a[40:43], v2 offset:55808
    v_mfma_f32_16x16x32_bf16 v[84:87], a[4:7], v[140:143], v[84:87]
    ds_read_b128 a[44:47], v2 offset:56832
    v_mfma_f32_16x16x32_bf16 v[56:59], a[8:11], v[136:139], v[56:59]
    ds_read_b128 a[48:51], v2 offset:57856
    v_mfma_f32_16x16x32_bf16 v[88:91], a[8:11], v[140:143], v[88:91]
    ds_read_b128 a[52:55], v2 offset:58880
    v_mfma_f32_16x16x32_bf16 v[60:63], a[12:15], v[136:139], v[60:63]
    ds_read_b128 a[56:59], v2 offset:59904
    v_mfma_f32_16x16x32_bf16 v[92:95], a[12:15], v[140:143], v[92:95]
    ds_read_b128 a[60:63], v25 offset:60928
    v_mfma_f32_16x16x32_bf16 v[64:67], a[16:19], v[136:139], v[64:67]
    v_mfma_f32_16x16x32_bf16 v[96:99], a[16:19], v[140:143], v[96:99]
    buffer_load_dwordx4 v[172:175], v23, s[28:31], s83 offen offset:2048 sc1
    v_mfma_f32_16x16x32_bf16 v[68:71], v[136:139], a[20:23], v[68:71]
    v_mfma_f32_16x16x32_bf16 v[100:103], v[140:143], a[20:23], v[100:103]
    v_mfma_f32_16x16x32_bf16 v[72:75], v[136:139], a[24:27], v[72:75]
    v_mfma_f32_16x16x32_bf16 v[104:107], v[140:143], a[24:27], v[104:107]
    buffer_load_dwordx4 v[176:179], v22, s[28:31], s83 offen offset:3072 sc1
    v_mfma_f32_16x16x32_bf16 v[76:79], v[136:139], a[28:31], v[76:79]
    v_mfma_f32_16x16x32_bf16 v[108:111], v[140:143], a[28:31], v[108:111]
    s_cmp_lg_u32 s40, 2
    s_cbranch_scc1 L20
    v_mfma_f32_16x16x32_bf16 v[112:115], a[8:11], v[188:191], v[112:115]
    v_mfma_f32_16x16x32_bf16 v[116:119], a[16:19], v[188:191], v[116:119]
    v_mfma_f32_16x16x32_bf16 v[120:123], a[12:15], v[188:191], v[120:123]
    v_mfma_f32_16x16x32_bf16 v[124:127], v[188:191], a[20:23], v[124:127]
    v_mfma_f32_16x16x32_bf16 v[128:131], v[188:191], a[24:27], v[128:131]
    v_mfma_f32_16x16x32_bf16 v[132:135], v[188:191], a[28:31], v[132:135]
L20:
    s_waitcnt vmcnt(8) lgkmcnt(0)
    v_min_u32 v46, v46, v47
    v_cmp_gt_u32 vcc, 5, v46
    s_cbranch_vccz L22
    s_mov_b32 s60, 0
L21:
    ds_read_b64 v[46:47], v39 offset:16
    s_waitcnt lgkmcnt(0)
    v_min_u32 v46, v46, v47
    v_cmp_gt_u32 vcc, 5, v46
    s_cbranch_vccz L22
    s_add_u32 s60, s60, 1
    s_cmp_lt_u32 s60, 3200000
    s_cbranch_scc1 L21
L22:
    v_mfma_f32_16x16x32_bf16 v[48:51], a[32:35], v[144:147], v[48:51]
    ds_read_b128 a[0:3], v2 offset:61440
    v_mfma_f32_16x16x32_bf16 v[80:83], a[32:35], v[148:151], v[80:83]
    ds_read_b128 a[4:7], v2 offset:62464
    v_mfma_f32_16x16x32_bf16 v[52:55], a[36:39], v[144:147], v[52:55]
    ds_read_b128 a[8:11], v2 offset:63488
    v_mfma_f32_16x16x32_bf16 v[84:87], a[36:39], v[148:151], v[84:87]
    ds_read_b128 a[12:15], v2 offset:64512
    v_mfma_f32_16x16x32_bf16 v[56:59], a[40:43], v[144:147], v[56:59]
    ds_read_b128 a[16:19], v7 offset:0
    v_mfma_f32_16x16x32_bf16 v[88:91], a[40:43], v[148:151], v[88:91]
    ds_read_b128 a[20:23], v7 offset:1024
    v_mfma_f32_16x16x32_bf16 v[60:63], a[44:47], v[144:147], v[60:63]
    ds_read_b128 a[24:27], v7 offset:2048
    v_mfma_f32_16x16x32_bf16 v[92:95], a[44:47], v[148:151], v[92:95]
    ds_read_b128 a[28:31], v26 offset:3072
    v_mfma_f32_16x16x32_bf16 v[64:67], a[48:51], v[144:147], v[64:67]
    v_mfma_f32_16x16x32_bf16 v[96:99], a[48:51], v[148:151], v[96:99]
    buffer_load_dwordx4 v[180:183], v23, s[28:31], s83 offen offset:3072 sc1
    v_mfma_f32_16x16x32_bf16 v[68:71], v[144:147], a[52:55], v[68:71]
    v_mfma_f32_16x16x32_bf16 v[100:103], v[148:151], a[52:55], v[100:103]
    v_mfma_f32_16x16x32_bf16 v[72:75], v[144:147], a[56:59], v[72:75]
    v_mfma_f32_16x16x32_bf16 v[104:107], v[148:151], a[56:59], v[104:107]
    buffer_load_dwordx4 v[136:139], v22, s[28:31], s84 offen offset:0 sc1
    v_mfma_f32_16x16x32_bf16 v[76:79], v[144:147], a[60:63], v[76:79]
    v_mfma_f32_16x16x32_bf16 v[108:111], v[148:151], a[60:63], v[108:111]
    s_cmp_lg_u32 s40, 3
    s_cbranch_scc1 L23
    v_mfma_f32_16x16x32_bf16 v[112:115], a[40:43], v[188:191], v[112:115]
    v_mfma_f32_16x16x32_bf16 v[116:119], a[48:51], v[188:191], v[116:119]
    v_mfma_f32_16x16x32_bf16 v[120:123], a[44:47], v[188:191], v[120:123]
    v_mfma_f32_16x16x32_bf16 v[124:127], v[188:191], a[52:55], v[124:127]
    v_mfma_f32_16x16x32_bf16 v[128:131], v[188:191], a[56:59], v[128:131]
    v_mfma_f32_16x16x32_bf16 v[132:135], v[188:191], a[60:63], v[132:135]
L23:
    s_waitcnt vmcnt(7) lgkmcnt(0)
    v_mfma_f32_16x16x32_bf16 v[48:51], a[0:3], v[152:155], v[48:51]
    ds_read_b128 a[32:35], v7 offset:3584
    v_mfma_f32_16x16x32_bf16 v[80:83], a[0:3], v[156:159], v[80:83]
    ds_read_b128 a[36:39], v7 offset:4608
    v_mfma_f32_16x16x32_bf16 v[52:55], a[4:7], v[152:155], v[52:55]
    ds_read_b128 a[40:43], v7 offset:5632
    v_mfma_f32_16x16x32_bf16 v[84:87], a[4:7], v[156:159], v[84:87]
    ds_read_b128 a[44:47], v7 offset:6656
    v_mfma_f32_16x16x32_bf16 v[56:59], a[8:11], v[152:155], v[56:59]
    ds_read_b128 a[48:51], v7 offset:7680
    v_mfma_f32_16x16x32_bf16 v[88:91], a[8:11], v[156:159], v[88:91]
    ds_read_b128 a[52:55], v7 offset:8704
    v_mfma_f32_16x16x32_bf16 v[60:63], a[12:15], v[152:155], v[60:63]
    ds_read_b128 a[56:59], v7 offset:9728
    v_mfma_f32_16x16x32_bf16 v[92:95], a[12:15], v[156:159], v[92:95]
    ds_read_b128 a[60:63], v26 offset:10752
    v_mfma_f32_16x16x32_bf16 v[64:67], a[16:19], v[152:155], v[64:67]
    buffer_load_dwordx4 v[140:143], v23, s[28:31], s84 offen offset:0 sc1
    v_mfma_f32_16x16x32_bf16 v[96:99], a[16:19], v[156:159], v[96:99]
    v_mfma_f32_16x16x32_bf16 v[68:71], v[152:155], a[20:23], v[68:71]
    v_mfma_f32_16x16x32_bf16 v[100:103], v[156:159], a[20:23], v[100:103]
    buffer_load_dwordx4 v[188:191], v24, s[28:31], s84 offen offset:0 sc1
    v_mfma_f32_16x16x32_bf16 v[72:75], v[152:155], a[24:27], v[72:75]
    v_mfma_f32_16x16x32_bf16 v[104:107], v[156:159], a[24:27], v[104:107]
    v_mfma_f32_16x16x32_bf16 v[76:79], v[152:155], a[28:31], v[76:79]
    buffer_load_dwordx4 v[144:147], v22, s[28:31], s84 offen offset:1024 sc1
    v_mfma_f32_16x16x32_bf16 v[108:111], v[156:159], a[28:31], v[108:111]
    s_cmp_lg_u32 s40, 0
    s_cbranch_scc1 L24
    v_mfma_f32_16x16x32_bf16 v[112:115], a[8:11], v[184:187], v[112:115]
    v_mfma_f32_16x16x32_bf16 v[116:119], a[16:19], v[184:187], v[116:119]
    v_mfma_f32_16x16x32_bf16 v[120:123], a[12:15], v[184:187], v[120:123]
    v_mfma_f32_16x16x32_bf16 v[124:127], v[184:187], a[20:23], v[124:127]
    v_mfma_f32_16x16x32_bf16 v[128:131], v[184:187], a[24:27], v[128:131]
    v_mfma_f32_16x16x32_bf16 v[132:135], v[184:187], a[28:31], v[132:135]
L24:
    s_waitcnt vmcnt(8) lgkmcnt(0)
    v_mfma_f32_16x16x32_bf16 v[48:51], a[32:35], v[160:163], v[48:51]
    ds_read_b128 a[0:3], v7 offset:11264
    v_mfma_f32_16x16x32_bf16 v[80:83], a[32:35], v[164:167], v[80:83]
    ds_read_b128 a[4:7], v7 offset:12288
    v_mfma_f32_16x16x32_bf16 v[52:55], a[36:39], v[160:163], v[52:55]
    ds_read_b128 a[8:11], v7 offset:13312
    v_mfma_f32_16x16x32_bf16 v[84:87], a[36:39], v[164:167], v[84:87]
    ds_read_b128 a[12:15], v7 offset:14336
    v_mfma_f32_16x16x32_bf16 v[56:59], a[40:43], v[160:163], v[56:59]
    ds_read_b128 a[16:19], v7 offset:15360
    v_mfma_f32_16x16x32_bf16 v[88:91], a[40:43], v[164:167], v[88:91]
    ds_read_b128 a[20:23], v7 offset:16384
    v_mfma_f32_16x16x32_bf16 v[60:63], a[44:47], v[160:163], v[60:63]
    ds_read_b128 a[24:27], v7 offset:17408
    v_mfma_f32_16x16x32_bf16 v[92:95], a[44:47], v[164:167], v[92:95]
    ds_read_b128 a[28:31], v26 offset:18432
    v_mfma_f32_16x16x32_bf16 v[64:67], a[48:51], v[160:163], v[64:67]
    v_mfma_f32_16x16x32_bf16 v[96:99], a[48:51], v[164:167], v[96:99]
    buffer_load_dwordx4 v[148:151], v23, s[28:31], s84 offen offset:1024 sc1
    v_mfma_f32_16x16x32_bf16 v[68:71], v[160:163], a[52:55], v[68:71]
    v_mfma_f32_16x16x32_bf16 v[100:103], v[164:167], a[52:55], v[100:103]
    v_mfma_f32_16x16x32_bf16 v[72:75], v[160:163], a[56:59], v[72:75]
    v_mfma_f32_16x16x32_bf16 v[104:107], v[164:167], a[56:59], v[104:107]
    buffer_load_dwordx4 v[152:155], v22, s[28:31], s84 offen offset:2048 sc1
    v_mfma_f32_16x16x32_bf16 v[76:79], v[160:163], a[60:63], v[76:79]
    v_mfma_f32_16x16x32_bf16 v[108:111], v[164:167], a[60:63], v[108:111]
    s_cmp_lg_u32 s40, 1
    s_cbranch_scc1 L25
    v_mfma_f32_16x16x32_bf16 v[112:115], a[40:43], v[184:187], v[112:115]
    v_mfma_f32_16x16x32_bf16 v[116:119], a[48:51], v[184:187], v[116:119]
    v_mfma_f32_16x16x32_bf16 v[120:123], a[44:47], v[184:187], v[120:123]
    v_mfma_f32_16x16x32_bf16 v[124:127], v[184:187], a[52:55], v[124:127]
    v_mfma_f32_16x16x32_bf16 v[128:131], v[184:187], a[56:59], v[128:131]
    v_mfma_f32_16x16x32_bf16 v[132:135], v[184:187], a[60:63], v[132:135]
L25:
    s_waitcnt vmcnt(8) lgkmcnt(0)
    ds_read_b64 v[46:47], v39 offset:16
    v_mfma_f32_16x16x32_bf16 v[48:51], a[0:3], v[168:171], v[48:51]
    ds_read_b128 a[32:35], v7 offset:18944
    v_mfma_f32_16x16x32_bf16 v[80:83], a[0:3], v[172:175], v[80:83]
    ds_read_b128 a[36:39], v7 offset:19968
    v_mfma_f32_16x16x32_bf16 v[52:55], a[4:7], v[168:171], v[52:55]
    ds_read_b128 a[40:43], v7 offset:20992
    v_mfma_f32_16x16x32_bf16 v[84:87], a[4:7], v[172:175], v[84:87]
    ds_read_b128 a[44:47], v7 offset:22016
    v_mfma_f32_16x16x32_bf16 v[56:59], a[8:11], v[168:171], v[56:59]
    ds_read_b128 a[48:51], v7 offset:23040
    v_mfma_f32_16x16x32_bf16 v[88:91], a[8:11], v[172:175], v[88:91]
    ds_read_b128 a[52:55], v7 offset:24064
    v_mfma_f32_16x16x32_bf16 v[60:63], a[12:15], v[168:171], v[60:63]
    ds_read_b128 a[56:59], v7 offset:25088
    v_mfma_f32_16x16x32_bf16 v[92:95], a[12:15], v[172:175], v[92:95]
    ds_read_b128 a[60:63], v26 offset:26112
    v_mfma_f32_16x16x32_bf16 v[64:67], a[16:19], v[168:171], v[64:67]
    v_mfma_f32_16x16x32_bf16 v[96:99], a[16:19], v[172:175], v[96:99]
    buffer_load_dwordx4 v[156:159], v23, s[28:31], s84 offen offset:2048 sc1
    v_mfma_f32_16x16x32_bf16 v[68:71], v[168:171], a[20:23], v[68:71]
    v_mfma_f32_16x16x32_bf16 v[100:103], v[172:175], a[20:23], v[100:103]
    v_mfma_f32_16x16x32_bf16 v[72:75], v[168:171], a[24:27], v[72:75]
    v_mfma_f32_16x16x32_bf16 v[104:107], v[172:175], a[24:27], v[104:107]
    buffer_load_dwordx4 v[160:163], v22, s[28:31], s84 offen offset:3072 sc1
    v_mfma_f32_16x16x32_bf16 v[76:79], v[168:171], a[28:31], v[76:79]
    v_mfma_f32_16x16x32_bf16 v[108:111], v[172:175], a[28:31], v[108:111]
    s_cmp_lg_u32 s40, 2
    s_cbranch_scc1 L26
    v_mfma_f32_16x16x32_bf16 v[112:115], a[8:11], v[184:187], v[112:115]
    v_mfma_f32_16x16x32_bf16 v[116:119], a[16:19], v[184:187], v[116:119]
    v_mfma_f32_16x16x32_bf16 v[120:123], a[12:15], v[184:187], v[120:123]
    v_mfma_f32_16x16x32_bf16 v[124:127], v[184:187], a[20:23], v[124:127]
    v_mfma_f32_16x16x32_bf16 v[128:131], v[184:187], a[24:27], v[128:131]
    v_mfma_f32_16x16x32_bf16 v[132:135], v[184:187], a[28:31], v[132:135]
L26:
    s_waitcnt vmcnt(8) lgkmcnt(0)
    v_min_u32 v46, v46, v47
    v_cmp_gt_u32 vcc, 6, v46
    s_cbranch_vccz L28
    s_mov_b32 s60, 0
L27:
    ds_read_b64 v[46:47], v39 offset:16
    s_waitcnt lgkmcnt(0)
    v_min_u32 v46, v46, v47
    v_cmp_gt_u32 vcc, 6, v46
    s_cbranch_vccz L28
    s_add_u32 s60, s60, 1
    s_cmp_lt_u32 s60, 3200000
    s_cbranch_scc1 L27
L28:
    v_mfma_f32_16x16x32_bf16 v[48:51], a[32:35], v[176:179], v[48:51]
    ds_read_b128 a[0:3], v7 offset:26624
    v_mfma_f32_16x16x32_bf16 v[80:83], a[32:35], v[180:183], v[80:83]
    ds_read_b128 a[4:7], v7 offset:27648
    v_mfma_f32_16x16x32_bf16 v[52:55], a[36:39], v[176:179], v[52:55]
    ds_read_b128 a[8:11], v7 offset:28672
    v_mfma_f32_16x16x32_bf16 v[84:87], a[36:39], v[180:183], v[84:87]
    ds_read_b128 a[12:15], v7 offset:29696
    v_mfma_f32_16x16x32_bf16 v[56:59], a[40:43], v[176:179], v[56:59]
    ds_read_b128 a[16:19], v7 offset:30720
    v_mfma_f32_16x16x32_bf16 v[88:91], a[40:43], v[180:183], v[88:91]
    ds_read_b128 a[20:23], v7 offset:31744
    v_mfma_f32_16x16x32_bf16 v[60:63], a[44:47], v[176:179], v[60:63]
    ds_read_b128 a[24:27], v7 offset:32768
    v_mfma_f32_16x16x32_bf16 v[92:95], a[44:47], v[180:183], v[92:95]
    ds_read_b128 a[28:31], v26 offset:33792
    v_mfma_f32_16x16x32_bf16 v[64:67], a[48:51], v[176:179], v[64:67]
    v_mfma_f32_16x16x32_bf16 v[96:99], a[48:51], v[180:183], v[96:99]
    buffer_load_dwordx4 v[164:167], v23, s[28:31], s84 offen offset:3072 sc1
    v_mfma_f32_16x16x32_bf16 v[68:71], v[176:179], a[52:55], v[68:71]
    v_mfma_f32_16x16x32_bf16 v[100:103], v[180:183], a[52:55], v[100:103]
    v_mfma_f32_16x16x32_bf16 v[72:75], v[176:179], a[56:59], v[72:75]
    v_mfma_f32_16x16x32_bf16 v[104:107], v[180:183], a[56:59], v[104:107]
    buffer_load_dwordx4 v[168:171], v22, s[28:31], s85 offen offset:0 sc1
    v_mfma_f32_16x16x32_bf16 v[76:79], v[176:179], a[60:63], v[76:79]
    v_mfma_f32_16x16x32_bf16 v[108:111], v[180:183], a[60:63], v[108:111]
    s_cmp_lg_u32 s40, 3
    s_cbranch_scc1 L29
    v_mfma_f32_16x16x32_bf16 v[112:115], a[40:43], v[184:187], v[112:115]
    v_mfma_f32_16x16x32_bf16 v[116:119], a[48:51], v[184:187], v[116:119]
    v_mfma_f32_16x16x32_bf16 v[120:123], a[44:47], v[184:187], v[120:123]
    v_mfma_f32_16x16x32_bf16 v[124:127], v[184:187], a[52:55], v[124:127]
    v_mfma_f32_16x16x32_bf16 v[128:131], v[184:187], a[56:59], v[128:131]
    v_mfma_f32_16x16x32_bf16 v[132:135], v[184:187], a[60:63], v[132:135]
L29:
    s_waitcnt vmcnt(7) lgkmcnt(0)
    v_mfma_f32_16x16x32_bf16 v[48:51], a[0:3], v[136:139], v[48:51]
    ds_read_b128 a[32:35], v7 offset:34304
    v_mfma_f32_16x16x32_bf16 v[80:83], a[0:3], v[140:143], v[80:83]
    ds_read_b128 a[36:39], v7 offset:35328
    v_mfma_f32_16x16x32_bf16 v[52:55], a[4:7], v[136:139], v[52:55]
    ds_read_b128 a[40:43], v7 offset:36352
    v_mfma_f32_16x16x32_bf16 v[84:87], a[4:7], v[140:143], v[84:87]
    ds_read_b128 a[44:47], v7 offset:37376
    v_mfma_f32_16x16x32_bf16 v[56:59], a[8:11], v[136:139], v[56:59]
    ds_read_b128 a[48:51], v7 offset:38400
    v_mfma_f32_16x16x32_bf16 v[88:91], a[8:11], v[140:143], v[88:91]
    ds_read_b128 a[52:55], v7 offset:39424
    v_mfma_f32_16x16x32_bf16 v[60:63], a[12:15], v[136:139], v[60:63]
    ds_read_b128 a[56:59], v7 offset:40448
    v_mfma_f32_16x16x32_bf16 v[92:95], a[12:15], v[140:143], v[92:95]
    ds_read_b128 a[60:63], v26 offset:41472
    v_mfma_f32_16x16x32_bf16 v[64:67], a[16:19], v[136:139], v[64:67]
    buffer_load_dwordx4 v[172:175], v23, s[28:31], s85 offen offset:0 sc1
    v_mfma_f32_16x16x32_bf16 v[96:99], a[16:19], v[140:143], v[96:99]
    v_mfma_f32_16x16x32_bf16 v[68:71], v[136:139], a[20:23], v[68:71]
    v_mfma_f32_16x16x32_bf16 v[100:103], v[140:143], a[20:23], v[100:103]
    buffer_load_dwordx4 v[184:187], v24, s[28:31], s85 offen offset:0 sc1
    v_mfma_f32_16x16x32_bf16 v[72:75], v[136:139], a[24:27], v[72:75]
    v_mfma_f32_16x16x32_bf16 v[104:107], v[140:143], a[24:27], v[104:107]
    v_mfma_f32_16x16x32_bf16 v[76:79], v[136:139], a[28:31], v[76:79]
    buffer_load_dwordx4 v[176:179], v22, s[28:31], s85 offen offset:1024 sc1
    v_mfma_f32_16x16x32_bf16 v[108:111], v[140:143], a[28:31], v[108:111]
    s_cmp_lg_u32 s40, 0
    s_cbranch_scc1 L30
    v_mfma_f32_16x16x32_bf16 v[112:115], a[8:11], v[188:191], v[112:115]
    v_mfma_f32_16x16x32_bf16 v[116:119], a[16:19], v[188:191], v[116:119]
    v_mfma_f32_16x16x32_bf16 v[120:123], a[12:15], v[188:191], v[120:123]
    v_mfma_f32_16x16x32_bf16 v[124:127], v[188:191], a[20:23], v[124:127]
    v_mfma_f32_16x16x32_bf16 v[128:131], v[188:191], a[24:27], v[128:131]
    v_mfma_f32_16x16x32_bf16 v[132:135], v[188:191], a[28:31], v[132:135]
L30:
    s_waitcnt vmcnt(8) lgkmcnt(0)
    v_mfma_f32_16x16x32_bf16 v[48:51], a[32:35], v[144:147], v[48:51]
    ds_read_b128 a[0:3], v7 offset:41984
    v_mfma_f32_16x16x32_bf16 v[80:83], a[32:35], v[148:151], v[80:83]
    ds_read_b128 a[4:7], v7 offset:43008
    v_mfma_f32_16x16x32_bf16 v[52:55], a[36:39], v[144:147], v[52:55]
    ds_read_b128 a[8:11], v7 offset:44032
    v_mfma_f32_16x16x32_bf16 v[84:87], a[36:39], v[148:151], v[84:87]
    ds_read_b128 a[12:15], v7 offset:45056
    v_mfma_f32_16x16x32_bf16 v[56:59], a[40:43], v[144:147], v[56:59]
    ds_read_b128 a[16:19], v7 offset:46080
    v_mfma_f32_16x16x32_bf16 v[88:91], a[40:43], v[148:151], v[88:91]
    ds_read_b128 a[20:23], v7 offset:47104
    v_mfma_f32_16x16x32_bf16 v[60:63], a[44:47], v[144:147], v[60:63]
    ds_read_b128 a[24:27], v7 offset:48128
    v_mfma_f32_16x16x32_bf16 v[92:95], a[44:47], v[148:151], v[92:95]
    ds_read_b128 a[28:31], v26 offset:49152
    v_mfma_f32_16x16x32_bf16 v[64:67], a[48:51], v[144:147], v[64:67]
    v_mfma_f32_16x16x32_bf16 v[96:99], a[48:51], v[148:151], v[96:99]
    buffer_load_dwordx4 v[180:183], v23, s[28:31], s85 offen offset:1024 sc1
    v_mfma_f32_16x16x32_bf16 v[68:71], v[144:147], a[52:55], v[68:71]
    v_mfma_f32_16x16x32_bf16 v[100:103], v[148:151], a[52:55], v[100:103]
    v_mfma_f32_16x16x32_bf16 v[72:75], v[144:147], a[56:59], v[72:75]
    v_mfma_f32_16x16x32_bf16 v[104:107], v[148:151], a[56:59], v[104:107]
    buffer_load_dwordx4 v[136:139], v22, s[28:31], s85 offen offset:2048 sc1
    v_mfma_f32_16x16x32_bf16 v[76:79], v[144:147], a[60:63], v[76:79]
    v_mfma_f32_16x16x32_bf16 v[108:111], v[148:151], a[60:63], v[108:111]
    s_cmp_lg_u32 s40, 1
    s_cbranch_scc1 L31
    v_mfma_f32_16x16x32_bf16 v[112:115], a[40:43], v[188:191], v[112:115]
    v_mfma_f32_16x16x32_bf16 v[116:119], a[48:51], v[188:191], v[116:119]
    v_mfma_f32_16x16x32_bf16 v[120:123], a[44:47], v[188:191], v[120:123]
    v_mfma_f32_16x16x32_bf16 v[124:127], v[188:191], a[52:55], v[124:127]
    v_mfma_f32_16x16x32_bf16 v[128:131], v[188:191], a[56:59], v[128:131]
    v_mfma_f32_16x16x32_bf16 v[132:135], v[188:191], a[60:63], v[132:135]
L31:
    s_waitcnt vmcnt(8) lgkmcnt(0)
    ds_read_b64 v[46:47], v39 offset:16
    v_mfma_f32_16x16x32_bf16 v[48:51], a[0:3], v[152:155], v[48:51]
    ds_read_b128 a[32:35], v7 offset:49664
    v_mfma_f32_16x16x32_bf16 v[80:83], a[0:3], v[156:159], v[80:83]
    ds_read_b128 a[36:39], v7 offset:50688
    v_mfma_f32_16x16x32_bf16 v[52:55], a[4:7], v[152:155], v[52:55]
    ds_read_b128 a[40:43], v7 offset:51712
    v_mfma_f32_16x16x32_bf16 v[84:87], a[4:7], v[156:159], v[84:87]
    ds_read_b128 a[44:47], v7 offset:52736
    v_mfma_f32_16x16x32_bf16 v[56:59], a[8:11], v[152:155], v[56:59]
    ds_read_b128 a[48:51], v7 offset:53760
    v_mfma_f32_16x16x32_bf16 v[88:91], a[8:11], v[156:159], v[88:91]
    ds_read_b128 a[52:55], v7 offset:54784
    v_mfma_f32_16x16x32_bf16 v[60:63], a[12:15], v[152:155], v[60:63]
    ds_read_b128 a[56:59], v7 offset:55808
    v_mfma_f32_16x16x32_bf16 v[92:95], a[12:15], v[156:159], v[92:95]
    ds_read_b128 a[60:63], v26 offset:56832
    v_mfma_f32_16x16x32_bf16 v[64:67], a[16:19], v[152:155], v[64:67]
    v_mfma_f32_16x16x32_bf16 v[96:99], a[16:19], v[156:159], v[96:99]
    buffer_load_dwordx4 v[140:143], v23, s[28:31], s85 offen offset:2048 sc1
    v_mfma_f32_16x16x32_bf16 v[68:71], v[152:155], a[20:23], v[68:71]
    v_mfma_f32_16x16x32_bf16 v[100:103], v[156:159], a[20:23], v[100:103]
    v_mfma_f32_16x16x32_bf16 v[72:75], v[152:155], a[24:27], v[72:75]
    v_mfma_f32_16x16x32_bf16 v[104:107], v[156:159], a[24:27], v[104:107]
    buffer_load_dwordx4 v[144:147], v22, s[28:31], s85 offen offset:3072 sc1
    v_mfma_f32_16x16x32_bf16 v[76:79], v[152:155], a[28:31], v[76:79]
    v_mfma_f32_16x16x32_bf16 v[108:111], v[156:159], a[28:31], v[108:111]
    s_cmp_lg_u32 s40, 2
    s_cbranch_scc1 L32
    v_mfma_f32_16x16x32_bf16 v[112:115], a[8:11], v[188:191], v[112:115]
    v_mfma_f32_16x16x32_bf16 v[116:119], a[16:19], v[188:191], v[116:119]
    v_mfma_f32_16x16x32_bf16 v[120:123], a[12:15], v[188:191], v[120:123]
    v_mfma_f32_16x16x32_bf16 v[124:127], v[188:191], a[20:23], v[124:127]
    v_mfma_f32_16x16x32_bf16 v[128:131], v[188:191], a[24:27], v[128:131]
    v_mfma_f32_16x16x32_bf16 v[132:135], v[188:191], a[28:31], v[132:135]
L32:
    s_waitcnt vmcnt(8) lgkmcnt(0)
    v_min_u32 v46, v46, v47
    v_cmp_gt_u32 vcc, 7, v46
    s_cbranch_vccz L34
    s_mov_b32 s60, 0
L33:
    ds_read_b64 v[46:47], v39 offset:16
    s_waitcnt lgkmcnt(0)
    v_min_u32 v46, v46, v47
    v_cmp_gt_u32 vcc, 7, v46
    s_cbranch_vccz L34
    s_add_u32 s60, s60, 1
    s_cmp_lt_u32 s60, 3200000
    s_cbranch_scc1 L33
L34:
    v_mov_b32_e64 v0, 4
    ds_write_b32 v45, v0
    v_mfma_f32_16x16x32_bf16 v[48:51], a[32:35], v[160:163], v[48:51]
    ds_read_b128 a[0:3], v7 offset:57344
    v_mfma_f32_16x16x32_bf16 v[80:83], a[32:35], v[164:167], v[80:83]
    ds_read_b128 a[4:7], v7 offset:58368
    v_mfma_f32_16x16x32_bf16 v[52:55], a[36:39], v[160:163], v[52:55]
    ds_read_b128 a[8:11], v7 offset:59392
    v_mfma_f32_16x16x32_bf16 v[84:87], a[36:39], v[164:167], v[84:87]
    ds_read_b128 a[12:15], v7 offset:60416
    v_mfma_f32_16x16x32_bf16 v[56:59], a[40:43], v[160:163], v[56:59]
    ds_read_b128 a[16:19], v7 offset:61440
    v_mfma_f32_16x16x32_bf16 v[88:91], a[40:43], v[164:167], v[88:91]
    ds_read_b128 a[20:23], v7 offset:62464
    v_mfma_f32_16x16x32_bf16 v[60:63], a[44:47], v[160:163], v[60:63]
    ds_read_b128 a[24:27], v7 offset:63488
    v_mfma_f32_16x16x32_bf16 v[92:95], a[44:47], v[164:167], v[92:95]
    ds_read_b128 a[28:31], v26 offset:64512
    v_mfma_f32_16x16x32_bf16 v[64:67], a[48:51], v[160:163], v[64:67]
    v_mfma_f32_16x16x32_bf16 v[96:99], a[48:51], v[164:167], v[96:99]
    buffer_load_dwordx4 v[148:151], v23, s[28:31], s85 offen offset:3072 sc1
    v_mfma_f32_16x16x32_bf16 v[68:71], v[160:163], a[52:55], v[68:71]
    v_mfma_f32_16x16x32_bf16 v[100:103], v[164:167], a[52:55], v[100:103]
    v_mfma_f32_16x16x32_bf16 v[72:75], v[160:163], a[56:59], v[72:75]
    v_mfma_f32_16x16x32_bf16 v[104:107], v[164:167], a[56:59], v[104:107]
    buffer_load_dwordx4 v[10:13], v37, s[32:35], 0 offen
    v_mfma_f32_16x16x32_bf16 v[76:79], v[160:163], a[60:63], v[76:79]
    v_mfma_f32_16x16x32_bf16 v[108:111], v[164:167], a[60:63], v[108:111]
    s_cmp_lg_u32 s40, 3
    s_cbranch_scc1 L35
    v_mfma_f32_16x16x32_bf16 v[112:115], a[40:43], v[188:191], v[112:115]
    v_mfma_f32_16x16x32_bf16 v[116:119], a[48:51], v[188:191], v[116:119]
    v_mfma_f32_16x16x32_bf16 v[120:123], a[44:47], v[188:191], v[120:123]
    v_mfma_f32_16x16x32_bf16 v[124:127], v[188:191], a[52:55], v[124:127]
    v_mfma_f32_16x16x32_bf16 v[128:131], v[188:191], a[56:59], v[128:131]
    v_mfma_f32_16x16x32_bf16 v[132:135], v[188:191], a[60:63], v[132:135]
L35:
    s_waitcnt vmcnt(7) lgkmcnt(0)
    v_mfma_f32_16x16x32_bf16 v[48:51], a[0:3], v[168:171], v[48:51]
    ds_read_b128 a[32:35], v7 offset:65024
    v_mfma_f32_16x16x32_bf16 v[80:83], a[0:3], v[172:175], v[80:83]
    ds_read_b128 a[36:39], v8 offset:512
    v_mfma_f32_16x16x32_bf16 v[52:55], a[4:7], v[168:171], v[52:55]
    ds_read_b128 a[40:43], v8 offset:1536
    v_mfma_f32_16x16x32_bf16 v[84:87], a[4:7], v[172:175], v[84:87]
    ds_read_b128 a[44:47], v8 offset:2560
    v_mfma_f32_16x16x32_bf16 v[56:59], a[8:11], v[168:171], v[56:59]
    ds_read_b128 a[48:51], v8 offset:3584
    v_mfma_f32_16x16x32_bf16 v[88:91], a[8:11], v[172:175], v[88:91]
    ds_read_b128 a[52:55], v8 offset:4608
    v_mfma_f32_16x16x32_bf16 v[60:63], a[12:15], v[168:171], v[60:63]
    ds_read_b128 a[56:59], v8 offset:5632
    v_mfma_f32_16x16x32_bf16 v[92:95], a[12:15], v[172:175], v[92:95]
    ds_read_b128 a[60:63], v27 offset:6656
    v_mfma_f32_16x16x32_bf16 v[64:67], a[16:19], v[168:171], v[64:67]
    buffer_load_dwordx4 v[14:17], v37, s[32:35], 0 offen offset:64
    v_mfma_f32_16x16x32_bf16 v[96:99], a[16:19], v[172:175], v[96:99]
    v_mfma_f32_16x16x32_bf16 v[68:71], v[168:171], a[20:23], v[68:71]
    v_mfma_f32_16x16x32_bf16 v[100:103], v[172:175], a[20:23], v[100:103]
    buffer_load_dwordx4 v[18:21], v38, s[32:35], 0 offen
    v_mfma_f32_16x16x32_bf16 v[72:75], v[168:171], a[24:27], v[72:75]
    v_mfma_f32_16x16x32_bf16 v[104:107], v[172:175], a[24:27], v[104:107]
    v_mfma_f32_16x16x32_bf16 v[76:79], v[168:171], a[28:31], v[76:79]
    v_mfma_f32_16x16x32_bf16 v[108:111], v[172:175], a[28:31], v[108:111]
    s_cmp_lg_u32 s40, 0
    s_cbranch_scc1 L36
    v_mfma_f32_16x16x32_bf16 v[112:115], a[8:11], v[184:187], v[112:115]
    v_mfma_f32_16x16x32_bf16 v[116:119], a[16:19], v[184:187], v[116:119]
    v_mfma_f32_16x16x32_bf16 v[120:123], a[12:15], v[184:187], v[120:123]
    v_mfma_f32_16x16x32_bf16 v[124:127], v[184:187], a[20:23], v[124:127]
    v_mfma_f32_16x16x32_bf16 v[128:131], v[184:187], a[24:27], v[128:131]
    v_mfma_f32_16x16x32_bf16 v[132:135], v[184:187], a[28:31], v[132:135]
L36:
    s_waitcnt vmcnt(7) lgkmcnt(0)
    v_mfma_f32_16x16x32_bf16 v[48:51], a[32:35], v[176:179], v[48:51]
    ds_read_b128 a[0:3], v8 offset:7168
    v_mfma_f32_16x16x32_bf16 v[80:83], a[32:35], v[180:183], v[80:83]
    ds_read_b128 a[4:7], v8 offset:8192
    v_mfma_f32_16x16x32_bf16 v[52:55], a[36:39], v[176:179], v[52:55]
    ds_read_b128 a[8:11], v8 offset:9216
    v_mfma_f32_16x16x32_bf16 v[84:87], a[36:39], v[180:183], v[84:87]
    ds_read_b128 a[12:15], v8 offset:10240
    v_mfma_f32_16x16x32_bf16 v[56:59], a[40:43], v[176:179], v[56:59]
    ds_read_b128 a[16:19], v8 offset:11264
    v_mfma_f32_16x16x32_bf16 v[88:91], a[40:43], v[180:183], v[88:91]
    ds_read_b128 a[20:23], v8 offset:12288
    v_mfma_f32_16x16x32_bf16 v[60:63], a[44:47], v[176:179], v[60:63]
    ds_read_b128 a[24:27], v8 offset:13312
    v_mfma_f32_16x16x32_bf16 v[92:95], a[44:47], v[180:183], v[92:95]
    ds_read_b128 a[28:31], v27 offset:14336
    v_mfma_f32_16x16x32_bf16 v[64:67], a[48:51], v[176:179], v[64:67]
    v_mfma_f32_16x16x32_bf16 v[96:99], a[48:51], v[180:183], v[96:99]
    v_mfma_f32_16x16x32_bf16 v[68:71], v[176:179], a[52:55], v[68:71]
    v_mfma_f32_16x16x32_bf16 v[100:103], v[180:183], a[52:55], v[100:103]
    v_mfma_f32_16x16x32_bf16 v[72:75], v[176:179], a[56:59], v[72:75]
    v_mfma_f32_16x16x32_bf16 v[104:107], v[180:183], a[56:59], v[104:107]
    v_mfma_f32_16x16x32_bf16 v[76:79], v[176:179], a[60:63], v[76:79]
    v_mfma_f32_16x16x32_bf16 v[108:111], v[180:183], a[60:63], v[108:111]
    s_cmp_lg_u32 s40, 1
    s_cbranch_scc1 L37
    v_mfma_f32_16x16x32_bf16 v[112:115], a[40:43], v[184:187], v[112:115]
    v_mfma_f32_16x16x32_bf16 v[116:119], a[48:51], v[184:187], v[116:119]
    v_mfma_f32_16x16x32_bf16 v[120:123], a[44:47], v[184:187], v[120:123]
    v_mfma_f32_16x16x32_bf16 v[124:127], v[184:187], a[52:55], v[124:127]
    v_mfma_f32_16x16x32_bf16 v[128:131], v[184:187], a[56:59], v[128:131]
    v_mfma_f32_16x16x32_bf16 v[132:135], v[184:187], a[60:63], v[132:135]
L37:
    s_waitcnt vmcnt(5) lgkmcnt(0)
    ds_read_b128 v[188:191], v39
    v_mfma_f32_16x16x32_bf16 v[48:51], a[0:3], v[136:139], v[48:51]
    ds_read_b128 a[32:35], v8 offset:14848
    v_mfma_f32_16x16x32_bf16 v[80:83], a[0:3], v[140:143], v[80:83]
    ds_read_b128 a[36:39], v8 offset:15872
    v_mfma_f32_16x16x32_bf16 v[52:55], a[4:7], v[136:139], v[52:55]
    ds_read_b128 a[40:43], v8 offset:16896
    v_mfma_f32_16x16x32_bf16 v[84:87], a[4:7], v[140:143], v[84:87]
    ds_read_b128 a[44:47], v8 offset:17920
    v_mfma_f32_16x16x32_bf16 v[56:59], a[8:11], v[136:139], v[56:59]
    ds_read_b128 a[48:51], v8 offset:18944
    v_mfma_f32_16x16x32_bf16 v[88:91], a[8:11], v[140:143], v[88:91]
    ds_read_b128 a[52:55], v8 offset:19968
    v_mfma_f32_16x16x32_bf16 v[60:63], a[12:15], v[136:139], v[60:63]
    ds_read_b128 a[56:59], v8 offset:20992
    v_mfma_f32_16x16x32_bf16 v[92:95], a[12:15], v[140:143], v[92:95]
    ds_read_b128 a[60:63], v27 offset:22016
    v_mfma_f32_16x16x32_bf16 v[64:67], a[16:19], v[136:139], v[64:67]
    v_mfma_f32_16x16x32_bf16 v[96:99], a[16:19], v[140:143], v[96:99]
    v_mfma_f32_16x16x32_bf16 v[68:71], v[136:139], a[20:23], v[68:71]
    v_mfma_f32_16x16x32_bf16 v[100:103], v[140:143], a[20:23], v[100:103]
    v_mfma_f32_16x16x32_bf16 v[72:75], v[136:139], a[24:27], v[72:75]
    v_mfma_f32_16x16x32_bf16 v[104:107], v[140:143], a[24:27], v[104:107]
    v_mfma_f32_16x16x32_bf16 v[76:79], v[136:139], a[28:31], v[76:79]
    v_mfma_f32_16x16x32_bf16 v[108:111], v[140:143], a[28:31], v[108:111]
    s_cmp_lg_u32 s40, 2
    s_cbranch_scc1 L38
    v_mfma_f32_16x16x32_bf16 v[112:115], a[8:11], v[184:187], v[112:115]
    v_mfma_f32_16x16x32_bf16 v[116:119], a[16:19], v[184:187], v[116:119]
    v_mfma_f32_16x16x32_bf16 v[120:123], a[12:15], v[184:187], v[120:123]
    v_mfma_f32_16x16x32_bf16 v[124:127], v[184:187], a[20:23], v[124:127]
    v_mfma_f32_16x16x32_bf16 v[128:131], v[184:187], a[24:27], v[128:131]
    v_mfma_f32_16x16x32_bf16 v[132:135], v[184:187], a[28:31], v[132:135]
L38:
    s_waitcnt vmcnt(3) lgkmcnt(0)
    v_mfma_f32_16x16x32_bf16 v[48:51], a[32:35], v[144:147], v[48:51]
    v_mfma_f32_16x16x32_bf16 v[80:83], a[32:35], v[148:151], v[80:83]
    v_mfma_f32_16x16x32_bf16 v[52:55], a[36:39], v[144:147], v[52:55]
    v_mfma_f32_16x16x32_bf16 v[84:87], a[36:39], v[148:151], v[84:87]
    v_mfma_f32_16x16x32_bf16 v[56:59], a[40:43], v[144:147], v[56:59]
    v_mfma_f32_16x16x32_bf16 v[88:91], a[40:43], v[148:151], v[88:91]
    v_mfma_f32_16x16x32_bf16 v[60:63], a[44:47], v[144:147], v[60:63]
    v_mfma_f32_16x16x32_bf16 v[92:95], a[44:47], v[148:151], v[92:95]
    v_mfma_f32_16x16x32_bf16 v[64:67], a[48:51], v[144:147], v[64:67]
    v_mfma_f32_16x16x32_bf16 v[96:99], a[48:51], v[148:151], v[96:99]
    v_mfma_f32_16x16x32_bf16 v[68:71], v[144:147], a[52:55], v[68:71]
    v_mfma_f32_16x16x32_bf16 v[100:103], v[148:151], a[52:55], v[100:103]
    v_mfma_f32_16x16x32_bf16 v[72:75], v[144:147], a[56:59], v[72:75]
    v_mfma_f32_16x16x32_bf16 v[104:107], v[148:151], a[56:59], v[104:107]
    v_mfma_f32_16x16x32_bf16 v[76:79], v[144:147], a[60:63], v[76:79]
    v_mfma_f32_16x16x32_bf16 v[108:111], v[148:151], a[60:63], v[108:111]
    s_cmp_lg_u32 s40, 3
    s_cbranch_scc1 L39
    v_mfma_f32_16x16x32_bf16 v[112:115], a[40:43], v[184:187], v[112:115]
    v_mfma_f32_16x16x32_bf16 v[116:119], a[48:51], v[184:187], v[116:119]
    v_mfma_f32_16x16x32_bf16 v[120:123], a[44:47], v[184:187], v[120:123]
    v_mfma_f32_16x16x32_bf16 v[124:127], v[184:187], a[52:55], v[124:127]
    v_mfma_f32_16x16x32_bf16 v[128:131], v[184:187], a[56:59], v[128:131]
    v_mfma_f32_16x16x32_bf16 v[132:135], v[184:187], a[60:63], v[132:135]
L39:
    v_min_u32_e64 v188, v188, v189
    v_min3_u32 v46, v188, v190, v191
    v_cmp_gt_u32 vcc, 4, v46
    s_cbranch_vccz L41
    s_mov_b32 s60, 0
L40:
    ds_read_b128 v[188:191], v39 offset:0
    s_waitcnt lgkmcnt(0)
    v_min_u32_e64 v188, v188, v189
    v_min3_u32 v46, v188, v190, v191
    v_cmp_gt_u32 vcc, 4, v46
    s_cbranch_vccz L41
    s_add_u32 s60, s60, 1
    s_cmp_lt_u32 s60, 3200000
    s_cbranch_scc1 L40
L41:
    s_nop 3
    ds_write_b128 v32, v[112:115] offset:0
    v_cvt_pk_bf16_f32 v136, v88, v89
    v_cvt_pk_bf16_f32 v137, v90, v91
    ds_write_b128 v32, v[116:119] offset:1024
    v_cvt_pk_bf16_f32 v138, v96, v97
    v_cvt_pk_bf16_f32 v139, v98, v99
    ds_write_b128 v32, v[120:123] offset:2048
    v_cvt_pk_bf16_f32 v140, v92, v93
    v_cvt_pk_bf16_f32 v141, v94, v95
    ds_write_b128 v32, v[124:127] offset:3072
    v_cvt_pk_bf16_f32 v158, v100, v101
    v_cvt_pk_bf16_f32 v159, v102, v103
    ds_write_b128 v32, v[128:131] offset:4096
    v_cvt_pk_bf16_f32 v164, v104, v105
    v_cvt_pk_bf16_f32 v165, v106, v107
    ds_write_b128 v32, v[132:135] offset:5120
    v_cvt_pk_bf16_f32 v170, v108, v109
    v_cvt_pk_bf16_f32 v171, v110, v111
    v_mov_b32 v0, 5
    ds_write_b32 v45, v0
    ds_write_b64 v33, v[136:137] offset:3072
    v_cvt_pk_bf16_f32 v142, v56, v57
    v_cvt_pk_bf16_f32 v143, v58, v59
    ds_write_b64 v33, v[138:139] offset:3584
    v_cvt_pk_bf16_f32 v144, v64, v65
    v_cvt_pk_bf16_f32 v145, v66, v67
    ds_write_b64 v33, v[140:141] offset:4096
    v_cvt_pk_bf16_f32 v146, v60, v61
    v_cvt_pk_bf16_f32 v147, v62, v63
    ds_write_b64 v33, v[158:159] offset:4608
    v_cvt_pk_bf16_f32 v172, v80, v81
    v_cvt_pk_bf16_f32 v173, v82, v83
    ds_write_b64 v33, v[164:165] offset:5120
    v_cvt_pk_bf16_f32 v178, v84, v85
    v_cvt_pk_bf16_f32 v179, v86, v87
    ds_write_b64 v33, v[170:171] offset:5632
    v_cvt_pk_bf16_f32 v180, v48, v49
    v_cvt_pk_bf16_f32 v181, v50, v51
    v_mov_b32_e64 v0, 6
    ds_write_b32 v45, v0
    v_mov_b32 v188, 0
    v_mov_b32 v189, 0
    v_mov_b32 v190, v138
    v_mov_b32 v191, v139
    v_cvt_pk_bf16_f32 v186, v52, v53
    v_cvt_pk_bf16_f32 v187, v54, v55
    v_permlane16_swap_b32 v188, v190
    v_permlane16_swap_b32 v189, v191
    v_cndmask_b32_e64 v174, 0, v188, s[56:57]
    v_cndmask_b32_e64 v175, 0, v189, s[56:57]
    v_cndmask_b32_e64 v176, 0, v188, s[58:59]
    v_cndmask_b32_e64 v177, 0, v189, s[58:59]
    v_cvt_pk_bf16_f32 v156, v68, v69
    v_cvt_pk_bf16_f32 v157, v70, v71
    v_cvt_pk_bf16_f32 v162, v72, v73
    v_cvt_pk_bf16_f32 v163, v74, v75
    v_cvt_pk_bf16_f32 v168, v76, v77
    v_cvt_pk_bf16_f32 v169, v78, v79
    v_mov_b32 v188, 0
    v_mov_b32 v189, 0
    v_mov_b32 v190, v144
    v_mov_b32 v191, v145
    s_nop 0
    v_permlane16_swap_b32 v188, v190
    v_permlane16_swap_b32 v189, v191
    v_cndmask_b32_e64 v182, 0, v188, s[56:57]
    v_cndmask_b32_e64 v183, 0, v189, s[56:57]
    v_cndmask_b32_e64 v184, 0, v188, s[58:59]
    v_cndmask_b32_e64 v185, 0, v189, s[58:59]
    v_mfma_f32_16x16x32_bf16 v[48:51], v[136:139], v[172:175], 0
    v_mfma_f32_16x16x32_bf16 v[52:55], v[142:145], v[172:175], 0
    v_mfma_f32_16x16x32_bf16 v[56:59], v[138:141], v[176:179], 0
    v_mfma_f32_16x16x32_bf16 v[60:63], v[144:147], v[176:179], 0
    s_nop 4
    v_cndmask_b32_e64 v64, v48, v49, s[48:49]
    v_cndmask_b32_e64 v65, v50, v51, s[48:49]
    v_cndmask_b32_e64 v66, v52, v53, s[48:49]
    v_cndmask_b32_e64 v67, v54, v55, s[48:49]
    v_cndmask_b32_e64 v72, v56, v57, s[48:49]
    v_cndmask_b32_e64 v73, v58, v59, s[48:49]
    v_cndmask_b32_e64 v74, v60, v61, s[48:49]
    v_cndmask_b32_e64 v75, v62, v63, s[48:49]
    v_cndmask_b32_e64 v64, v66, v64, s[50:51]
    v_cndmask_b32_e64 v65, v67, v65, s[52:53]
    v_cndmask_b32_e64 v72, v74, v72, s[50:51]
    v_cndmask_b32_e64 v73, v75, v73, s[52:53]
    v_max_f32 v66, v64, v65
    v_max_f32 v74, v72, v73
    v_mov_b32 v68, v66
    v_mov_b32 v69, v74
    s_nop 0
    v_permlane32_swap_b32 v66, v68
    v_permlane32_swap_b32 v74, v69
    v_max_f32 v66, v66, v68
    v_max_f32 v74, v74, v69
    v_mov_b32 v68, v66
    v_mov_b32 v69, v74
    s_nop 0
    v_permlane16_swap_b32 v66, v68
    v_permlane16_swap_b32 v74, v69
    v_max_f32 v66, v66, v68
    v_max_f32 v74, v74, v69
    v_mul_f32_e64 v66, v66, -s67
    v_mul_f32_e64 v74, v74, -s67
    v_fma_f32 v64, v64, s67, v66
    v_fma_f32 v65, v65, s67, v66
    v_fma_f32 v72, v72, s67, v74
    v_fma_f32 v73, v73, s67, v74
    v_exp_f32 v64, v64
    v_exp_f32 v65, v65
    v_exp_f32 v72, v72
    v_exp_f32 v73, v73
    v_add_f32 v66, v64, v65
    v_add_f32 v74, v72, v73
    v_mov_b32 v68, v66
    v_mov_b32 v69, v74
    s_nop 0
    v_permlane32_swap_b32 v66, v68
    v_permlane32_swap_b32 v74, v69
    v_add_f32 v66, v66, v68
    v_add_f32 v74, v74, v69
    v_mov_b32 v68, v66
    v_mov_b32 v69, v74
    s_nop 0
    v_permlane16_swap_b32 v66, v68
    v_permlane16_swap_b32 v74, v69
    v_add_f32 v66, v66, v68
    v_add_f32 v74, v74, v69
    v_rcp_f32 v66, v66
    v_rcp_f32 v74, v74
    v_mul_f32 v64, v64, v66
    v_mul_f32 v65, v65, v66
    v_mul_f32 v72, v72, v74
    v_mul_f32 v73, v73, v74
    v_cvt_pk_bf16_f32 v64, v64, v65
    v_cvt_pk_bf16_f32 v72, v72, v73
    v_perm_b32 v80, v64, v64, v28
    v_perm_b32 v81, v64, v64, v29
    v_perm_b32 v82, v64, v64, v30
    v_perm_b32 v83, v64, v64, v31
    v_perm_b32 v84, v72, v72, v28
    v_perm_b32 v85, v72, v72, v29
    v_perm_b32 v86, v72, v72, v30
    v_perm_b32 v87, v72, v72, v31
    ds_read_b64 v[46:47], v39 offset:24
    v_mfma_f32_16x16x32_bf16 v[88:91], v[156:159], v[80:83], 0
    v_mfma_f32_16x16x32_bf16 v[92:95], v[162:165], v[80:83], 0
    v_mfma_f32_16x16x32_bf16 v[96:99], v[162:165], v[84:87], 0
    v_mfma_f32_16x16x32_bf16 v[100:103], v[168:171], v[84:87], 0
    s_waitcnt lgkmcnt(0)
    v_min_u32 v46, v46, v47
    v_cmp_gt_u32 vcc, 3, v46
    s_cbranch_vccz L43
    s_mov_b32 s60, 0
L42:
    ds_read_b64 v[46:47], v39 offset:24
    s_waitcnt lgkmcnt(0)
    v_min_u32 v46, v46, v47
    v_cmp_gt_u32 vcc, 3, v46
    s_cbranch_vccz L43
    s_add_u32 s60, s60, 1
    s_cmp_lt_u32 s60, 3200000
    s_cbranch_scc1 L42
L43:
    ds_read_b64 v[148:149], v33 offset:0
    ds_read_b64 v[150:151], v33 offset:512
    ds_read_b64 v[152:153], v33 offset:1024
    ds_read_b64 v[154:155], v33 offset:1536
    ds_read_b64 v[160:161], v33 offset:2048
    ds_read_b64 v[166:167], v33 offset:2560
    ds_read_b32 v46, v39 offset:32
    v_cvt_pk_bf16_f32 v116, v88, v89
    v_cvt_pk_bf16_f32 v117, v90, v91
    v_cndmask_b32_e64 v92, v96, v92, s[54:55]
    v_cndmask_b32_e64 v93, v97, v93, s[54:55]
    v_cndmask_b32_e64 v94, v98, v94, s[54:55]
    v_cndmask_b32_e64 v95, v99, v95, s[54:55]
    v_cvt_pk_bf16_f32 v118, v92, v93
    v_cvt_pk_bf16_f32 v119, v94, v95
    v_cvt_pk_bf16_f32 v126, v100, v101
    v_cvt_pk_bf16_f32 v127, v102, v103
    v_permlane16_swap_b32 v116, v118
    v_permlane16_swap_b32 v117, v119
    s_waitcnt lgkmcnt(0)
    v_mov_b32_e64 v0, 7
    ds_write_b32 v45, v0
    v_mfma_f32_16x16x32_bf16 v[48:51], v[142:145], v[180:183], 0
    v_mfma_f32_16x16x32_bf16 v[52:55], v[148:151], v[180:183], 0
    v_mfma_f32_16x16x32_bf16 v[56:59], v[144:147], v[184:187], 0
    v_mfma_f32_16x16x32_bf16 v[60:63], v[150:153], v[184:187], 0
    v_readfirstlane_b32 s60, v46
    s_nop 0
    s_cmp_eq_u32 s60, 2
    s_cselect_b32 s6, 1, 0
    s_cselect_b32 s8, 0xff880000, 0
    s_cselect_b32 s9, 0xffb00000, 0
    s_cselect_b32 s10, 0xff380000, 0
    s_add_u32 s8, s8, 0x780000
    s_add_u32 s9, s9, 0xa00000
    s_add_u32 s10, s10, 0xc80000
    s_add_u32 s60, s63, 1
    s_and_b32 s60, s60, 15
    s_cmp_lt_u32 s60, 2
    s_cselect_b32 s5, 1, 0
    s_cselect_b32 s7, 0, s6
    s_cselect_b32 s11, 0xa00000, s9
    buffer_store_dwordx4 v[116:119], v41, s[28:31], 0 offen sc1
    v_cndmask_b32_e64 v64, v48, v49, s[48:49]
    v_cndmask_b32_e64 v65, v50, v51, s[48:49]
    v_cndmask_b32_e64 v66, v52, v53, s[48:49]
    v_cndmask_b32_e64 v67, v54, v55, s[48:49]
    v_cndmask_b32_e64 v72, v56, v57, s[48:49]
    v_cndmask_b32_e64 v73, v58, v59, s[48:49]
    v_cndmask_b32_e64 v74, v60, v61, s[48:49]
    v_cndmask_b32_e64 v75, v62, v63, s[48:49]
    v_min_f32 v66, s66, v66
    v_min_f32 v67, s66, v67
    v_min_f32 v74, s66, v74
    v_min_f32_e64 v75, s66, v75
    v_cndmask_b32_e64 v64, v66, v64, s[50:51]
    v_cndmask_b32_e64 v65, v67, v65, s[52:53]
    v_cndmask_b32_e64 v72, v74, v72, s[50:51]
    v_cndmask_b32_e64 v73, v75, v73, s[52:53]
    v_max_f32 v66, v64, v65
    v_max_f32 v74, v72, v73
    v_mov_b32 v68, v66
    v_mov_b32 v69, v74
    s_nop 0
    v_permlane32_swap_b32 v66, v68
    v_permlane32_swap_b32 v74, v69
    v_max_f32 v66, v66, v68
    v_max_f32 v74, v74, v69
    v_mov_b32 v68, v66
    v_mov_b32 v69, v74
    s_nop 0
    v_permlane16_swap_b32 v66, v68
    v_permlane16_swap_b32 v74, v69
    v_max_f32 v66, v66, v68
    v_max_f32 v74, v74, v69
    v_mul_f32_e64 v66, v66, -s67
    v_mul_f32_e64 v74, v74, -s67
    v_fma_f32 v64, v64, s67, v66
    v_fma_f32 v65, v65, s67, v66
    v_fma_f32 v72, v72, s67, v74
    v_fma_f32 v73, v73, s67, v74
    v_exp_f32 v64, v64
    v_exp_f32 v65, v65
    v_exp_f32 v72, v72
    v_exp_f32 v73, v73
    v_add_f32 v66, v64, v65
    v_add_f32 v74, v72, v73
    v_mov_b32 v68, v66
    v_mov_b32 v69, v74
    s_nop 0
    v_permlane32_swap_b32 v66, v68
    v_permlane32_swap_b32 v74, v69
    v_add_f32 v66, v66, v68
    v_add_f32 v74, v74, v69
    v_mov_b32 v68, v66
    v_mov_b32 v69, v74
    s_nop 0
    v_permlane16_swap_b32 v66, v68
    v_permlane16_swap_b32 v74, v69
    v_add_f32 v66, v66, v68
    v_add_f32 v74, v74, v69
    v_rcp_f32 v66, v66
    v_rcp_f32 v74, v74
    v_mul_f32 v64, v64, v66
    v_mul_f32 v65, v65, v66
    v_mul_f32 v72, v72, v74
    v_mul_f32 v73, v73, v74
    v_cvt_pk_bf16_f32 v64, v64, v65
    v_cvt_pk_bf16_f32 v72, v72, v73
    v_perm_b32 v80, v64, v64, v28
    v_perm_b32 v81, v64, v64, v29
    v_perm_b32 v82, v64, v64, v30
    v_perm_b32 v83, v64, v64, v31
    v_perm_b32 v84, v72, v72, v28
    v_perm_b32 v85, v72, v72, v29
    v_perm_b32 v86, v72, v72, v30
    v_perm_b32 v87, v72, v72, v31
    v_mfma_f32_16x16x32_bf16 v[88:91], v[154:157], v[80:83], 0
    v_mfma_f32_16x16x32_bf16 v[92:95], v[160:163], v[80:83], 0
    v_mfma_f32_16x16x32_bf16 v[96:99], v[160:163], v[84:87], 0
    v_mfma_f32_16x16x32_bf16 v[100:103], v[166:169], v[84:87], 0
    s_nop 4
    v_cvt_pk_bf16_f32 v120, v88, v89
    v_cvt_pk_bf16_f32 v121, v90, v91
    v_cndmask_b32_e64 v92, v96, v92, s[54:55]
    v_cndmask_b32_e64 v93, v97, v93, s[54:55]
    v_cndmask_b32_e64 v94, v98, v94, s[54:55]
    v_cndmask_b32_e64 v95, v99, v95, s[54:55]
    v_cvt_pk_bf16_f32 v122, v92, v93
    v_cvt_pk_bf16_f32 v123, v94, v95
    v_cvt_pk_bf16_f32 v124, v100, v101
    v_cvt_pk_bf16_f32 v125, v102, v103
    v_permlane16_swap_b32 v120, v122
    v_permlane16_swap_b32 v121, v123
    buffer_store_dwordx4 v[120:123], v40, s[28:31], 0 offen sc1
    v_permlane16_swap_b32 v124, v126
    v_permlane16_swap_b32 v125, v127
    buffer_store_dwordx4 v[124:127], v42, s[28:31], 0 offen sc1
    v_mov_b32 v105, v43
    s_mul_i32 s60, s44, 2560
    s_add_u32 s60, s60, s65
    v_add_u32 v40, s60, v36
    v_lshrrev_b32 v48, 1, v6
    v_lshlrev_b32 v48, 8, v48
    v_lshl_add_u32 v48, v5, 4, v48
    s_add_u32 s60, s60, 2048
    v_add_u32 v48, s60, v48
    v_and_b32 v49, 1, v6
    v_cmp_eq_u32 vcc, 0, v49
    v_mov_b32 v49, 0x80000000
    s_nop 0
    v_cndmask_b32_e64 v41, v49, v48, vcc
    s_lshl_b32 s60, s63, 10
    s_lshl_b32 s61, s44, 7
    s_add_u32 s61, s61, s60
    v_lshl_add_u32 v48, v5, 3, s61
    v_cndmask_b32_e64 v42, v49, v48, s[54:55]
    v_lshlrev_b32 v48, 8, v6
    v_lshl_add_u32 v48, v5, 3, v48
    v_add_u32 v43, s60, v48
    s_lshl_b32 s60, s63, 7
    s_lshl_b32 s61, s44, 2
    s_add_u32 s60, s60, s61
    v_mov_b32 v44, s60
    s_lshr_b32 s61, s63, 1
    s_lshl_b32 s60, s61, 7
    s_add_u32 s60, s60, 0x2208000
    v_and_b32 v104, 15, v1
    v_lshl_add_u32 v104, v104, 2, s60
    s_add_u32 s60, s12, 0x500000
    v_add_u32_e64 v48, s60, v2
    s_add_u32 s60, s13, 0x500000
    v_add_u32_e64 v49, s60, v2
    s_add_u32 s60, s14, 0x500000
    v_add_u32_e64 v50, s60, v2
    s_add_u32 s60, s15, 0x500000
    v_add_u32 v51, s60, v2
    s_waitcnt vmcnt(3)
    v_permlane16_swap_b32 v10, v12
    v_permlane16_swap_b32 v11, v13
    v_permlane16_swap_b32 v14, v16
    v_permlane16_swap_b32 v15, v17
    v_permlane16_swap_b32 v18, v20
    v_permlane16_swap_b32 v19, v21
    v_lshlrev_b32_e64 v52, 16, v10
    v_and_b32 v53, 0xffff0000, v10
    v_lshlrev_b32_e64 v54, 16, v11
    v_and_b32 v55, 0xffff0000, v11
    v_lshlrev_b32_e64 v56, 16, v12
    v_and_b32 v57, 0xffff0000, v12
    v_lshlrev_b32_e64 v58, 16, v13
    v_and_b32 v59, 0xffff0000, v13
    v_lshlrev_b32_e64 v60, 16, v14
    v_and_b32 v61, 0xffff0000, v14
    v_lshlrev_b32_e64 v62, 16, v15
    v_and_b32 v63, 0xffff0000, v15
    v_lshlrev_b32_e64 v64, 16, v16
    v_and_b32 v65, 0xffff0000, v16
    v_lshlrev_b32_e64 v66, 16, v17
    v_and_b32 v67, 0xffff0000, v17
    v_lshlrev_b32_e64 v68, 16, v18
    v_and_b32 v69, 0xffff0000, v18
    v_lshlrev_b32_e64 v70, 16, v19
    v_and_b32 v71, 0xffff0000, v19
    s_waitcnt vmcnt(0)
    s_cmp_eq_u32 s6, 0
    s_cbranch_scc1 L44
    s_mov_b64 exec, 1
    buffer_store_dword v3, v105, s[28:31], 0 offen
    s_mov_b64 exec, -1
    s_branch L45
L44:
    s_mov_b64 exec, 1
    buffer_store_dword v3, v105, s[28:31], 0 offen sc1
    s_mov_b64 exec, -1
L45:
    v_add_u32 v105, 0x220c000, v44
    s_mov_b32 s60, 0
    v_not_b32 v0, v3
L46:
    v_mov_b32_e64 v4, v0
    buffer_load_dword v4, v104, s[28:31], 0 offen sc1
    s_mov_b32 s61, 0
L47:
    v_cmp_eq_u32 vcc, v4, v0
    s_cbranch_vccz L48
    s_add_u32 s61, s61, 1
    s_cmp_lt_u32 s61, 200
    s_cbranch_scc1 L47
L48:
    v_cmp_ne_u32 vcc, v4, v3
    s_cbranch_vccz L49
    s_add_u32 s60, s60, 1
    s_cmp_lt_u32 s60, 400000
    s_cbranch_scc1 L46
L49:
    buffer_load_dwordx4 v[112:115], v48, s[28:31], 0 offen offset:0 sc1
    buffer_load_dwordx4 v[116:119], v48, s[28:31], 0 offen offset:1024 sc1
    buffer_load_dwordx4 v[120:123], v48, s[28:31], 0 offen offset:2048 sc1
    buffer_load_dwordx4 v[124:127], v48, s[28:31], 0 offen offset:3072 sc1
    buffer_load_dwordx4 v[128:131], v49, s[28:31], 0 offen offset:0 sc1
    buffer_load_dwordx4 v[132:135], v49, s[28:31], 0 offen offset:1024 sc1
    buffer_load_dwordx4 v[136:139], v49, s[28:31], 0 offen offset:2048 sc1
    buffer_load_dwordx4 v[140:143], v49, s[28:31], 0 offen offset:3072 sc1
    buffer_load_dwordx4 v[144:147], v50, s[28:31], 0 offen offset:0 sc1
    buffer_load_dwordx4 v[148:151], v50, s[28:31], 0 offen offset:1024 sc1
    buffer_load_dwordx4 v[152:155], v50, s[28:31], 0 offen offset:2048 sc1
    s_mov_b32 s60, 0
L50:
    ds_read_b64 v[46:47], v39 offset:16
    s_waitcnt lgkmcnt(0)
    v_min_u32 v46, v46, v47
    v_cmp_gt_u32 vcc, 10, v46
    s_cbranch_vccz L51
    s_add_u32 s60, s60, 1
    s_cmp_lt_u32 s60, 3200000
    s_cbranch_scc1 L50
L51:
    ds_read_b128 a[0:3], v2 offset:0
    ds_read_b128 a[4:7], v2 offset:1024
    ds_read_b128 a[8:11], v2 offset:2048
    ds_read_b128 a[12:15], v2 offset:3072
    ds_read_b128 a[16:19], v2 offset:4096
    ds_read_b128 a[20:23], v2 offset:5120
    ds_read_b128 a[24:27], v2 offset:6144
    ds_read_b128 a[28:31], v2 offset:7168
    ds_read_b128 a[32:35], v2 offset:8192
    ds_read_b128 a[36:39], v2 offset:9216
    v_lshrrev_b32 v110, 3, v1
    v_min_u32 v110, 2, v110
    s_sub_u32 s60, s63, 1
    v_add_u32 v110, s60, v110
    s_and_b32 s60, s63, 0x70
    v_max_i32 v110, s60, v110
    s_or_b32 s60, s60, 15
    v_min_i32 v110, s60, v110
    v_and_b32 v92, 7, v1
    v_lshlrev_b32_e64 v110, 7, v110
    v_lshl_add_u32 v110, v92, 2, v110
    v_add_u32 v110, 0x2210000, v110
    s_lshl_b32 s66, s63, 4
    s_movk_i32 s67, 20480
    v_mov_b32 v92, 0xa00000
    v_mov_b32_e64 v93, s9
    v_mov_b32 v94, 0x80000000
    v_lshlrev_b32 v95, 8, v6
    s_lshr_b32 s60, s77, 13
    s_add_u32 s60, s60, 1
    s_sub_u32 s61, 0, s60
    s_bitcmp1_b32 s77, 12
    s_cselect_b32 s60, s60, s61
    s_add_u32 s60, s60, s66
    v_add_u32 v96, s60, v5
    s_sub_u32 s61, s12, s65
    v_lshrrev_b32 v97, 4, v96
    v_xor_b32 v98, s63, v97
    v_cmp_lt_u32 vcc, 15, v98
    v_mul_lo_u32 v97, v97, s67
    v_and_b32_e64 v99, 15, v96
    v_cndmask_b32_e64 v98, v93, v92, vcc
    v_lshl_add_u32 v97, v99, 4, v97
    v_cmp_gt_u32 vcc, 2048, v96
    v_add3_u32 v97, v97, v98, v95
    v_add_u32_e64 v97, s61, v97
    v_cndmask_b32_e64 v106, v94, v97, vcc
    s_lshr_b32 s60, s78, 13
    s_add_u32 s60, s60, 1
    s_sub_u32 s61, 0, s60
    s_bitcmp1_b32 s78, 12
    s_cselect_b32 s60, s60, s61
    s_add_u32 s60, s60, s66
    v_add_u32 v96, s60, v5
    s_sub_u32 s61, s13, s65
    v_lshrrev_b32 v97, 4, v96
    v_xor_b32 v98, s63, v97
    v_cmp_lt_u32 vcc, 15, v98
    v_mul_lo_u32 v97, v97, s67
    v_and_b32 v99, 15, v96
    v_cndmask_b32_e64 v98, v93, v92, vcc
    v_lshl_add_u32 v97, v99, 4, v97
    v_cmp_gt_u32 vcc, 2048, v96
    v_add3_u32 v97, v97, v98, v95
    v_add_u32_e64 v97, s61, v97
    v_cndmask_b32_e64 v107, v94, v97, vcc
    s_lshr_b32 s60, s79, 13
    s_add_u32 s60, s60, 1
    s_sub_u32 s61, 0, s60
    s_bitcmp1_b32 s79, 12
    s_cselect_b32 s60, s60, s61
    s_add_u32 s60, s60, s66
    v_add_u32 v96, s60, v5
    s_sub_u32 s61, s14, s65
    v_lshrrev_b32 v97, 4, v96
    v_xor_b32 v98, s63, v97
    v_cmp_lt_u32 vcc, 15, v98
    v_mul_lo_u32 v97, v97, s67
    v_and_b32 v99, 15, v96
    v_cndmask_b32_e64 v98, v93, v92, vcc
    v_lshl_add_u32 v97, v99, 4, v97
    v_cmp_gt_u32 vcc, 2048, v96
    v_add3_u32 v97, v97, v98, v95
    v_add_u32_e64 v97, s61, v97
    v_cndmask_b32_e64 v108, v94, v97, vcc
    s_lshr_b32 s60, s80, 13
    s_add_u32 s60, s60, 1
    s_sub_u32 s61, 0, s60
    s_bitcmp1_b32 s80, 12
    s_cselect_b32 s60, s60, s61
    s_add_u32 s60, s60, s66
    v_add_u32 v96, s60, v5
    s_sub_u32 s61, s15, s65
    v_lshrrev_b32 v97, 4, v96
    v_xor_b32 v98, s63, v97
    v_cmp_lt_u32 vcc, 15, v98
    v_mul_lo_u32 v97, v97, s67
    v_and_b32 v99, 15, v96
    v_cndmask_b32_e64 v98, v93, v92, vcc
    v_lshl_add_u32 v97, v99, 4, v97
    v_cmp_gt_u32 vcc, 2048, v96
    v_add3_u32 v97, v97, v98, v95
    v_add_u32_e64 v97, s61, v97
    v_cndmask_b32_e64 v109, v94, v97, vcc
    s_waitcnt vmcnt(10) lgkmcnt(5)
    v_mfma_f32_16x16x32_bf16 v[52:55], a[0:3], v[112:115], v[52:55]
    ds_read_b128 a[40:43], v2 offset:10240
    buffer_load_dwordx4 v[156:159], v50, s[28:31], 0 offen offset:3072 sc1
    v_mfma_f32_16x16x32_bf16 v[56:59], a[4:7], v[112:115], v[56:59]
    ds_read_b128 a[44:47], v2 offset:11264
    v_mfma_f32_16x16x32_bf16 v[60:63], a[8:11], v[112:115], v[60:63]
    ds_read_b128 a[48:51], v2 offset:12288
    buffer_load_dwordx4 v[160:163], v51, s[28:31], 0 offen offset:0 sc1
    v_mfma_f32_16x16x32_bf16 v[64:67], a[12:15], v[112:115], v[64:67]
    ds_read_b128 a[52:55], v2 offset:13312
    v_mfma_f32_16x16x32_bf16 v[68:71], a[16:19], v[112:115], v[68:71]
    ds_read_b128 a[56:59], v2 offset:14336
    s_waitcnt vmcnt(11) lgkmcnt(5)
    v_mfma_f32_16x16x32_bf16 v[52:55], a[20:23], v[116:119], v[52:55]
    ds_read_b128 a[0:3], v2 offset:15360
    buffer_load_dwordx4 v[164:167], v51, s[28:31], 0 offen offset:1024 sc1
    v_mfma_f32_16x16x32_bf16 v[56:59], a[24:27], v[116:119], v[56:59]
    ds_read_b128 a[4:7], v2 offset:16384
    v_mfma_f32_16x16x32_bf16 v[60:63], a[28:31], v[116:119], v[60:63]
    ds_read_b128 a[8:11], v2 offset:17408
    buffer_load_dwordx4 v[168:171], v51, s[28:31], 0 offen offset:2048 sc1
    v_mfma_f32_16x16x32_bf16 v[64:67], a[32:35], v[116:119], v[64:67]
    ds_read_b128 a[12:15], v2 offset:18432
    v_mfma_f32_16x16x32_bf16 v[68:71], a[36:39], v[116:119], v[68:71]
    ds_read_b128 a[16:19], v2 offset:19456
    s_waitcnt vmcnt(12) lgkmcnt(5)
    v_mfma_f32_16x16x32_bf16 v[52:55], a[40:43], v[120:123], v[52:55]
    ds_read_b128 a[20:23], v2 offset:20480
    buffer_load_dwordx4 v[172:175], v51, s[28:31], 0 offen offset:3072 sc1
    v_mfma_f32_16x16x32_bf16 v[56:59], a[44:47], v[120:123], v[56:59]
    ds_read_b128 a[24:27], v2 offset:21504
    v_mfma_f32_16x16x32_bf16 v[60:63], a[48:51], v[120:123], v[60:63]
    ds_read_b128 a[28:31], v2 offset:22528
    buffer_load_dwordx4 v[176:179], v48, s[28:31], s76 offen offset:0 sc1
    v_mfma_f32_16x16x32_bf16 v[64:67], a[52:55], v[120:123], v[64:67]
    ds_read_b128 a[32:35], v2 offset:23552
    v_mfma_f32_16x16x32_bf16 v[68:71], a[56:59], v[120:123], v[68:71]
    ds_read_b128 a[36:39], v2 offset:24576
    s_waitcnt vmcnt(13) lgkmcnt(5)
    v_mfma_f32_16x16x32_bf16 v[52:55], a[0:3], v[124:127], v[52:55]
    ds_read_b128 a[40:43], v2 offset:25600
    buffer_load_dwordx4 v[180:183], v49, s[28:31], s76 offen offset:0 sc1
    v_mfma_f32_16x16x32_bf16 v[56:59], a[4:7], v[124:127], v[56:59]
    ds_read_b128 a[44:47], v2 offset:26624
    v_mfma_f32_16x16x32_bf16 v[60:63], a[8:11], v[124:127], v[60:63]
    ds_read_b128 a[48:51], v2 offset:27648
    buffer_load_dwordx4 v[184:187], v50, s[28:31], s76 offen offset:0 sc1
    v_mov_b32_e64 v0, 8
    ds_write_b32 v45, v0
    v_mfma_f32_16x16x32_bf16 v[64:67], a[12:15], v[124:127], v[64:67]
    ds_read_b128 a[52:55], v2 offset:28672
    v_mfma_f32_16x16x32_bf16 v[68:71], a[16:19], v[124:127], v[68:71]
    ds_read_b128 a[56:59], v2 offset:29696
    s_waitcnt vmcnt(14) lgkmcnt(6)
    v_mfma_f32_16x16x32_bf16 v[52:55], a[20:23], v[128:131], v[52:55]
    ds_read_b128 a[0:3], v2 offset:30720
    buffer_load_dwordx4 v[188:191], v51, s[28:31], s76 offen offset:0 sc1
    v_mfma_f32_16x16x32_bf16 v[56:59], a[24:27], v[128:131], v[56:59]
    ds_read_b128 a[4:7], v2 offset:31744
    v_mfma_f32_16x16x32_bf16 v[60:63], a[28:31], v[128:131], v[60:63]
    ds_read_b128 a[8:11], v2 offset:32768
    v_mfma_f32_16x16x32_bf16 v[64:67], a[32:35], v[128:131], v[64:67]
    ds_read_b128 a[12:15], v2 offset:33792
    v_mfma_f32_16x16x32_bf16 v[68:71], a[36:39], v[128:131], v[68:71]
    ds_read_b128 a[16:19], v2 offset:34816
    s_waitcnt vmcnt(14) lgkmcnt(5)
    v_mfma_f32_16x16x32_bf16 v[52:55], a[40:43], v[132:135], v[52:55]
    ds_read_b128 a[20:23], v2 offset:35840
    v_mfma_f32_16x16x32_bf16 v[56:59], a[44:47], v[132:135], v[56:59]
    ds_read_b128 a[24:27], v2 offset:36864
    v_mfma_f32_16x16x32_bf16 v[60:63], a[48:51], v[132:135], v[60:63]
    ds_read_b128 a[28:31], v2 offset:37888
    v_mfma_f32_16x16x32_bf16 v[64:67], a[52:55], v[132:135], v[64:67]
    ds_read_b128 a[32:35], v2 offset:38912
    v_mfma_f32_16x16x32_bf16 v[68:71], a[56:59], v[132:135], v[68:71]
    ds_read_b128 a[36:39], v2 offset:39936
    s_waitcnt vmcnt(13) lgkmcnt(5)
    v_mfma_f32_16x16x32_bf16 v[52:55], a[0:3], v[136:139], v[52:55]
    ds_read_b128 a[40:43], v2 offset:61440
    v_mfma_f32_16x16x32_bf16 v[56:59], a[4:7], v[136:139], v[56:59]
    ds_read_b128 a[44:47], v2 offset:62464
    v_mfma_f32_16x16x32_bf16 v[60:63], a[8:11], v[136:139], v[60:63]
    ds_read_b128 a[48:51], v2 offset:63488
    v_mfma_f32_16x16x32_bf16 v[64:67], a[12:15], v[136:139], v[64:67]
    ds_read_b128 a[52:55], v2 offset:64512
    v_mfma_f32_16x16x32_bf16 v[68:71], a[16:19], v[136:139], v[68:71]
    ds_read_b128 a[56:59], v7 offset:0
    s_waitcnt vmcnt(12) lgkmcnt(5)
    v_mfma_f32_16x16x32_bf16 v[52:55], a[20:23], v[140:143], v[52:55]
    ds_read_b128 a[0:3], v7 offset:1024
    v_mfma_f32_16x16x32_bf16 v[56:59], a[24:27], v[140:143], v[56:59]
    ds_read_b128 a[4:7], v7 offset:2048
    v_mfma_f32_16x16x32_bf16 v[60:63], a[28:31], v[140:143], v[60:63]
    ds_read_b128 a[8:11], v7 offset:3072
    v_mfma_f32_16x16x32_bf16 v[64:67], a[32:35], v[140:143], v[64:67]
    ds_read_b128 a[12:15], v7 offset:4096
    v_mfma_f32_16x16x32_bf16 v[68:71], a[36:39], v[140:143], v[68:71]
    ds_read_b128 a[16:19], v7 offset:5120
    s_waitcnt vmcnt(11) lgkmcnt(5)
    v_mfma_f32_16x16x32_bf16 v[52:55], a[40:43], v[144:147], v[52:55]
    ds_read_b128 a[20:23], v7 offset:6144
    v_mfma_f32_16x16x32_bf16 v[56:59], a[44:47], v[144:147], v[56:59]
    ds_read_b128 a[24:27], v7 offset:7168
    v_mfma_f32_16x16x32_bf16 v[60:63], a[48:51], v[144:147], v[60:63]
    ds_read_b128 a[28:31], v7 offset:8192
    v_mfma_f32_16x16x32_bf16 v[64:67], a[52:55], v[144:147], v[64:67]
    ds_read_b128 a[32:35], v7 offset:9216
    v_mfma_f32_16x16x32_bf16 v[68:71], a[56:59], v[144:147], v[68:71]
    ds_read_b128 a[36:39], v7 offset:10240
    s_waitcnt vmcnt(10) lgkmcnt(5)
    v_mfma_f32_16x16x32_bf16 v[52:55], a[0:3], v[148:151], v[52:55]
    ds_read_b128 a[40:43], v7 offset:11264
    v_mfma_f32_16x16x32_bf16 v[56:59], a[4:7], v[148:151], v[56:59]
    ds_read_b128 a[44:47], v7 offset:12288
    v_mfma_f32_16x16x32_bf16 v[60:63], a[8:11], v[148:151], v[60:63]
    ds_read_b128 a[48:51], v7 offset:13312
    v_mfma_f32_16x16x32_bf16 v[64:67], a[12:15], v[148:151], v[64:67]
    ds_read_b128 a[52:55], v7 offset:14336
    v_mfma_f32_16x16x32_bf16 v[68:71], a[16:19], v[148:151], v[68:71]
    ds_read_b128 a[56:59], v7 offset:15360
    s_waitcnt vmcnt(9) lgkmcnt(5)
    v_mfma_f32_16x16x32_bf16 v[52:55], a[20:23], v[152:155], v[52:55]
    ds_read_b128 a[0:3], v7 offset:16384
    v_mfma_f32_16x16x32_bf16 v[56:59], a[24:27], v[152:155], v[56:59]
    ds_read_b128 a[4:7], v7 offset:17408
    v_mfma_f32_16x16x32_bf16 v[60:63], a[28:31], v[152:155], v[60:63]
    ds_read_b128 a[8:11], v7 offset:18432
    v_mfma_f32_16x16x32_bf16 v[64:67], a[32:35], v[152:155], v[64:67]
    ds_read_b128 a[12:15], v7 offset:19456
    v_mfma_f32_16x16x32_bf16 v[68:71], a[36:39], v[152:155], v[68:71]
    ds_read_b128 a[16:19], v7 offset:20480
    s_waitcnt vmcnt(8) lgkmcnt(5)
    v_mfma_f32_16x16x32_bf16 v[52:55], a[40:43], v[156:159], v[52:55]
    ds_read_b128 a[20:23], v7 offset:21504
    v_mfma_f32_16x16x32_bf16 v[56:59], a[44:47], v[156:159], v[56:59]
    ds_read_b128 a[24:27], v7 offset:22528
    v_mfma_f32_16x16x32_bf16 v[60:63], a[48:51], v[156:159], v[60:63]
    ds_read_b128 a[28:31], v7 offset:23552
    v_mfma_f32_16x16x32_bf16 v[64:67], a[52:55], v[156:159], v[64:67]
    ds_read_b128 a[32:35], v7 offset:24576
    v_mfma_f32_16x16x32_bf16 v[68:71], a[56:59], v[156:159], v[68:71]
    ds_read_b128 a[36:39], v7 offset:25600
    s_waitcnt vmcnt(7) lgkmcnt(5)
    v_mfma_f32_16x16x32_bf16 v[52:55], a[0:3], v[160:163], v[52:55]
    ds_read_b128 a[40:43], v7 offset:26624
    v_mfma_f32_16x16x32_bf16 v[56:59], a[4:7], v[160:163], v[56:59]
    ds_read_b128 a[44:47], v7 offset:27648
    v_mfma_f32_16x16x32_bf16 v[60:63], a[8:11], v[160:163], v[60:63]
    ds_read_b128 a[48:51], v7 offset:28672
    v_mfma_f32_16x16x32_bf16 v[64:67], a[12:15], v[160:163], v[64:67]
    ds_read_b128 a[52:55], v7 offset:29696
    v_mfma_f32_16x16x32_bf16 v[68:71], a[16:19], v[160:163], v[68:71]
    ds_read_b128 a[56:59], v7 offset:30720
    s_waitcnt vmcnt(6) lgkmcnt(5)
    v_mfma_f32_16x16x32_bf16 v[52:55], a[20:23], v[164:167], v[52:55]
    ds_read_b128 a[0:3], v7 offset:31744
    v_mfma_f32_16x16x32_bf16 v[56:59], a[24:27], v[164:167], v[56:59]
    ds_read_b128 a[4:7], v7 offset:32768
    v_mfma_f32_16x16x32_bf16 v[60:63], a[28:31], v[164:167], v[60:63]
    ds_read_b128 a[8:11], v7 offset:33792
    v_mfma_f32_16x16x32_bf16 v[64:67], a[32:35], v[164:167], v[64:67]
    ds_read_b128 a[12:15], v7 offset:34816
    v_mfma_f32_16x16x32_bf16 v[68:71], a[36:39], v[164:167], v[68:71]
    ds_read_b128 a[16:19], v7 offset:35840
    s_waitcnt vmcnt(5) lgkmcnt(5)
    v_mfma_f32_16x16x32_bf16 v[52:55], a[40:43], v[168:171], v[52:55]
    ds_read_b128 a[20:23], v2 offset:40960
    v_mfma_f32_16x16x32_bf16 v[56:59], a[44:47], v[168:171], v[56:59]
    ds_read_b128 a[24:27], v2 offset:41984
    v_mfma_f32_16x16x32_bf16 v[60:63], a[48:51], v[168:171], v[60:63]
    ds_read_b128 a[28:31], v2 offset:43008
    v_mfma_f32_16x16x32_bf16 v[64:67], a[52:55], v[168:171], v[64:67]
    ds_read_b128 a[32:35], v2 offset:44032
    v_mfma_f32_16x16x32_bf16 v[68:71], a[56:59], v[168:171], v[68:71]
    ds_read_b128 a[36:39], v2 offset:45056
    s_waitcnt vmcnt(4) lgkmcnt(5)
    v_mfma_f32_16x16x32_bf16 v[52:55], a[0:3], v[172:175], v[52:55]
    ds_read_b128 a[40:43], v2 offset:46080
    v_mfma_f32_16x16x32_bf16 v[56:59], a[4:7], v[172:175], v[56:59]
    ds_read_b128 a[44:47], v2 offset:47104
    v_mfma_f32_16x16x32_bf16 v[60:63], a[8:11], v[172:175], v[60:63]
    ds_read_b128 a[48:51], v2 offset:48128
    v_mfma_f32_16x16x32_bf16 v[64:67], a[12:15], v[172:175], v[64:67]
    ds_read_b128 a[52:55], v2 offset:49152
    v_mfma_f32_16x16x32_bf16 v[68:71], a[16:19], v[172:175], v[68:71]
    ds_read_b128 a[56:59], v2 offset:50176
    s_waitcnt vmcnt(3) lgkmcnt(5)
    v_mfma_f32_16x16x32_bf16 v[52:55], a[20:23], v[176:179], v[52:55]
    ds_read_b128 a[0:3], v2 offset:51200
    v_mfma_f32_16x16x32_bf16 v[56:59], a[24:27], v[176:179], v[56:59]
    ds_read_b128 a[4:7], v2 offset:52224
    v_mfma_f32_16x16x32_bf16 v[60:63], a[28:31], v[176:179], v[60:63]
    ds_read_b128 a[8:11], v2 offset:53248
    v_mfma_f32_16x16x32_bf16 v[64:67], a[32:35], v[176:179], v[64:67]
    ds_read_b128 a[12:15], v2 offset:54272
    v_mfma_f32_16x16x32_bf16 v[68:71], a[36:39], v[176:179], v[68:71]
    ds_read_b128 a[16:19], v2 offset:55296
    s_waitcnt vmcnt(2) lgkmcnt(5)
    v_mfma_f32_16x16x32_bf16 v[52:55], a[40:43], v[180:183], v[52:55]
    ds_read_b128 a[20:23], v2 offset:56320
    v_mfma_f32_16x16x32_bf16 v[56:59], a[44:47], v[180:183], v[56:59]
    ds_read_b128 a[24:27], v2 offset:57344
    v_mfma_f32_16x16x32_bf16 v[60:63], a[48:51], v[180:183], v[60:63]
    ds_read_b128 a[28:31], v2 offset:58368
    v_mfma_f32_16x16x32_bf16 v[64:67], a[52:55], v[180:183], v[64:67]
    ds_read_b128 a[32:35], v2 offset:59392
    v_mfma_f32_16x16x32_bf16 v[68:71], a[56:59], v[180:183], v[68:71]
    ds_read_b128 a[36:39], v2 offset:60416
    s_waitcnt vmcnt(1) lgkmcnt(5)
    v_mfma_f32_16x16x32_bf16 v[52:55], a[0:3], v[184:187], v[52:55]
    v_mfma_f32_16x16x32_bf16 v[56:59], a[4:7], v[184:187], v[56:59]
    v_mfma_f32_16x16x32_bf16 v[60:63], a[8:11], v[184:187], v[60:63]
    v_mfma_f32_16x16x32_bf16 v[64:67], a[12:15], v[184:187], v[64:67]
    v_mfma_f32_16x16x32_bf16 v[68:71], a[16:19], v[184:187], v[68:71]
    s_waitcnt vmcnt(0) lgkmcnt(0)
    v_mfma_f32_16x16x32_bf16 v[52:55], a[20:23], v[188:191], v[52:55]
    v_mfma_f32_16x16x32_bf16 v[56:59], a[24:27], v[188:191], v[56:59]
    v_mfma_f32_16x16x32_bf16 v[60:63], a[28:31], v[188:191], v[60:63]
    v_mfma_f32_16x16x32_bf16 v[64:67], a[32:35], v[188:191], v[64:67]
    v_mfma_f32_16x16x32_bf16 v[68:71], a[36:39], v[188:191], v[68:71]
    v_mov_b32_e64 v0, 9
    ds_write_b32 v45, v0
    s_nop 1
    v_cvt_pk_bf16_f32 v10, v52, v53
    v_cvt_pk_bf16_f32 v11, v54, v55
    v_cvt_pk_bf16_f32 v12, v56, v57
    v_cvt_pk_bf16_f32 v13, v58, v59
    v_cvt_pk_bf16_f32 v14, v60, v61
    v_cvt_pk_bf16_f32 v15, v62, v63
    v_cvt_pk_bf16_f32 v16, v64, v65
    v_cvt_pk_bf16_f32 v17, v66, v67
    v_cvt_pk_bf16_f32 v18, v68, v69
    v_cvt_pk_bf16_f32 v19, v70, v71
    s_mov_b32 s61, 0x3f803f80
    v_mov_b32 v84, 0
    v_mov_b32 v85, 0
    v_mov_b32 v86, 0
    v_mov_b32 v87, 0
    v_dot2c_f32_bf16 v84, s61, v10
    v_dot2c_f32_bf16 v86, v10, v10
    v_dot2c_f32_bf16 v85, s61, v11
    v_dot2c_f32_bf16 v87, v11, v11
    v_dot2c_f32_bf16 v84, s61, v12
    v_dot2c_f32_bf16 v86, v12, v12
    v_dot2c_f32_bf16 v85, s61, v13
    v_dot2c_f32_bf16 v87, v13, v13
    v_dot2c_f32_bf16 v84, s61, v14
    v_dot2c_f32_bf16 v86, v14, v14
    v_dot2c_f32_bf16 v85, s61, v15
    v_dot2c_f32_bf16 v87, v15, v15
    v_dot2c_f32_bf16 v84, s61, v16
    v_dot2c_f32_bf16 v86, v16, v16
    v_dot2c_f32_bf16 v85, s61, v17
    v_dot2c_f32_bf16 v87, v17, v17
    v_dot2c_f32_bf16 v84, s61, v18
    v_dot2c_f32_bf16 v86, v18, v18
    v_dot2c_f32_bf16 v85, s61, v19
    v_dot2c_f32_bf16 v87, v19, v19
    s_cmp_eq_u32 s6, 0
    s_cbranch_scc1 L52
    v_permlane16_swap_b32 v10, v12
    v_permlane16_swap_b32 v11, v13
    buffer_store_dwordx4 v[10:13], v40, s[28:31], s8 offen
    v_permlane16_swap_b32 v14, v16
    v_permlane16_swap_b32 v15, v17
    buffer_store_dwordx4 v[14:17], v40, s[28:31], s8 offen offset:1024
    v_permlane16_swap_b32 v18, v20
    v_permlane16_swap_b32 v19, v21
    buffer_store_dwordx4 v[18:21], v41, s[28:31], s8 offen
    v_add_f32 v84, v84, v85
    v_add_f32 v85, v86, v87
    v_mov_b32 v86, v84
    v_mov_b32 v87, v85
    s_nop 0
    v_permlane32_swap_b32 v84, v86
    v_permlane32_swap_b32 v85, v87
    v_add_f32 v84, v84, v86
    v_add_f32 v85, v85, v87
    v_mov_b32 v86, v84
    v_mov_b32 v87, v85
    s_nop 0
    v_permlane16_swap_b32 v84, v86
    v_permlane16_swap_b32 v85, v87
    v_add_f32 v84, v84, v86
    v_add_f32_e64 v85, v85, v87
    s_mov_b32 s60, 0x2100000
    buffer_store_dwordx2 v[84:85], v42, s[28:31], s60 offen
    s_branch L53
L52:
    v_permlane16_swap_b32 v10, v12
    v_permlane16_swap_b32 v11, v13
    buffer_store_dwordx4 v[10:13], v40, s[28:31], s8 offen sc1
    v_permlane16_swap_b32 v14, v16
    v_permlane16_swap_b32 v15, v17
    buffer_store_dwordx4 v[14:17], v40, s[28:31], s8 offen offset:1024 sc1
    v_permlane16_swap_b32 v18, v20
    v_permlane16_swap_b32 v19, v21
    buffer_store_dwordx4 v[18:21], v41, s[28:31], s8 offen sc1
    v_add_f32 v84, v84, v85
    v_add_f32 v85, v86, v87
    v_mov_b32 v86, v84
    v_mov_b32 v87, v85
    s_nop 0
    v_permlane32_swap_b32 v84, v86
    v_permlane32_swap_b32 v85, v87
    v_add_f32 v84, v84, v86
    v_add_f32 v85, v85, v87
    v_mov_b32 v86, v84
    v_mov_b32 v87, v85
    s_nop 0
    v_permlane16_swap_b32 v84, v86
    v_permlane16_swap_b32 v85, v87
    v_add_f32 v84, v84, v86
    v_add_f32_e64 v85, v85, v87
    s_mov_b32 s60, 0x2100000
    buffer_store_dwordx2 v[84:85], v42, s[28:31], s60 offen sc1
L53:
    s_lshl_b32 s60, s63, 7
    s_add_u32 s60, s60, 0x220c000
    v_and_b32 v104, 7, v1
    v_lshl_add_u32 v104, v104, 2, s60
    s_add_u32 s60, s12, s8
    v_add_u32 v48, s60, v2
    s_add_u32 s60, s13, s8
    v_add_u32 v49, s60, v2
    s_add_u32 s60, s14, s8
    v_add_u32 v50, s60, v2
    s_add_u32 s60, s15, s8
    v_add_u32 v51, s60, v2
    v_lshlrev_b32_e64 v111, 4, v6
    v_add_u32 v111, 162880, v111
    s_mov_b32 s62, 0x2100000
    s_waitcnt vmcnt(0)
    s_cmp_eq_u32 s6, 0
    s_cbranch_scc1 L54
    s_mov_b64 exec, 1
    buffer_store_dword v3, v105, s[28:31], 0 offen
    s_mov_b64 exec, -1
    s_branch L55
L54:
    s_mov_b64 exec, 1
    buffer_store_dword v3, v105, s[28:31], 0 offen sc1
    s_mov_b64 exec, -1
L55:
    v_add_u32 v105, 0x2210000, v44
    s_mov_b32 s60, 0
    v_not_b32 v0, v3
L56:
    v_mov_b32_e64 v4, v0
    buffer_load_dword v4, v104, s[28:31], 0 offen sc1
    s_mov_b32 s61, 0
L57:
    v_cmp_eq_u32 vcc, v4, v0
    s_cbranch_vccz L58
    s_add_u32 s61, s61, 1
    s_cmp_lt_u32 s61, 200
    s_cbranch_scc1 L57
L58:
    v_cmp_ne_u32 vcc, v4, v3
    s_cbranch_vccz L59
    s_add_u32 s60, s60, 1
    s_cmp_lt_u32 s60, 400000
    s_cbranch_scc1 L56
L59:
    buffer_load_dwordx2 v[72:73], v43, s[28:31], s62 offen sc1
    buffer_load_dwordx2 v[74:75], v43, s[28:31], s62 offen offset:128 sc1
    buffer_load_dwordx4 v[112:115], v48, s[28:31], 0 offen offset:0 sc1
    buffer_load_dwordx4 v[116:119], v48, s[28:31], 0 offen offset:1024 sc1
    buffer_load_dwordx4 v[120:123], v48, s[28:31], 0 offen offset:2048 sc1
    buffer_load_dwordx4 v[124:127], v48, s[28:31], 0 offen offset:3072 sc1
    buffer_load_dwordx4 v[128:131], v49, s[28:31], 0 offen offset:0 sc1
    buffer_load_dwordx4 v[132:135], v49, s[28:31], 0 offen offset:1024 sc1
    buffer_load_dwordx4 v[136:139], v49, s[28:31], 0 offen offset:2048 sc1
    buffer_load_dwordx4 v[140:143], v49, s[28:31], 0 offen offset:3072 sc1
    buffer_load_dwordx4 v[144:147], v50, s[28:31], 0 offen offset:0 sc1
    buffer_load_dwordx4 v[148:151], v50, s[28:31], 0 offen offset:1024 sc1
    buffer_load_dwordx4 v[152:155], v50, s[28:31], 0 offen offset:2048 sc1
    s_mov_b32 s60, 0
L60:
    ds_read_b64 v[46:47], v39 offset:16
    s_waitcnt lgkmcnt(0)
    v_min_u32 v46, v46, v47
    v_cmp_gt_u32 vcc, 14, v46
    s_cbranch_vccz L61
    s_add_u32 s60, s60, 1
    s_cmp_lt_u32 s60, 3200000
    s_cbranch_scc1 L60
L61:
    ds_read_b128 a[0:3], v7 offset:36864
    ds_read_b128 a[4:7], v7 offset:37888
    ds_read_b128 a[8:11], v7 offset:38912
    ds_read_b128 a[12:15], v7 offset:39936
    ds_read_b128 a[16:19], v7 offset:40960
    ds_read_b128 a[20:23], v7 offset:41984
    ds_read_b128 a[24:27], v7 offset:43008
    ds_read_b128 a[28:31], v7 offset:44032
    ds_read_b128 a[32:35], v7 offset:45056
    ds_read_b128 a[36:39], v7 offset:46080
    s_waitcnt vmcnt(10) lgkmcnt(5)
    v_mfma_f32_16x16x32_bf16 v[52:55], a[0:3], v[112:115], 0
    ds_read_b128 a[40:43], v7 offset:47104
    buffer_load_dwordx4 v[156:159], v50, s[28:31], 0 offen offset:3072 sc1
    v_mfma_f32_16x16x32_bf16 v[56:59], a[4:7], v[112:115], 0
    ds_read_b128 a[44:47], v7 offset:48128
    v_mfma_f32_16x16x32_bf16 v[60:63], a[8:11], v[112:115], 0
    ds_read_b128 a[48:51], v7 offset:49152
    buffer_load_dwordx4 v[160:163], v51, s[28:31], 0 offen offset:0 sc1
    v_mfma_f32_16x16x32_bf16 v[64:67], a[12:15], v[112:115], 0
    ds_read_b128 a[52:55], v7 offset:50176
    v_mfma_f32_16x16x32_bf16 v[68:71], a[16:19], v[112:115], 0
    ds_read_b128 a[56:59], v7 offset:51200
    s_waitcnt vmcnt(11) lgkmcnt(5)
    v_mfma_f32_16x16x32_bf16 v[52:55], a[20:23], v[116:119], v[52:55]
    ds_read_b128 a[0:3], v7 offset:52224
    buffer_load_dwordx4 v[164:167], v51, s[28:31], 0 offen offset:1024 sc1
    v_mfma_f32_16x16x32_bf16 v[56:59], a[24:27], v[116:119], v[56:59]
    ds_read_b128 a[4:7], v7 offset:53248
    v_add_f32_e64 v72, v72, v74
    v_mfma_f32_16x16x32_bf16 v[60:63], a[28:31], v[116:119], v[60:63]
    ds_read_b128 a[8:11], v7 offset:54272
    buffer_load_dwordx4 v[168:171], v51, s[28:31], 0 offen offset:2048 sc1
    v_mfma_f32_16x16x32_bf16 v[64:67], a[32:35], v[116:119], v[64:67]
    ds_read_b128 a[12:15], v7 offset:55296
    v_add_f32_e64 v73, v73, v75
    v_mfma_f32_16x16x32_bf16 v[68:71], a[36:39], v[116:119], v[68:71]
    ds_read_b128 a[16:19], v7 offset:56320
    v_mov_b32 v74, v72
    s_waitcnt vmcnt(12) lgkmcnt(5)
    v_mfma_f32_16x16x32_bf16 v[52:55], a[40:43], v[120:123], v[52:55]
    ds_read_b128 a[20:23], v2 offset:40960
    buffer_load_dwordx4 v[172:175], v51, s[28:31], 0 offen offset:3072 sc1
    v_mfma_f32_16x16x32_bf16 v[56:59], a[44:47], v[120:123], v[56:59]
    ds_read_b128 a[24:27], v2 offset:41984
    v_mov_b32_e64 v75, v73
    v_mfma_f32_16x16x32_bf16 v[60:63], a[48:51], v[120:123], v[60:63]
    ds_read_b128 a[28:31], v2 offset:43008
    buffer_load_dwordx4 v[176:179], v48, s[28:31], s76 offen offset:0 sc1
    v_mfma_f32_16x16x32_bf16 v[64:67], a[52:55], v[120:123], v[64:67]
    ds_read_b128 a[32:35], v2 offset:44032
    v_permlane32_swap_b32 v72, v74
    v_mfma_f32_16x16x32_bf16 v[68:71], a[56:59], v[120:123], v[68:71]
    ds_read_b128 a[36:39], v2 offset:45056
    v_permlane32_swap_b32 v73, v75
    s_waitcnt vmcnt(13) lgkmcnt(5)
    v_mfma_f32_16x16x32_bf16 v[52:55], a[0:3], v[124:127], v[52:55]
    ds_read_b128 a[40:43], v2 offset:46080
    buffer_load_dwordx4 v[180:183], v49, s[28:31], s76 offen offset:0 sc1
    v_mfma_f32_16x16x32_bf16 v[56:59], a[4:7], v[124:127], v[56:59]
    ds_read_b128 a[44:47], v2 offset:47104
    v_add_f32 v72, v72, v74
    v_mfma_f32_16x16x32_bf16 v[60:63], a[8:11], v[124:127], v[60:63]
    ds_read_b128 a[48:51], v2 offset:48128
    buffer_load_dwordx4 v[184:187], v50, s[28:31], s76 offen offset:0 sc1
    v_mov_b32_e64 v0, 10
    ds_write_b32 v45, v0
    v_mfma_f32_16x16x32_bf16 v[64:67], a[12:15], v[124:127], v[64:67]
    ds_read_b128 a[52:55], v2 offset:49152
    v_add_f32_e64 v73, v73, v75
    v_mfma_f32_16x16x32_bf16 v[68:71], a[16:19], v[124:127], v[68:71]
    ds_read_b128 a[56:59], v2 offset:50176
    v_mov_b32 v74, v72
    s_waitcnt vmcnt(14) lgkmcnt(6)
    v_mfma_f32_16x16x32_bf16 v[52:55], a[20:23], v[128:131], v[52:55]
    ds_read_b128 a[0:3], v2 offset:51200
    buffer_load_dwordx4 v[188:191], v51, s[28:31], s76 offen offset:0 sc1
    v_mfma_f32_16x16x32_bf16 v[56:59], a[24:27], v[128:131], v[56:59]
    ds_read_b128 a[4:7], v2 offset:52224
    v_mov_b32_e64 v75, v73
    v_mfma_f32_16x16x32_bf16 v[60:63], a[28:31], v[128:131], v[60:63]
    ds_read_b128 a[8:11], v2 offset:53248
    v_permlane16_swap_b32 v72, v74
    v_mfma_f32_16x16x32_bf16 v[64:67], a[32:35], v[128:131], v[64:67]
    ds_read_b128 a[12:15], v2 offset:54272
    v_permlane16_swap_b32 v73, v75
    v_mfma_f32_16x16x32_bf16 v[68:71], a[36:39], v[128:131], v[68:71]
    ds_read_b128 a[16:19], v2 offset:55296
    v_add_f32 v72, v72, v74
    s_waitcnt vmcnt(14) lgkmcnt(5)
    v_mfma_f32_16x16x32_bf16 v[52:55], a[40:43], v[132:135], v[52:55]
    ds_read_b128 a[20:23], v2 offset:56320
    v_add_f32_e64 v73, v73, v75
    v_mfma_f32_16x16x32_bf16 v[56:59], a[44:47], v[132:135], v[56:59]
    ds_read_b128 a[24:27], v2 offset:57344
    v_mul_f32 v34, 0x3acccccd, v72
    v_mfma_f32_16x16x32_bf16 v[60:63], a[48:51], v[132:135], v[60:63]
    ds_read_b128 a[28:31], v2 offset:58368
    v_mul_f32 v73, 0x3acccccd, v73
    v_mfma_f32_16x16x32_bf16 v[64:67], a[52:55], v[132:135], v[64:67]
    ds_read_b128 a[32:35], v2 offset:59392
    v_fma_f32 v73, -v34, v34, v73
    v_mfma_f32_16x16x32_bf16 v[68:71], a[56:59], v[132:135], v[68:71]
    ds_read_b128 a[36:39], v2 offset:60416
    v_max_f32 v73, 0, v73
    s_waitcnt vmcnt(13) lgkmcnt(5)
    v_mfma_f32_16x16x32_bf16 v[52:55], a[0:3], v[136:139], v[52:55]
    ds_read_b128 a[40:43], v2 offset:0
    v_add_f32 v72, 0x3727c5ac, v73
    v_mfma_f32_16x16x32_bf16 v[56:59], a[4:7], v[136:139], v[56:59]
    ds_read_b128 a[44:47], v2 offset:1024
    v_rsq_f32_e64 v35, v72
    v_mfma_f32_16x16x32_bf16 v[60:63], a[8:11], v[136:139], v[60:63]
    ds_read_b128 a[48:51], v2 offset:2048
    v_fmamk_f32 v72, v72, 0x3727c5ac, v73
    v_mfma_f32_16x16x32_bf16 v[64:67], a[12:15], v[136:139], v[64:67]
    ds_read_b128 a[52:55], v2 offset:3072
    v_rsq_f32_e64 v74, v72
    v_mfma_f32_16x16x32_bf16 v[68:71], a[16:19], v[136:139], v[68:71]
    ds_read_b128 a[56:59], v2 offset:4096
    v_sqrt_f32 v80, v72
    s_waitcnt vmcnt(12) lgkmcnt(5)
    v_mfma_f32_16x16x32_bf16 v[52:55], a[20:23], v[140:143], v[52:55]
    ds_read_b128 a[0:3], v2 offset:5120
    v_mul_f32 v76, 0xc0135761, v74
    v_mfma_f32_16x16x32_bf16 v[56:59], a[24:27], v[140:143], v[56:59]
    ds_read_b128 a[4:7], v2 offset:6144
    v_mul_f32_e64 v75, v74, v74
    v_mfma_f32_16x16x32_bf16 v[60:63], a[28:31], v[140:143], v[60:63]
    ds_read_b128 a[8:11], v2 offset:7168
    v_mul_f32_e64 v75, v75, v74
    v_mfma_f32_16x16x32_bf16 v[64:67], a[32:35], v[140:143], v[64:67]
    ds_read_b128 a[12:15], v2 offset:8192
    v_mul_f32 v78, 0xbdd2d3e8, v75
    v_mfma_f32_16x16x32_bf16 v[68:71], a[36:39], v[140:143], v[68:71]
    ds_read_b128 a[16:19], v2 offset:9216
    s_waitcnt vmcnt(11) lgkmcnt(5)
    v_mfma_f32_16x16x32_bf16 v[52:55], a[40:43], v[144:147], v[52:55]
    ds_read_b128 a[20:23], v2 offset:10240
    v_mfma_f32_16x16x32_bf16 v[56:59], a[44:47], v[144:147], v[56:59]
    ds_read_b128 a[24:27], v2 offset:11264
    v_mfma_f32_16x16x32_bf16 v[60:63], a[48:51], v[144:147], v[60:63]
    ds_read_b128 a[28:31], v2 offset:12288
    v_mfma_f32_16x16x32_bf16 v[64:67], a[52:55], v[144:147], v[64:67]
    ds_read_b128 a[32:35], v2 offset:13312
    v_mfma_f32_16x16x32_bf16 v[68:71], a[56:59], v[144:147], v[68:71]
    ds_read_b128 a[36:39], v2 offset:14336
    s_waitcnt vmcnt(10) lgkmcnt(5)
    v_mfma_f32_16x16x32_bf16 v[52:55], a[0:3], v[148:151], v[52:55]
    ds_read_b128 a[40:43], v2 offset:15360
    v_mfma_f32_16x16x32_bf16 v[56:59], a[4:7], v[148:151], v[56:59]
    ds_read_b128 a[44:47], v2 offset:16384
    v_mfma_f32_16x16x32_bf16 v[60:63], a[8:11], v[148:151], v[60:63]
    ds_read_b128 a[48:51], v2 offset:17408
    v_mfma_f32_16x16x32_bf16 v[64:67], a[12:15], v[148:151], v[64:67]
    ds_read_b128 a[52:55], v2 offset:18432
    v_mfma_f32_16x16x32_bf16 v[68:71], a[16:19], v[148:151], v[68:71]
    ds_read_b128 a[56:59], v2 offset:19456
    s_waitcnt vmcnt(9) lgkmcnt(5)
    v_mfma_f32_16x16x32_bf16 v[52:55], a[20:23], v[152:155], v[52:55]
    ds_read_b128 a[0:3], v2 offset:20480
    v_mfma_f32_16x16x32_bf16 v[56:59], a[24:27], v[152:155], v[56:59]
    ds_read_b128 a[4:7], v2 offset:21504
    v_mfma_f32_16x16x32_bf16 v[60:63], a[28:31], v[152:155], v[60:63]
    ds_read_b128 a[8:11], v2 offset:22528
    v_mfma_f32_16x16x32_bf16 v[64:67], a[32:35], v[152:155], v[64:67]
    ds_read_b128 a[12:15], v2 offset:23552
    v_mfma_f32_16x16x32_bf16 v[68:71], a[36:39], v[152:155], v[68:71]
    ds_read_b128 a[16:19], v2 offset:24576
    s_waitcnt vmcnt(8) lgkmcnt(5)
    v_mfma_f32_16x16x32_bf16 v[52:55], a[40:43], v[156:159], v[52:55]
    ds_read_b128 a[20:23], v2 offset:25600
    v_mfma_f32_16x16x32_bf16 v[56:59], a[44:47], v[156:159], v[56:59]
    ds_read_b128 a[24:27], v2 offset:26624
    v_mfma_f32_16x16x32_bf16 v[60:63], a[48:51], v[156:159], v[60:63]
    ds_read_b128 a[28:31], v2 offset:27648
    v_mfma_f32_16x16x32_bf16 v[64:67], a[52:55], v[156:159], v[64:67]
    ds_read_b128 a[32:35], v2 offset:28672
    v_mfma_f32_16x16x32_bf16 v[68:71], a[56:59], v[156:159], v[68:71]
    ds_read_b128 a[36:39], v2 offset:29696
    s_waitcnt vmcnt(7) lgkmcnt(5)
    v_mfma_f32_16x16x32_bf16 v[52:55], a[0:3], v[160:163], v[52:55]
    ds_read_b128 a[40:43], v2 offset:30720
    v_mfma_f32_16x16x32_bf16 v[56:59], a[4:7], v[160:163], v[56:59]
    ds_read_b128 a[44:47], v2 offset:31744
    v_mfma_f32_16x16x32_bf16 v[60:63], a[8:11], v[160:163], v[60:63]
    ds_read_b128 a[48:51], v2 offset:32768
    v_mfma_f32_16x16x32_bf16 v[64:67], a[12:15], v[160:163], v[64:67]
    ds_read_b128 a[52:55], v2 offset:33792
    v_mfma_f32_16x16x32_bf16 v[68:71], a[16:19], v[160:163], v[68:71]
    ds_read_b128 a[56:59], v2 offset:34816
    s_waitcnt vmcnt(6) lgkmcnt(5)
    v_mfma_f32_16x16x32_bf16 v[52:55], a[20:23], v[164:167], v[52:55]
    ds_read_b128 a[0:3], v2 offset:35840
    v_mfma_f32_16x16x32_bf16 v[56:59], a[24:27], v[164:167], v[56:59]
    ds_read_b128 a[4:7], v2 offset:36864
    v_mfma_f32_16x16x32_bf16 v[60:63], a[28:31], v[164:167], v[60:63]
    ds_read_b128 a[8:11], v2 offset:37888
    v_mfma_f32_16x16x32_bf16 v[64:67], a[32:35], v[164:167], v[64:67]
    ds_read_b128 a[12:15], v2 offset:38912
    v_mfma_f32_16x16x32_bf16 v[68:71], a[36:39], v[164:167], v[68:71]
    ds_read_b128 a[16:19], v2 offset:39936
    s_waitcnt vmcnt(5) lgkmcnt(5)
    v_mfma_f32_16x16x32_bf16 v[52:55], a[40:43], v[168:171], v[52:55]
    ds_read_b128 a[20:23], v7 offset:57344
    v_mfma_f32_16x16x32_bf16 v[56:59], a[44:47], v[168:171], v[56:59]
    ds_read_b128 a[24:27], v7 offset:58368
    v_mfma_f32_16x16x32_bf16 v[60:63], a[48:51], v[168:171], v[60:63]
    ds_read_b128 a[28:31], v7 offset:59392
    v_mfma_f32_16x16x32_bf16 v[64:67], a[52:55], v[168:171], v[64:67]
    ds_read_b128 a[32:35], v7 offset:60416
    v_mfma_f32_16x16x32_bf16 v[68:71], a[56:59], v[168:171], v[68:71]
    ds_read_b128 a[36:39], v7 offset:61440
    s_waitcnt vmcnt(4) lgkmcnt(5)
    v_mfma_f32_16x16x32_bf16 v[52:55], a[0:3], v[172:175], v[52:55]
    ds_read_b128 a[40:43], v7 offset:62464
    v_mfma_f32_16x16x32_bf16 v[56:59], a[4:7], v[172:175], v[56:59]
    ds_read_b128 a[44:47], v7 offset:63488
    v_mfma_f32_16x16x32_bf16 v[60:63], a[8:11], v[172:175], v[60:63]
    ds_read_b128 a[48:51], v7 offset:64512
    v_mfma_f32_16x16x32_bf16 v[64:67], a[12:15], v[172:175], v[64:67]
    ds_read_b128 a[52:55], v8 offset:0
    v_mfma_f32_16x16x32_bf16 v[68:71], a[16:19], v[172:175], v[68:71]
    ds_read_b128 a[56:59], v8 offset:1024
    s_waitcnt vmcnt(3) lgkmcnt(5)
    ds_read_b64 v[46:47], v39 offset:24
    v_mfma_f32_16x16x32_bf16 v[52:55], a[20:23], v[176:179], v[52:55]
    ds_read_b128 a[0:3], v8 offset:2048
    v_mfma_f32_16x16x32_bf16 v[56:59], a[24:27], v[176:179], v[56:59]
    ds_read_b128 a[4:7], v8 offset:3072
    v_mfma_f32_16x16x32_bf16 v[60:63], a[28:31], v[176:179], v[60:63]
    ds_read_b128 a[8:11], v8 offset:4096
    v_mfma_f32_16x16x32_bf16 v[64:67], a[32:35], v[176:179], v[64:67]
    ds_read_b128 a[12:15], v8 offset:5120
    v_mfma_f32_16x16x32_bf16 v[68:71], a[36:39], v[176:179], v[68:71]
    ds_read_b128 a[16:19], v8 offset:6144
    s_waitcnt vmcnt(2) lgkmcnt(6)
    v_mfma_f32_16x16x32_bf16 v[52:55], a[40:43], v[180:183], v[52:55]
    ds_read_b128 a[20:23], v8 offset:7168
    v_mfma_f32_16x16x32_bf16 v[56:59], a[44:47], v[180:183], v[56:59]
    ds_read_b128 a[24:27], v8 offset:8192
    v_mfma_f32_16x16x32_bf16 v[60:63], a[48:51], v[180:183], v[60:63]
    ds_read_b128 a[28:31], v8 offset:9216
    v_mfma_f32_16x16x32_bf16 v[64:67], a[52:55], v[180:183], v[64:67]
    ds_read_b128 a[32:35], v8 offset:10240
    v_mfma_f32_16x16x32_bf16 v[68:71], a[56:59], v[180:183], v[68:71]
    ds_read_b128 a[36:39], v8 offset:11264
    s_waitcnt vmcnt(1) lgkmcnt(5)
    v_min_u32 v46, v46, v47
    v_cmp_gt_u32 vcc, 5, v46
    s_cbranch_vccz L63
    s_mov_b32 s60, 0
L62:
    ds_read_b64 v[46:47], v39 offset:24
    s_waitcnt lgkmcnt(0)
    v_min_u32 v46, v46, v47
    v_cmp_gt_u32 vcc, 5, v46
    s_cbranch_vccz L63
    s_add_u32 s60, s60, 1
    s_cmp_lt_u32 s60, 3200000
    s_cbranch_scc1 L62
L63:
    ds_read_b128 v[112:115], v111 offset:0
    ds_read_b128 v[116:119], v111 offset:64
    ds_read_b128 v[120:123], v111 offset:128
    ds_read_b128 v[124:127], v111 offset:192
    ds_read_b128 v[128:131], v111 offset:256
    v_mfma_f32_16x16x32_bf16 v[52:55], a[0:3], v[184:187], v[52:55]
    v_mfma_f32_16x16x32_bf16 v[56:59], a[4:7], v[184:187], v[56:59]
    v_mfma_f32_16x16x32_bf16 v[60:63], a[8:11], v[184:187], v[60:63]
    v_mfma_f32_16x16x32_bf16 v[64:67], a[12:15], v[184:187], v[64:67]
    v_mfma_f32_16x16x32_bf16 v[68:71], a[16:19], v[184:187], v[68:71]
    s_waitcnt vmcnt(0) lgkmcnt(5)
    v_mfma_f32_16x16x32_bf16 v[52:55], a[20:23], v[188:191], v[52:55]
    v_mfma_f32_16x16x32_bf16 v[56:59], a[24:27], v[188:191], v[56:59]
    v_mfma_f32_16x16x32_bf16 v[60:63], a[28:31], v[188:191], v[60:63]
    v_mfma_f32_16x16x32_bf16 v[64:67], a[32:35], v[188:191], v[64:67]
    v_mfma_f32_16x16x32_bf16 v[68:71], a[36:39], v[188:191], v[68:71]
    v_mov_b32_e64 v0, 11
    ds_write_b32 v45, v0
    s_waitcnt lgkmcnt(1)
    s_nop 0
    v_pk_fma_f32 v[52:53], v[112:113], v[34:35], v[52:53] op_sel_hi:[1,0,1] neg_lo:[0,1,0] neg_hi:[0,1,0]
    v_pk_fma_f32 v[54:55], v[114:115], v[34:35], v[54:55] op_sel_hi:[1,0,1] neg_lo:[0,1,0] neg_hi:[0,1,0]
    v_pk_fma_f32 v[56:57], v[116:117], v[34:35], v[56:57] op_sel_hi:[1,0,1] neg_lo:[0,1,0] neg_hi:[0,1,0]
    v_pk_fma_f32 v[58:59], v[118:119], v[34:35], v[58:59] op_sel_hi:[1,0,1] neg_lo:[0,1,0] neg_hi:[0,1,0]
    v_pk_fma_f32 v[60:61], v[120:121], v[34:35], v[60:61] op_sel_hi:[1,0,1] neg_lo:[0,1,0] neg_hi:[0,1,0]
    v_pk_mul_f32 v[136:137], v[52:53], v[52:53]
    v_pk_mul_f32 v[138:139], v[54:55], v[54:55]
    v_pk_mul_f32 v[140:141], v[56:57], v[56:57]
    v_pk_mul_f32 v[142:143], v[58:59], v[58:59]
    v_pk_mul_f32 v[144:145], v[60:61], v[60:61]
    v_pk_fma_f32 v[136:137], v[136:137], v[78:79], v[76:77] op_sel_hi:[1,0,0]
    v_pk_fma_f32 v[138:139], v[138:139], v[78:79], v[76:77] op_sel_hi:[1,0,0]
    v_pk_fma_f32 v[140:141], v[140:141], v[78:79], v[76:77] op_sel_hi:[1,0,0]
    v_pk_fma_f32 v[142:143], v[142:143], v[78:79], v[76:77] op_sel_hi:[1,0,0]
    v_pk_fma_f32 v[144:145], v[144:145], v[78:79], v[76:77] op_sel_hi:[1,0,0]
    v_pk_mul_f32 v[136:137], v[136:137], v[52:53]
    v_pk_mul_f32 v[138:139], v[138:139], v[54:55]
    v_pk_mul_f32 v[140:141], v[140:141], v[56:57]
    v_pk_mul_f32 v[142:143], v[142:143], v[58:59]
    v_pk_mul_f32 v[144:145], v[144:145], v[60:61]
    v_exp_f32 v136, v136
    v_exp_f32 v137, v137
    v_exp_f32 v138, v138
    v_exp_f32 v139, v139
    v_exp_f32 v140, v140
    v_exp_f32 v141, v141
    v_exp_f32 v142, v142
    v_exp_f32 v143, v143
    v_exp_f32 v144, v144
    v_exp_f32 v145, v145
    v_pk_fma_f32 v[136:137], v[136:137], v[80:81], v[80:81] op_sel_hi:[1,0,0]
    v_pk_fma_f32 v[138:139], v[138:139], v[80:81], v[80:81] op_sel_hi:[1,0,0]
    v_pk_fma_f32 v[140:141], v[140:141], v[80:81], v[80:81] op_sel_hi:[1,0,0]
    v_pk_fma_f32 v[142:143], v[142:143], v[80:81], v[80:81] op_sel_hi:[1,0,0]
    v_pk_fma_f32 v[144:145], v[144:145], v[80:81], v[80:81] op_sel_hi:[1,0,0]
    v_rcp_f32 v136, v136
    v_rcp_f32 v137, v137
    v_rcp_f32 v138, v138
    v_rcp_f32 v139, v139
    v_rcp_f32 v140, v140
    v_rcp_f32 v141, v141
    v_rcp_f32 v142, v142
    v_rcp_f32 v143, v143
    v_rcp_f32 v144, v144
    v_rcp_f32 v145, v145
    v_pk_mul_f32 v[136:137], v[136:137], v[52:53]
    v_pk_mul_f32 v[138:139], v[138:139], v[54:55]
    v_pk_mul_f32 v[140:141], v[140:141], v[56:57]
    v_pk_mul_f32 v[142:143], v[142:143], v[58:59]
    v_pk_mul_f32 v[144:145], v[144:145], v[60:61]
    v_cvt_pk_bf16_f32 v92, v136, v137
    v_cvt_pk_bf16_f32 v93, v138, v139
    v_cvt_pk_bf16_f32 v94, v140, v141
    v_cvt_pk_bf16_f32 v95, v142, v143
    v_cvt_pk_bf16_f32 v96, v144, v145
    v_pk_fma_f32 v[62:63], v[122:123], v[34:35], v[62:63] op_sel_hi:[1,0,1] neg_lo:[0,1,0] neg_hi:[0,1,0]
    v_pk_fma_f32 v[64:65], v[124:125], v[34:35], v[64:65] op_sel_hi:[1,0,1] neg_lo:[0,1,0] neg_hi:[0,1,0]
    v_pk_fma_f32 v[66:67], v[126:127], v[34:35], v[66:67] op_sel_hi:[1,0,1] neg_lo:[0,1,0] neg_hi:[0,1,0]
    v_pk_fma_f32 v[68:69], v[128:129], v[34:35], v[68:69] op_sel_hi:[1,0,1] neg_lo:[0,1,0] neg_hi:[0,1,0]
    v_pk_fma_f32 v[70:71], v[130:131], v[34:35], v[70:71] op_sel_hi:[1,0,1] neg_lo:[0,1,0] neg_hi:[0,1,0]
    v_pk_mul_f32 v[136:137], v[62:63], v[62:63]
    v_pk_mul_f32 v[138:139], v[64:65], v[64:65]
    v_pk_mul_f32 v[140:141], v[66:67], v[66:67]
    v_pk_mul_f32 v[142:143], v[68:69], v[68:69]
    v_pk_mul_f32 v[144:145], v[70:71], v[70:71]
    v_pk_fma_f32 v[136:137], v[136:137], v[78:79], v[76:77] op_sel_hi:[1,0,0]
    v_pk_fma_f32 v[138:139], v[138:139], v[78:79], v[76:77] op_sel_hi:[1,0,0]
    v_pk_fma_f32 v[140:141], v[140:141], v[78:79], v[76:77] op_sel_hi:[1,0,0]
    v_pk_fma_f32 v[142:143], v[142:143], v[78:79], v[76:77] op_sel_hi:[1,0,0]
    v_pk_fma_f32 v[144:145], v[144:145], v[78:79], v[76:77] op_sel_hi:[1,0,0]
    v_pk_mul_f32 v[136:137], v[136:137], v[62:63]
    v_pk_mul_f32 v[138:139], v[138:139], v[64:65]
    v_pk_mul_f32 v[140:141], v[140:141], v[66:67]
    v_pk_mul_f32 v[142:143], v[142:143], v[68:69]
    v_pk_mul_f32 v[144:145], v[144:145], v[70:71]
    v_exp_f32 v136, v136
    v_exp_f32 v137, v137
    v_exp_f32 v138, v138
    v_exp_f32 v139, v139
    v_exp_f32 v140, v140
    v_exp_f32 v141, v141
    v_exp_f32 v142, v142
    v_exp_f32 v143, v143
    v_exp_f32 v144, v144
    v_exp_f32 v145, v145
    v_pk_fma_f32 v[136:137], v[136:137], v[80:81], v[80:81] op_sel_hi:[1,0,0]
    v_pk_fma_f32 v[138:139], v[138:139], v[80:81], v[80:81] op_sel_hi:[1,0,0]
    v_pk_fma_f32 v[140:141], v[140:141], v[80:81], v[80:81] op_sel_hi:[1,0,0]
    v_pk_fma_f32 v[142:143], v[142:143], v[80:81], v[80:81] op_sel_hi:[1,0,0]
    v_pk_fma_f32 v[144:145], v[144:145], v[80:81], v[80:81] op_sel_hi:[1,0,0]
    v_rcp_f32 v136, v136
    v_rcp_f32 v137, v137
    v_rcp_f32 v138, v138
    v_rcp_f32 v139, v139
    v_rcp_f32 v140, v140
    v_rcp_f32 v141, v141
    v_rcp_f32 v142, v142
    v_rcp_f32 v143, v143
    v_rcp_f32 v144, v144
    v_rcp_f32 v145, v145
    v_pk_mul_f32 v[136:137], v[136:137], v[62:63]
    v_pk_mul_f32 v[138:139], v[138:139], v[64:65]
    v_pk_mul_f32 v[140:141], v[140:141], v[66:67]
    v_pk_mul_f32 v[142:143], v[142:143], v[68:69]
    v_pk_mul_f32 v[144:145], v[144:145], v[70:71]
    v_cvt_pk_bf16_f32 v97, v136, v137
    v_cvt_pk_bf16_f32 v98, v138, v139
    v_cvt_pk_bf16_f32 v99, v140, v141
    v_cvt_pk_bf16_f32 v100, v142, v143
    v_cvt_pk_bf16_f32 v101, v144, v145
    s_cmp_eq_u32 s6, 0
    s_cbranch_scc1 L64
    v_permlane16_swap_b32 v92, v94
    v_permlane16_swap_b32 v93, v95
    buffer_store_dwordx4 v[92:95], v40, s[28:31], s9 offen
    v_permlane16_swap_b32 v96, v98
    v_permlane16_swap_b32 v97, v99
    buffer_store_dwordx4 v[96:99], v40, s[28:31], s9 offen offset:1024
    v_permlane16_swap_b32 v100, v102
    v_permlane16_swap_b32 v101, v103
    buffer_store_dwordx4 v[100:103], v41, s[28:31], s9 offen
    s_branch L65
L64:
    v_permlane16_swap_b32 v92, v94
    v_permlane16_swap_b32 v93, v95
    buffer_store_dwordx4 v[92:95], v40, s[28:31], s9 offen sc1
    v_permlane16_swap_b32 v96, v98
    v_permlane16_swap_b32 v97, v99
    buffer_store_dwordx4 v[96:99], v40, s[28:31], s9 offen offset:1024 sc1
    v_permlane16_swap_b32 v100, v102
    v_permlane16_swap_b32 v101, v103
    buffer_store_dwordx4 v[100:103], v41, s[28:31], s9 offen sc1
L65:
    s_cmp_lg_u32 s5, 0
    s_cselect_b32 s34, s30, 0
    s_mov_b32 s32, s28
    s_mov_b32 s33, s29
    s_mov_b32 s62, 0xa00000
    buffer_store_dwordx4 v[92:95], v40, s[32:35], s62 offen sc1
    buffer_store_dwordx4 v[96:99], v40, s[32:35], s62 offen offset:1024 sc1
    buffer_store_dwordx4 v[100:103], v41, s[32:35], s62 offen sc1
    v_permlane16_swap_b32 v10, v12
    v_permlane16_swap_b32 v11, v13
    v_permlane16_swap_b32 v14, v16
    v_permlane16_swap_b32 v15, v17
    v_permlane16_swap_b32 v18, v20
    v_permlane16_swap_b32 v19, v21
    v_lshlrev_b32 v52, 16, v10
    v_and_b32 v53, 0xffff0000, v10
    v_lshlrev_b32_e64 v54, 16, v11
    v_and_b32 v55, 0xffff0000, v11
    v_lshlrev_b32_e64 v56, 16, v12
    v_and_b32 v57, 0xffff0000, v12
    v_lshlrev_b32_e64 v58, 16, v13
    v_and_b32 v59, 0xffff0000, v13
    v_lshlrev_b32_e64 v60, 16, v14
    v_and_b32 v61, 0xffff0000, v14
    v_lshlrev_b32_e64 v62, 16, v15
    v_and_b32 v63, 0xffff0000, v15
    v_lshlrev_b32_e64 v64, 16, v16
    v_and_b32 v65, 0xffff0000, v16
    v_lshlrev_b32_e64 v66, 16, v17
    v_and_b32 v67, 0xffff0000, v17
    v_lshlrev_b32_e64 v68, 16, v18
    v_and_b32 v69, 0xffff0000, v18
    v_lshlrev_b32_e64 v70, 16, v19
    v_and_b32 v71, 0xffff0000, v19
    v_mul_f32_e64 v72, -v34, v35
    v_mov_b32_e64 v74, v35
    v_pk_fma_f32 v[52:53], v[52:53], v[74:75], v[72:73] op_sel_hi:[1,0,0]
    v_pk_fma_f32 v[54:55], v[54:55], v[74:75], v[72:73] op_sel_hi:[1,0,0]
    v_pk_fma_f32 v[56:57], v[56:57], v[74:75], v[72:73] op_sel_hi:[1,0,0]
    v_pk_fma_f32 v[58:59], v[58:59], v[74:75], v[72:73] op_sel_hi:[1,0,0]
    v_pk_fma_f32 v[60:61], v[60:61], v[74:75], v[72:73] op_sel_hi:[1,0,0]
    v_pk_fma_f32 v[62:63], v[62:63], v[74:75], v[72:73] op_sel_hi:[1,0,0]
    v_pk_fma_f32 v[64:65], v[64:65], v[74:75], v[72:73] op_sel_hi:[1,0,0]
    v_pk_fma_f32 v[66:67], v[66:67], v[74:75], v[72:73] op_sel_hi:[1,0,0]
    v_pk_fma_f32 v[68:69], v[68:69], v[74:75], v[72:73] op_sel_hi:[1,0,0]
    v_pk_fma_f32 v[70:71], v[70:71], v[74:75], v[72:73] op_sel_hi:[1,0,0]
    s_lshl_b32 s60, s63, 3
    s_add_u32 s60, s60, s44
    s_lshl_b32 s60, s60, 7
    s_add_u32 s60, s60, 0x2280000
    v_mov_b32 v48, s60
    s_bitcmp1_b32 s63, 0
    s_cselect_b32 s60, 1, -1
    s_add_u32 s60, s60, s63
    s_cmp_lt_u32 s60, 128
    s_cselect_b32 s66, s5, 0
    s_lshl_b32 s60, s60, 10
    s_add_u32 s60, s60, 0x2280000
    v_and_b32 v49, 7, v1
    v_lshl_add_u32 v49, v49, 7, s60
    s_waitcnt vmcnt(3)
    s_cmp_eq_u32 s6, 0
    s_cbranch_scc1 L66
    s_mov_b64 exec, 1
    buffer_store_dword v3, v105, s[28:31], 0 offen
    s_mov_b64 exec, -1
    s_branch L67
L66:
    s_mov_b64 exec, 1
    buffer_store_dword v3, v105, s[28:31], 0 offen sc1
    s_mov_b64 exec, -1
L67:
    v_add_u32 v105, 0x2214000, v44
    s_mov_b32 s60, 0
    v_not_b32 v0, v3
L68:
    v_mov_b32_e64 v4, v0
    buffer_load_dword v4, v110, s[28:31], 0 offen sc1
    s_mov_b32 s61, 0
L69:
    v_cmp_eq_u32 vcc, v4, v0
    s_cbranch_vccz L70
    s_add_u32 s61, s61, 1
    s_cmp_lt_u32 s61, 200
    s_cbranch_scc1 L69
L70:
    v_cmp_ne_u32 vcc, v4, v3
    s_cbranch_vccz L71
    s_add_u32 s60, s60, 1
    s_cmp_lt_u32 s60, 400000
    s_cbranch_scc1 L68
L71:
    buffer_load_dwordx4 v[112:115], v106, s[28:31], 0 offen offset:0 sc1
    buffer_load_dwordx4 v[116:119], v106, s[28:31], 0 offen offset:1024 sc1
    buffer_load_dwordx4 v[120:123], v106, s[28:31], 0 offen offset:2048 sc1
    buffer_load_dwordx4 v[124:127], v106, s[28:31], 0 offen offset:3072 sc1
    buffer_load_dwordx4 v[128:131], v107, s[28:31], 0 offen offset:0 sc1
    buffer_load_dwordx4 v[132:135], v107, s[28:31], 0 offen offset:1024 sc1
    buffer_load_dwordx4 v[136:139], v107, s[28:31], 0 offen offset:2048 sc1
    buffer_load_dwordx4 v[140:143], v107, s[28:31], 0 offen offset:3072 sc1
    s_waitcnt vmcnt(9)
    s_mov_b64 exec, 1
    buffer_store_dword v3, v48, s[32:35], 0 offen sc1
    s_mov_b64 exec, -1
    s_mov_b32 s60, 0
L72:
    ds_read_b64 v[46:47], v39 offset:16
    s_waitcnt lgkmcnt(0)
    v_min_u32 v46, v46, v47
    v_cmp_gt_u32 vcc, 15, v46
    s_cbranch_vccz L73
    s_add_u32 s60, s60, 1
    s_cmp_lt_u32 s60, 3200000
    s_cbranch_scc1 L72
L73:
    s_mov_b32 s60, 0
L74:
    ds_read_b64 v[46:47], v39 offset:24
    s_waitcnt lgkmcnt(0)
    v_min_u32 v46, v46, v47
    v_cmp_gt_u32 vcc, 9, v46
    s_cbranch_vccz L75
    s_add_u32 s60, s60, 1
    s_cmp_lt_u32 s60, 3200000
    s_cbranch_scc1 L74
L75:
    ds_read_b128 a[0:3], v2 offset:61440
    ds_read_b128 a[4:7], v2 offset:62464
    ds_read_b128 a[8:11], v2 offset:63488
    ds_read_b128 a[12:15], v2 offset:64512
    ds_read_b128 a[16:19], v7 offset:0
    ds_read_b128 a[20:23], v7 offset:1024
    ds_read_b128 a[24:27], v7 offset:2048
    ds_read_b128 a[28:31], v7 offset:3072
    ds_read_b128 a[32:35], v7 offset:4096
    ds_read_b128 a[36:39], v7 offset:5120
    s_waitcnt vmcnt(8) lgkmcnt(5)
    v_mfma_f32_16x16x32_bf16 v[52:55], a[0:3], v[112:115], v[52:55]
    ds_read_b128 a[40:43], v7 offset:6144
    v_mfma_f32_16x16x32_bf16 v[56:59], a[4:7], v[112:115], v[56:59]
    ds_read_b128 a[44:47], v7 offset:7168
    v_mfma_f32_16x16x32_bf16 v[60:63], a[8:11], v[112:115], v[60:63]
    ds_read_b128 a[48:51], v7 offset:8192
    v_mfma_f32_16x16x32_bf16 v[64:67], a[12:15], v[112:115], v[64:67]
    ds_read_b128 a[52:55], v7 offset:9216
    v_mfma_f32_16x16x32_bf16 v[68:71], a[16:19], v[112:115], v[68:71]
    ds_read_b128 a[56:59], v7 offset:10240
    s_waitcnt vmcnt(7) lgkmcnt(5)
    s_cmp_eq_u32 s66, 0
    s_cbranch_scc1 L76
    s_mov_b32 s60, 0
    v_not_b32 v0, v3
L77:
    v_mov_b32_e64 v4, v0
    buffer_load_dword v4, v49, s[28:31], 0 offen sc1
    s_mov_b32 s61, 0
L78:
    v_cmp_eq_u32 vcc, v4, v0
    s_cbranch_vccz L79
    s_add_u32 s61, s61, 1
    s_cmp_lt_u32 s61, 200
    s_cbranch_scc1 L78
L79:
    v_cmp_ne_u32 vcc, v4, v3
    s_cbranch_vccz L80
    s_add_u32 s60, s60, 1
    s_cmp_lt_u32 s60, 400000
    s_cbranch_scc1 L77
L80:
L76:
    v_mfma_f32_16x16x32_bf16 v[52:55], a[20:23], v[116:119], v[52:55]
    ds_read_b128 a[0:3], v7 offset:11264
    buffer_load_dwordx4 v[144:147], v108, s[28:31], 0 offen offset:0 sc1
    v_mfma_f32_16x16x32_bf16 v[56:59], a[24:27], v[116:119], v[56:59]
    ds_read_b128 a[4:7], v7 offset:12288
    v_mfma_f32_16x16x32_bf16 v[60:63], a[28:31], v[116:119], v[60:63]
    ds_read_b128 a[8:11], v7 offset:13312
    buffer_load_dwordx4 v[148:151], v108, s[28:31], 0 offen offset:1024 sc1
    v_mfma_f32_16x16x32_bf16 v[64:67], a[32:35], v[116:119], v[64:67]
    ds_read_b128 a[12:15], v7 offset:14336
    v_mfma_f32_16x16x32_bf16 v[68:71], a[36:39], v[116:119], v[68:71]
    ds_read_b128 a[16:19], v7 offset:15360
    s_waitcnt vmcnt(8) lgkmcnt(5)
    v_mfma_f32_16x16x32_bf16 v[52:55], a[40:43], v[120:123], v[52:55]
    ds_read_b128 a[20:23], v2 offset:0
    buffer_load_dwordx4 v[152:155], v108, s[28:31], 0 offen offset:2048 sc1
    v_mfma_f32_16x16x32_bf16 v[56:59], a[44:47], v[120:123], v[56:59]
    ds_read_b128 a[24:27], v2 offset:1024
    v_mfma_f32_16x16x32_bf16 v[60:63], a[48:51], v[120:123], v[60:63]
    ds_read_b128 a[28:31], v2 offset:2048
    buffer_load_dwordx4 v[156:159], v108, s[28:31], 0 offen offset:3072 sc1
    v_mfma_f32_16x16x32_bf16 v[64:67], a[52:55], v[120:123], v[64:67]
    ds_read_b128 a[32:35], v2 offset:3072
    v_mfma_f32_16x16x32_bf16 v[68:71], a[56:59], v[120:123], v[68:71]
    ds_read_b128 a[36:39], v2 offset:4096
    s_waitcnt vmcnt(9) lgkmcnt(5)
    v_mfma_f32_16x16x32_bf16 v[52:55], a[0:3], v[124:127], v[52:55]
    ds_read_b128 a[40:43], v2 offset:5120
    buffer_load_dwordx4 v[160:163], v109, s[28:31], 0 offen offset:0 sc1
    v_mfma_f32_16x16x32_bf16 v[56:59], a[4:7], v[124:127], v[56:59]
    ds_read_b128 a[44:47], v2 offset:6144
    v_mfma_f32_16x16x32_bf16 v[60:63], a[8:11], v[124:127], v[60:63]
    ds_read_b128 a[48:51], v2 offset:7168
    buffer_load_dwordx4 v[164:167], v109, s[28:31], 0 offen offset:1024 sc1
    v_mfma_f32_16x16x32_bf16 v[64:67], a[12:15], v[124:127], v[64:67]
    ds_read_b128 a[52:55], v2 offset:8192
    v_mfma_f32_16x16x32_bf16 v[68:71], a[16:19], v[124:127], v[68:71]
    ds_read_b128 a[56:59], v2 offset:9216
    s_waitcnt vmcnt(10) lgkmcnt(5)
    v_mfma_f32_16x16x32_bf16 v[52:55], a[20:23], v[128:131], v[52:55]
    ds_read_b128 a[0:3], v2 offset:10240
    buffer_load_dwordx4 v[168:171], v109, s[28:31], 0 offen offset:2048 sc1
    v_mfma_f32_16x16x32_bf16 v[56:59], a[24:27], v[128:131], v[56:59]
    ds_read_b128 a[4:7], v2 offset:11264
    v_mfma_f32_16x16x32_bf16 v[60:63], a[28:31], v[128:131], v[60:63]
    ds_read_b128 a[8:11], v2 offset:12288
    buffer_load_dwordx4 v[172:175], v109, s[28:31], 0 offen offset:3072 sc1
    v_mfma_f32_16x16x32_bf16 v[64:67], a[32:35], v[128:131], v[64:67]
    ds_read_b128 a[12:15], v2 offset:13312
    v_mfma_f32_16x16x32_bf16 v[68:71], a[36:39], v[128:131], v[68:71]
    ds_read_b128 a[16:19], v2 offset:14336
    s_waitcnt vmcnt(11) lgkmcnt(5)
    v_mfma_f32_16x16x32_bf16 v[52:55], a[40:43], v[132:135], v[52:55]
    ds_read_b128 a[20:23], v2 offset:15360
    buffer_load_dwordx4 v[176:179], v106, s[28:31], s76 offen offset:0 sc1
    v_mfma_f32_16x16x32_bf16 v[56:59], a[44:47], v[132:135], v[56:59]
    ds_read_b128 a[24:27], v2 offset:16384
    v_mfma_f32_16x16x32_bf16 v[60:63], a[48:51], v[132:135], v[60:63]
    ds_read_b128 a[28:31], v2 offset:17408
    buffer_load_dwordx4 v[180:183], v107, s[28:31], s76 offen offset:0 sc1
    v_mfma_f32_16x16x32_bf16 v[64:67], a[52:55], v[132:135], v[64:67]
    ds_read_b128 a[32:35], v2 offset:18432
    v_mfma_f32_16x16x32_bf16 v[68:71], a[56:59], v[132:135], v[68:71]
    ds_read_b128 a[36:39], v2 offset:19456
    s_waitcnt vmcnt(12) lgkmcnt(5)
    v_mfma_f32_16x16x32_bf16 v[52:55], a[0:3], v[136:139], v[52:55]
    ds_read_b128 a[40:43], v7 offset:36864
    buffer_load_dwordx4 v[184:187], v108, s[28:31], s76 offen offset:0 sc1
    v_mov_b32_e64 v0, 12
    ds_write_b32 v45, v0
    v_mfma_f32_16x16x32_bf16 v[56:59], a[4:7], v[136:139], v[56:59]
    ds_read_b128 a[44:47], v7 offset:37888
    v_mfma_f32_16x16x32_bf16 v[60:63], a[8:11], v[136:139], v[60:63]
    ds_read_b128 a[48:51], v7 offset:38912
    buffer_load_dwordx4 v[188:191], v109, s[28:31], s76 offen offset:0 sc1
    v_mfma_f32_16x16x32_bf16 v[64:67], a[12:15], v[136:139], v[64:67]
    ds_read_b128 a[52:55], v7 offset:39936
    v_mfma_f32_16x16x32_bf16 v[68:71], a[16:19], v[136:139], v[68:71]
    ds_read_b128 a[56:59], v7 offset:40960
    s_waitcnt vmcnt(13) lgkmcnt(6)
    v_mfma_f32_16x16x32_bf16 v[52:55], a[20:23], v[140:143], v[52:55]
    ds_read_b128 a[0:3], v7 offset:41984
    v_mfma_f32_16x16x32_bf16 v[56:59], a[24:27], v[140:143], v[56:59]
    ds_read_b128 a[4:7], v7 offset:43008
    v_mfma_f32_16x16x32_bf16 v[60:63], a[28:31], v[140:143], v[60:63]
    ds_read_b128 a[8:11], v7 offset:44032
    v_mfma_f32_16x16x32_bf16 v[64:67], a[32:35], v[140:143], v[64:67]
    ds_read_b128 a[12:15], v7 offset:45056
    v_mfma_f32_16x16x32_bf16 v[68:71], a[36:39], v[140:143], v[68:71]
    ds_read_b128 a[16:19], v7 offset:46080
    s_waitcnt vmcnt(11) lgkmcnt(5)
    v_mfma_f32_16x16x32_bf16 v[52:55], a[40:43], v[144:147], v[52:55]
    ds_read_b128 a[20:23], v7 offset:47104
    v_mfma_f32_16x16x32_bf16 v[56:59], a[44:47], v[144:147], v[56:59]
    ds_read_b128 a[24:27], v7 offset:48128
    v_mfma_f32_16x16x32_bf16 v[60:63], a[48:51], v[144:147], v[60:63]
    ds_read_b128 a[28:31], v7 offset:49152
    v_mfma_f32_16x16x32_bf16 v[64:67], a[52:55], v[144:147], v[64:67]
    ds_read_b128 a[32:35], v7 offset:50176
    v_mfma_f32_16x16x32_bf16 v[68:71], a[56:59], v[144:147], v[68:71]
    ds_read_b128 a[36:39], v7 offset:51200
    s_waitcnt vmcnt(10) lgkmcnt(5)
    v_mfma_f32_16x16x32_bf16 v[52:55], a[0:3], v[148:151], v[52:55]
    ds_read_b128 a[40:43], v7 offset:52224
    v_mfma_f32_16x16x32_bf16 v[56:59], a[4:7], v[148:151], v[56:59]
    ds_read_b128 a[44:47], v7 offset:53248
    v_mfma_f32_16x16x32_bf16 v[60:63], a[8:11], v[148:151], v[60:63]
    ds_read_b128 a[48:51], v7 offset:54272
    v_mfma_f32_16x16x32_bf16 v[64:67], a[12:15], v[148:151], v[64:67]
    ds_read_b128 a[52:55], v7 offset:55296
    v_mfma_f32_16x16x32_bf16 v[68:71], a[16:19], v[148:151], v[68:71]
    ds_read_b128 a[56:59], v7 offset:56320
    s_waitcnt vmcnt(9) lgkmcnt(5)
    v_mfma_f32_16x16x32_bf16 v[52:55], a[20:23], v[152:155], v[52:55]
    ds_read_b128 a[0:3], v7 offset:57344
    v_mfma_f32_16x16x32_bf16 v[56:59], a[24:27], v[152:155], v[56:59]
    ds_read_b128 a[4:7], v7 offset:58368
    v_mfma_f32_16x16x32_bf16 v[60:63], a[28:31], v[152:155], v[60:63]
    ds_read_b128 a[8:11], v7 offset:59392
    v_mfma_f32_16x16x32_bf16 v[64:67], a[32:35], v[152:155], v[64:67]
    ds_read_b128 a[12:15], v7 offset:60416
    v_mfma_f32_16x16x32_bf16 v[68:71], a[36:39], v[152:155], v[68:71]
    ds_read_b128 a[16:19], v7 offset:61440
    s_waitcnt vmcnt(8) lgkmcnt(5)
    v_mfma_f32_16x16x32_bf16 v[52:55], a[40:43], v[156:159], v[52:55]
    ds_read_b128 a[20:23], v7 offset:62464
    v_mfma_f32_16x16x32_bf16 v[56:59], a[44:47], v[156:159], v[56:59]
    ds_read_b128 a[24:27], v7 offset:63488
    v_mfma_f32_16x16x32_bf16 v[60:63], a[48:51], v[156:159], v[60:63]
    ds_read_b128 a[28:31], v7 offset:64512
    v_mfma_f32_16x16x32_bf16 v[64:67], a[52:55], v[156:159], v[64:67]
    ds_read_b128 a[32:35], v8 offset:0
    v_mfma_f32_16x16x32_bf16 v[68:71], a[56:59], v[156:159], v[68:71]
    ds_read_b128 a[36:39], v8 offset:1024
    s_waitcnt vmcnt(7) lgkmcnt(5)
    v_mfma_f32_16x16x32_bf16 v[52:55], a[0:3], v[160:163], v[52:55]
    ds_read_b128 a[40:43], v8 offset:2048
    v_mfma_f32_16x16x32_bf16 v[56:59], a[4:7], v[160:163], v[56:59]
    ds_read_b128 a[44:47], v8 offset:3072
    v_mfma_f32_16x16x32_bf16 v[60:63], a[8:11], v[160:163], v[60:63]
    ds_read_b128 a[48:51], v8 offset:4096
    v_mfma_f32_16x16x32_bf16 v[64:67], a[12:15], v[160:163], v[64:67]
    ds_read_b128 a[52:55], v8 offset:5120
    v_mfma_f32_16x16x32_bf16 v[68:71], a[16:19], v[160:163], v[68:71]
    ds_read_b128 a[56:59], v8 offset:6144
    s_waitcnt vmcnt(6) lgkmcnt(5)
    v_mfma_f32_16x16x32_bf16 v[52:55], a[20:23], v[164:167], v[52:55]
    ds_read_b128 a[0:3], v8 offset:7168
    v_mfma_f32_16x16x32_bf16 v[56:59], a[24:27], v[164:167], v[56:59]
    ds_read_b128 a[4:7], v8 offset:8192
    v_mfma_f32_16x16x32_bf16 v[60:63], a[28:31], v[164:167], v[60:63]
    ds_read_b128 a[8:11], v8 offset:9216
    v_mfma_f32_16x16x32_bf16 v[64:67], a[32:35], v[164:167], v[64:67]
    ds_read_b128 a[12:15], v8 offset:10240
    v_mfma_f32_16x16x32_bf16 v[68:71], a[36:39], v[164:167], v[68:71]
    ds_read_b128 a[16:19], v8 offset:11264
    s_waitcnt vmcnt(5) lgkmcnt(5)
    v_mfma_f32_16x16x32_bf16 v[52:55], a[40:43], v[168:171], v[52:55]
    ds_read_b128 a[20:23], v7 offset:16384
    v_mfma_f32_16x16x32_bf16 v[56:59], a[44:47], v[168:171], v[56:59]
    ds_read_b128 a[24:27], v7 offset:17408
    v_mfma_f32_16x16x32_bf16 v[60:63], a[48:51], v[168:171], v[60:63]
    ds_read_b128 a[28:31], v7 offset:18432
    v_mfma_f32_16x16x32_bf16 v[64:67], a[52:55], v[168:171], v[64:67]
    ds_read_b128 a[32:35], v7 offset:19456
    v_mfma_f32_16x16x32_bf16 v[68:71], a[56:59], v[168:171], v[68:71]
    ds_read_b128 a[36:39], v7 offset:20480
    s_waitcnt vmcnt(4) lgkmcnt(5)
    v_mfma_f32_16x16x32_bf16 v[52:55], a[0:3], v[172:175], v[52:55]
    ds_read_b128 a[40:43], v7 offset:21504
    v_mfma_f32_16x16x32_bf16 v[56:59], a[4:7], v[172:175], v[56:59]
    ds_read_b128 a[44:47], v7 offset:22528
    v_mfma_f32_16x16x32_bf16 v[60:63], a[8:11], v[172:175], v[60:63]
    ds_read_b128 a[48:51], v7 offset:23552
    v_mfma_f32_16x16x32_bf16 v[64:67], a[12:15], v[172:175], v[64:67]
    ds_read_b128 a[52:55], v7 offset:24576
    v_mfma_f32_16x16x32_bf16 v[68:71], a[16:19], v[172:175], v[68:71]
    ds_read_b128 a[56:59], v7 offset:25600
    s_waitcnt vmcnt(3) lgkmcnt(5)
    v_mfma_f32_16x16x32_bf16 v[52:55], a[20:23], v[176:179], v[52:55]
    ds_read_b128 a[0:3], v7 offset:26624
    v_mfma_f32_16x16x32_bf16 v[56:59], a[24:27], v[176:179], v[56:59]
    ds_read_b128 a[4:7], v7 offset:27648
    v_mfma_f32_16x16x32_bf16 v[60:63], a[28:31], v[176:179], v[60:63]
    ds_read_b128 a[8:11], v7 offset:28672
    v_mfma_f32_16x16x32_bf16 v[64:67], a[32:35], v[176:179], v[64:67]
    ds_read_b128 a[12:15], v7 offset:29696
    v_mfma_f32_16x16x32_bf16 v[68:71], a[36:39], v[176:179], v[68:71]
    ds_read_b128 a[16:19], v7 offset:30720
    s_waitcnt vmcnt(2) lgkmcnt(5)
    v_mfma_f32_16x16x32_bf16 v[52:55], a[40:43], v[180:183], v[52:55]
    ds_read_b128 a[20:23], v7 offset:31744
    v_mfma_f32_16x16x32_bf16 v[56:59], a[44:47], v[180:183], v[56:59]
    ds_read_b128 a[24:27], v7 offset:32768
    v_mfma_f32_16x16x32_bf16 v[60:63], a[48:51], v[180:183], v[60:63]
    ds_read_b128 a[28:31], v7 offset:33792
    v_mfma_f32_16x16x32_bf16 v[64:67], a[52:55], v[180:183], v[64:67]
    ds_read_b128 a[32:35], v7 offset:34816
    v_mfma_f32_16x16x32_bf16 v[68:71], a[56:59], v[180:183], v[68:71]
    ds_read_b128 a[36:39], v7 offset:35840
    s_waitcnt vmcnt(1) lgkmcnt(5)
    v_mfma_f32_16x16x32_bf16 v[52:55], a[0:3], v[184:187], v[52:55]
    v_mfma_f32_16x16x32_bf16 v[56:59], a[4:7], v[184:187], v[56:59]
    v_mfma_f32_16x16x32_bf16 v[60:63], a[8:11], v[184:187], v[60:63]
    v_mfma_f32_16x16x32_bf16 v[64:67], a[12:15], v[184:187], v[64:67]
    v_mfma_f32_16x16x32_bf16 v[68:71], a[16:19], v[184:187], v[68:71]
    s_waitcnt vmcnt(0) lgkmcnt(0)
    v_mfma_f32_16x16x32_bf16 v[52:55], a[20:23], v[188:191], v[52:55]
    v_mfma_f32_16x16x32_bf16 v[56:59], a[24:27], v[188:191], v[56:59]
    v_mfma_f32_16x16x32_bf16 v[60:63], a[28:31], v[188:191], v[60:63]
    v_mfma_f32_16x16x32_bf16 v[64:67], a[32:35], v[188:191], v[64:67]
    v_mfma_f32_16x16x32_bf16 v[68:71], a[36:39], v[188:191], v[68:71]
    v_mov_b32 v0, 13
    ds_write_b32 v45, v0
    s_nop 1
    v_cvt_pk_bf16_f32 v22, v52, v53
    v_cvt_pk_bf16_f32 v23, v54, v55
    v_cvt_pk_bf16_f32 v24, v56, v57
    v_cvt_pk_bf16_f32 v25, v58, v59
    v_cvt_pk_bf16_f32 v26, v60, v61
    v_cvt_pk_bf16_f32 v27, v62, v63
    v_cvt_pk_bf16_f32 v28, v64, v65
    v_cvt_pk_bf16_f32 v29, v66, v67
    v_cvt_pk_bf16_f32 v30, v68, v69
    v_cvt_pk_bf16_f32 v31, v70, v71
    s_mov_b32 s61, 0x3f803f80
    v_mov_b32 v84, 0
    v_mov_b32 v85, 0
    v_mov_b32 v86, 0
    v_mov_b32 v87, 0
    v_dot2c_f32_bf16 v84, s61, v22
    v_dot2c_f32_bf16 v86, v22, v22
    v_dot2c_f32_bf16 v85, s61, v23
    v_dot2c_f32_bf16 v87, v23, v23
    v_dot2c_f32_bf16 v84, s61, v24
    v_dot2c_f32_bf16 v86, v24, v24
    v_dot2c_f32_bf16 v85, s61, v25
    v_dot2c_f32_bf16 v87, v25, v25
    v_dot2c_f32_bf16 v84, s61, v26
    v_dot2c_f32_bf16 v86, v26, v26
    v_dot2c_f32_bf16 v85, s61, v27
    v_dot2c_f32_bf16 v87, v27, v27
    v_dot2c_f32_bf16 v84, s61, v28
    v_dot2c_f32_bf16 v86, v28, v28
    v_dot2c_f32_bf16 v85, s61, v29
    v_dot2c_f32_bf16 v87, v29, v29
    v_dot2c_f32_bf16 v84, s61, v30
    v_dot2c_f32_bf16 v86, v30, v30
    v_dot2c_f32_bf16 v85, s61, v31
    v_dot2c_f32_bf16 v87, v31, v31
    s_cmp_eq_u32 s6, 0
    s_cbranch_scc1 L81
    v_permlane16_swap_b32 v22, v24
    v_permlane16_swap_b32 v23, v25
    buffer_store_dwordx4 v[22:25], v40, s[28:31], s10 offen
    v_permlane16_swap_b32 v26, v28
    v_permlane16_swap_b32 v27, v29
    buffer_store_dwordx4 v[26:29], v40, s[28:31], s10 offen offset:1024
    v_permlane16_swap_b32 v30, v32
    v_permlane16_swap_b32 v31, v33
    buffer_store_dwordx4 v[30:33], v41, s[28:31], s10 offen
    v_add_f32 v84, v84, v85
    v_add_f32 v85, v86, v87
    v_mov_b32 v86, v84
    v_mov_b32 v87, v85
    s_nop 0
    v_permlane32_swap_b32 v84, v86
    v_permlane32_swap_b32 v85, v87
    v_add_f32 v84, v84, v86
    v_add_f32 v85, v85, v87
    v_mov_b32 v86, v84
    v_mov_b32 v87, v85
    s_nop 0
    v_permlane16_swap_b32 v84, v86
    v_permlane16_swap_b32 v85, v87
    v_add_f32 v84, v84, v86
    v_add_f32_e64 v85, v85, v87
    s_mov_b32 s60, 0x2120000
    buffer_store_dwordx2 v[84:85], v42, s[28:31], s60 offen
    s_branch L82
L81:
    v_permlane16_swap_b32 v22, v24
    v_permlane16_swap_b32 v23, v25
    buffer_store_dwordx4 v[22:25], v40, s[28:31], s10 offen sc1
    v_permlane16_swap_b32 v26, v28
    v_permlane16_swap_b32 v27, v29
    buffer_store_dwordx4 v[26:29], v40, s[28:31], s10 offen offset:1024 sc1
    v_permlane16_swap_b32 v30, v32
    v_permlane16_swap_b32 v31, v33
    buffer_store_dwordx4 v[30:33], v41, s[28:31], s10 offen sc1
    v_add_f32 v84, v84, v85
    v_add_f32 v85, v86, v87
    v_mov_b32 v86, v84
    v_mov_b32 v87, v85
    s_nop 0
    v_permlane32_swap_b32 v84, v86
    v_permlane32_swap_b32 v85, v87
    v_add_f32 v84, v84, v86
    v_add_f32 v85, v85, v87
    v_mov_b32 v86, v84
    v_mov_b32 v87, v85
    s_nop 0
    v_permlane16_swap_b32 v84, v86
    v_permlane16_swap_b32 v85, v87
    v_add_f32 v84, v84, v86
    v_add_f32_e64 v85, v85, v87
    s_mov_b32 s60, 0x2120000
    buffer_store_dwordx2 v[84:85], v42, s[28:31], s60 offen sc1
L82:
    s_lshl_b32 s66, s45, 3
    s_lshl_b32 s60, s40, 1
    s_add_u32 s66, s66, s60
    v_and_b32 v106, 15, v1
    v_lshrrev_b32 v107, 3, v106
    v_and_b32 v106, 7, v106
    v_add_u32 v107, s66, v107
    v_lshlrev_b32 v107, 7, v107
    v_lshl_add_u32 v106, v106, 2, v107
    v_add_u32 v108, 0x2214000, v106
    s_mul_i32 s60, s66, 20480
    s_add_u32 s60, s60, s10
    v_add_u32 v113, s60, v2
    v_add_u32 v115, 20480, v113
    s_lshl_b32 s60, s66, 10
    s_add_u32 s60, s60, 0x2120000
    v_lshlrev_b32 v106, 8, v6
    v_lshl_add_u32 v106, v5, 3, v106
    v_add_u32_e64 v127, s60, v106
    s_mul_i32 s60, s66, 57344
    s_mul_i32 s61, s46, 3584
    s_add_u32 s60, s60, s61
    s_add_u32 s60, s60, 0xf00000
    v_add_u32 v117, s60, v36
    v_add_u32 v119, 57344, v117
    v_and_b32_e64 v106, 1, v6
    v_mul_u32_u24 v106, 57344, v106
    v_lshrrev_b32_e64 v107, 1, v6
    v_lshl_add_u32 v106, v107, 8, v106
    v_lshl_add_u32 v106, v5, 4, v106
    s_add_u32 s60, s60, 3072
    v_add_u32 v121, s60, v106
    s_lshr_b32 s60, s66, 1
    s_lshl_b32 s60, s60, 7
    s_lshl_b32 s61, s46, 2
    s_add_u32 s60, s60, s61
    s_add_u32 s60, s60, 0x2218000
    v_mov_b32 v123, s60
    s_waitcnt vmcnt(0)
    s_cmp_eq_u32 s6, 0
    s_cbranch_scc1 L83
    s_mov_b64 exec, 1
    buffer_store_dword v3, v105, s[28:31], 0 offen
    s_mov_b64 exec, -1
    s_branch L84
L83:
    s_mov_b64 exec, 1
    buffer_store_dword v3, v105, s[28:31], 0 offen sc1
    s_mov_b64 exec, -1
L84:
    s_mov_b32 s60, 0
    v_not_b32 v0, v3
L85:
    v_mov_b32_e64 v4, v0
    buffer_load_dword v4, v108, s[28:31], 0 offen sc1
    s_mov_b32 s61, 0
L86:
    v_cmp_eq_u32 vcc, v4, v0
    s_cbranch_vccz L87
    s_add_u32 s61, s61, 1
    s_cmp_lt_u32 s61, 200
    s_cbranch_scc1 L86
L87:
    v_cmp_ne_u32 vcc, v4, v3
    s_cbranch_vccz L88
    s_add_u32 s60, s60, 1
    s_cmp_lt_u32 s60, 400000
    s_cbranch_scc1 L85
L88:
    buffer_load_dwordx2 v[104:105], v127, s[28:31], 0 offen offset:0 sc1
    buffer_load_dwordx2 v[106:107], v127, s[28:31], 0 offen offset:128 sc1
    buffer_load_dwordx2 v[108:109], v127, s[28:31], 0 offen offset:1024 sc1
    buffer_load_dwordx2 v[110:111], v127, s[28:31], 0 offen offset:1152 sc1
    buffer_load_dwordx4 v[128:131], v113, s[28:31], s81 offen offset:0 sc1
    buffer_load_dwordx4 v[132:135], v115, s[28:31], s81 offen offset:0 sc1
    buffer_load_dwordx4 v[136:139], v113, s[28:31], s81 offen offset:1024 sc1
    buffer_load_dwordx4 v[140:143], v115, s[28:31], s81 offen offset:1024 sc1
    buffer_load_dwordx4 v[144:147], v113, s[28:31], s81 offen offset:2048 sc1
    buffer_load_dwordx4 v[148:151], v115, s[28:31], s81 offen offset:2048 sc1
    buffer_load_dwordx4 v[152:155], v113, s[28:31], s81 offen offset:3072 sc1
    buffer_load_dwordx4 v[156:159], v115, s[28:31], s81 offen offset:3072 sc1
    buffer_load_dwordx4 v[160:163], v113, s[28:31], s82 offen offset:0 sc1
    buffer_load_dwordx4 v[164:167], v115, s[28:31], s82 offen offset:0 sc1
    buffer_load_dwordx4 v[168:171], v113, s[28:31], s82 offen offset:1024 sc1
    buffer_load_dwordx4 v[172:175], v115, s[28:31], s82 offen offset:1024 sc1
    buffer_load_dwordx4 v[176:179], v113, s[28:31], s82 offen offset:2048 sc1
    buffer_load_dwordx4 v[180:183], v115, s[28:31], s82 offen offset:2048 sc1
    s_mov_b32 s60, 0
L89:
    ds_read_b64 v[46:47], v39 offset:16
    s_waitcnt lgkmcnt(0)
    v_min_u32 v46, v46, v47
    v_cmp_gt_u32 vcc, 17, v46
    s_cbranch_vccz L90
    s_add_u32 s60, s60, 1
    s_cmp_lt_u32 s60, 3200000
    s_cbranch_scc1 L89
L90:
    ds_read_b128 a[0:3], v2 offset:20480
    ds_read_b128 a[4:7], v2 offset:21504
    ds_read_b128 a[8:11], v2 offset:22528
    ds_read_b128 a[12:15], v2 offset:23552
    ds_read_b128 a[16:19], v2 offset:24576
    ds_read_b128 a[20:23], v2 offset:25600
    ds_read_b128 a[24:27], v2 offset:26624
    s_waitcnt vmcnt(12) lgkmcnt(0)
    v_mfma_f32_16x16x32_bf16 v[48:51], a[0:3], v[128:131], 0
    ds_read_b128 a[28:31], v2 offset:27648
    v_mfma_f32_16x16x32_bf16 v[76:79], a[0:3], v[132:135], 0
    ds_read_b128 a[32:35], v2 offset:28672
    v_mfma_f32_16x16x32_bf16 v[52:55], a[4:7], v[128:131], 0
    ds_read_b128 a[36:39], v2 offset:29696
    v_mfma_f32_16x16x32_bf16 v[80:83], a[4:7], v[132:135], 0
    ds_read_b128 a[40:43], v2 offset:30720
    v_mfma_f32_16x16x32_bf16 v[56:59], a[8:11], v[128:131], 0
    ds_read_b128 a[44:47], v2 offset:31744
    v_mfma_f32_16x16x32_bf16 v[84:87], a[8:11], v[132:135], 0
    ds_read_b128 a[48:51], v2 offset:32768
    v_mfma_f32_16x16x32_bf16 v[60:63], a[12:15], v[128:131], 0
    ds_read_b128 a[52:55], v2 offset:33792
    v_mfma_f32_16x16x32_bf16 v[88:91], a[12:15], v[132:135], 0
    buffer_load_dwordx4 v[184:187], v113, s[28:31], s82 offen offset:3072 sc1
    v_mfma_f32_16x16x32_bf16 v[64:67], a[16:19], v[128:131], 0
    v_mov_b32 v0, 14
    ds_write_b32 v45, v0
    v_mfma_f32_16x16x32_bf16 v[92:95], a[16:19], v[132:135], 0
    v_mfma_f32_16x16x32_bf16 v[68:71], a[20:23], v[128:131], 0
    buffer_load_dwordx4 v[188:191], v115, s[28:31], s82 offen offset:3072 sc1
    v_mfma_f32_16x16x32_bf16 v[96:99], a[20:23], v[132:135], 0
    v_mfma_f32_16x16x32_bf16 v[72:75], a[24:27], v[128:131], 0
    v_mfma_f32_16x16x32_bf16 v[100:103], a[24:27], v[132:135], 0
    s_waitcnt vmcnt(12) lgkmcnt(1)
    v_mfma_f32_16x16x32_bf16 v[48:51], a[28:31], v[136:139], v[48:51]
    ds_read_b128 a[0:3], v2 offset:34816
    v_mfma_f32_16x16x32_bf16 v[76:79], a[28:31], v[140:143], v[76:79]
    ds_read_b128 a[4:7], v2 offset:35840
    v_mfma_f32_16x16x32_bf16 v[52:55], a[32:35], v[136:139], v[52:55]
    ds_read_b128 a[8:11], v2 offset:36864
    v_mfma_f32_16x16x32_bf16 v[80:83], a[32:35], v[140:143], v[80:83]
    ds_read_b128 a[12:15], v2 offset:37888
    v_mfma_f32_16x16x32_bf16 v[56:59], a[36:39], v[136:139], v[56:59]
    ds_read_b128 a[16:19], v2 offset:38912
    v_mfma_f32_16x16x32_bf16 v[84:87], a[36:39], v[140:143], v[84:87]
    ds_read_b128 a[20:23], v2 offset:39936
    v_mfma_f32_16x16x32_bf16 v[60:63], a[40:43], v[136:139], v[60:63]
    ds_read_b128 a[24:27], v2 offset:40960
    v_mfma_f32_16x16x32_bf16 v[88:91], a[40:43], v[140:143], v[88:91]
    buffer_load_dwordx4 v[128:131], v113, s[28:31], s83 offen offset:0 sc1
    v_mfma_f32_16x16x32_bf16 v[64:67], a[44:47], v[136:139], v[64:67]
    v_add_f32 v104, v104, v106
    v_mfma_f32_16x16x32_bf16 v[92:95], a[44:47], v[140:143], v[92:95]
    v_add_f32_e64 v105, v105, v107
    v_mfma_f32_16x16x32_bf16 v[68:71], a[48:51], v[136:139], v[68:71]
    buffer_load_dwordx4 v[132:135], v115, s[28:31], s83 offen offset:0 sc1
    v_mfma_f32_16x16x32_bf16 v[96:99], a[48:51], v[140:143], v[96:99]
    v_mov_b32_e64 v106, v104
    v_mfma_f32_16x16x32_bf16 v[72:75], a[52:55], v[136:139], v[72:75]
    v_mov_b32_e64 v107, v105
    v_mfma_f32_16x16x32_bf16 v[100:103], a[52:55], v[140:143], v[100:103]
    v_permlane32_swap_b32 v104, v106
    s_waitcnt vmcnt(12) lgkmcnt(0)
    v_mfma_f32_16x16x32_bf16 v[48:51], a[0:3], v[144:147], v[48:51]
    ds_read_b128 a[28:31], v2 offset:41984
    v_mfma_f32_16x16x32_bf16 v[76:79], a[0:3], v[148:151], v[76:79]
    ds_read_b128 a[32:35], v2 offset:43008
    v_mfma_f32_16x16x32_bf16 v[52:55], a[4:7], v[144:147], v[52:55]
    ds_read_b128 a[36:39], v2 offset:44032
    v_mfma_f32_16x16x32_bf16 v[80:83], a[4:7], v[148:151], v[80:83]
    ds_read_b128 a[40:43], v2 offset:45056
    v_mfma_f32_16x16x32_bf16 v[56:59], a[8:11], v[144:147], v[56:59]
    ds_read_b128 a[44:47], v2 offset:46080
    v_mfma_f32_16x16x32_bf16 v[84:87], a[8:11], v[148:151], v[84:87]
    ds_read_b128 a[48:51], v2 offset:47104
    v_mfma_f32_16x16x32_bf16 v[60:63], a[12:15], v[144:147], v[60:63]
    ds_read_b128 a[52:55], v2 offset:48128
    v_mfma_f32_16x16x32_bf16 v[88:91], a[12:15], v[148:151], v[88:91]
    buffer_load_dwordx4 v[136:139], v113, s[28:31], s83 offen offset:1024 sc1
    v_mfma_f32_16x16x32_bf16 v[64:67], a[16:19], v[144:147], v[64:67]
    v_permlane32_swap_b32 v105, v107
    v_mfma_f32_16x16x32_bf16 v[92:95], a[16:19], v[148:151], v[92:95]
    v_add_f32 v104, v104, v106
    v_mfma_f32_16x16x32_bf16 v[68:71], a[20:23], v[144:147], v[68:71]
    buffer_load_dwordx4 v[140:143], v115, s[28:31], s83 offen offset:1024 sc1
    v_mfma_f32_16x16x32_bf16 v[96:99], a[20:23], v[148:151], v[96:99]
    v_add_f32_e64 v105, v105, v107
    v_mfma_f32_16x16x32_bf16 v[72:75], a[24:27], v[144:147], v[72:75]
    v_mov_b32_e64 v106, v104
    v_mfma_f32_16x16x32_bf16 v[100:103], a[24:27], v[148:151], v[100:103]
    v_mov_b32 v107, v105
    s_waitcnt vmcnt(12) lgkmcnt(0)
    v_mfma_f32_16x16x32_bf16 v[48:51], a[28:31], v[152:155], v[48:51]
    ds_read_b128 a[0:3], v2 offset:49152
    v_mfma_f32_16x16x32_bf16 v[76:79], a[28:31], v[156:159], v[76:79]
    ds_read_b128 a[4:7], v2 offset:50176
    v_mfma_f32_16x16x32_bf16 v[52:55], a[32:35], v[152:155], v[52:55]
    ds_read_b128 a[8:11], v2 offset:51200
    v_mfma_f32_16x16x32_bf16 v[80:83], a[32:35], v[156:159], v[80:83]
    ds_read_b128 a[12:15], v2 offset:52224
    v_mfma_f32_16x16x32_bf16 v[56:59], a[36:39], v[152:155], v[56:59]
    ds_read_b128 a[16:19], v2 offset:53248
    v_mfma_f32_16x16x32_bf16 v[84:87], a[36:39], v[156:159], v[84:87]
    ds_read_b128 a[20:23], v2 offset:54272
    v_mfma_f32_16x16x32_bf16 v[60:63], a[40:43], v[152:155], v[60:63]
    ds_read_b128 a[24:27], v2 offset:55296
    v_mfma_f32_16x16x32_bf16 v[88:91], a[40:43], v[156:159], v[88:91]
    buffer_load_dwordx4 v[144:147], v113, s[28:31], s83 offen offset:2048 sc1
    v_mfma_f32_16x16x32_bf16 v[64:67], a[44:47], v[152:155], v[64:67]
    v_mov_b32_e64 v0, 15
    ds_write_b32 v45, v0
    v_mfma_f32_16x16x32_bf16 v[92:95], a[44:47], v[156:159], v[92:95]
    v_permlane16_swap_b32 v104, v106
    v_mfma_f32_16x16x32_bf16 v[68:71], a[48:51], v[152:155], v[68:71]
    buffer_load_dwordx4 v[148:151], v115, s[28:31], s83 offen offset:2048 sc1
    v_mfma_f32_16x16x32_bf16 v[96:99], a[48:51], v[156:159], v[96:99]
    v_permlane16_swap_b32 v105, v107
    v_mfma_f32_16x16x32_bf16 v[72:75], a[52:55], v[152:155], v[72:75]
    v_add_f32_e64 v104, v104, v106
    v_mfma_f32_16x16x32_bf16 v[100:103], a[52:55], v[156:159], v[100:103]
    v_add_f32 v105, v105, v107
    s_waitcnt vmcnt(12) lgkmcnt(1)
    v_mfma_f32_16x16x32_bf16 v[48:51], a[0:3], v[160:163], v[48:51]
    ds_read_b128 a[28:31], v2 offset:56320
    v_mfma_f32_16x16x32_bf16 v[76:79], a[0:3], v[164:167], v[76:79]
    ds_read_b128 a[32:35], v2 offset:57344
    v_mfma_f32_16x16x32_bf16 v[52:55], a[4:7], v[160:163], v[52:55]
    ds_read_b128 a[36:39], v2 offset:58368
    v_mfma_f32_16x16x32_bf16 v[80:83], a[4:7], v[164:167], v[80:83]
    ds_read_b128 a[40:43], v2 offset:59392
    v_mfma_f32_16x16x32_bf16 v[56:59], a[8:11], v[160:163], v[56:59]
    ds_read_b128 a[44:47], v2 offset:60416
    v_mfma_f32_16x16x32_bf16 v[84:87], a[8:11], v[164:167], v[84:87]
    ds_read_b128 a[48:51], v2 offset:61440
    v_mfma_f32_16x16x32_bf16 v[60:63], a[12:15], v[160:163], v[60:63]
    ds_read_b128 a[52:55], v2 offset:62464
    v_mfma_f32_16x16x32_bf16 v[88:91], a[12:15], v[164:167], v[88:91]
    buffer_load_dwordx4 v[152:155], v113, s[28:31], s83 offen offset:3072 sc1
    v_mfma_f32_16x16x32_bf16 v[64:67], a[16:19], v[160:163], v[64:67]
    v_mul_f32 v112, 0x3acccccd, v104
    v_mfma_f32_16x16x32_bf16 v[92:95], a[16:19], v[164:167], v[92:95]
    v_mul_f32 v105, 0x3acccccd, v105
    v_mfma_f32_16x16x32_bf16 v[68:71], a[20:23], v[160:163], v[68:71]
    buffer_load_dwordx4 v[156:159], v115, s[28:31], s83 offen offset:3072 sc1
    v_mfma_f32_16x16x32_bf16 v[96:99], a[20:23], v[164:167], v[96:99]
    v_fma_f32 v105, -v112, v112, v105
    v_mfma_f32_16x16x32_bf16 v[72:75], a[24:27], v[160:163], v[72:75]
    v_max_f32_e64 v105, 0, v105
    v_mfma_f32_16x16x32_bf16 v[100:103], a[24:27], v[164:167], v[100:103]
    v_add_f32 v104, 0x3727c5ac, v105
    s_waitcnt vmcnt(12) lgkmcnt(0)
    v_mfma_f32_16x16x32_bf16 v[48:51], a[28:31], v[168:171], v[48:51]
    ds_read_b128 a[0:3], v2 offset:63488
    v_mfma_f32_16x16x32_bf16 v[76:79], a[28:31], v[172:175], v[76:79]
    ds_read_b128 a[4:7], v2 offset:64512
    v_mfma_f32_16x16x32_bf16 v[52:55], a[32:35], v[168:171], v[52:55]
    ds_read_b128 a[8:11], v7 offset:0
    v_mfma_f32_16x16x32_bf16 v[80:83], a[32:35], v[172:175], v[80:83]
    ds_read_b128 a[12:15], v7 offset:1024
    v_mfma_f32_16x16x32_bf16 v[56:59], a[36:39], v[168:171], v[56:59]
    ds_read_b128 a[16:19], v7 offset:2048
    v_mfma_f32_16x16x32_bf16 v[84:87], a[36:39], v[172:175], v[84:87]
    ds_read_b128 a[20:23], v7 offset:3072
    v_mfma_f32_16x16x32_bf16 v[60:63], a[40:43], v[168:171], v[60:63]
    ds_read_b128 a[24:27], v7 offset:4096
    v_mfma_f32_16x16x32_bf16 v[88:91], a[40:43], v[172:175], v[88:91]
    buffer_load_dwordx4 v[160:163], v113, s[28:31], s84 offen offset:0 sc1
    v_mfma_f32_16x16x32_bf16 v[64:67], a[44:47], v[168:171], v[64:67]
    v_rsq_f32 v106, v104
    v_mfma_f32_16x16x32_bf16 v[92:95], a[44:47], v[172:175], v[92:95]
    v_sqrt_f32_e64 v124, v104
    v_mfma_f32_16x16x32_bf16 v[68:71], a[48:51], v[168:171], v[68:71]
    buffer_load_dwordx4 v[164:167], v115, s[28:31], s84 offen offset:0 sc1
    v_mfma_f32_16x16x32_bf16 v[96:99], a[48:51], v[172:175], v[96:99]
    v_mul_f32 v116, 0xc0135761, v106
    v_mfma_f32_16x16x32_bf16 v[72:75], a[52:55], v[168:171], v[72:75]
    v_mul_f32_e64 v107, v106, v106
    v_mfma_f32_16x16x32_bf16 v[100:103], a[52:55], v[172:175], v[100:103]
    v_mul_f32 v107, v107, v106
    s_waitcnt vmcnt(12) lgkmcnt(0)
    v_mfma_f32_16x16x32_bf16 v[48:51], a[0:3], v[176:179], v[48:51]
    ds_read_b64 v[46:47], v39 offset:16
    ds_read_b128 a[28:31], v7 offset:5120
    v_mfma_f32_16x16x32_bf16 v[76:79], a[0:3], v[180:183], v[76:79]
    ds_read_b128 a[32:35], v7 offset:6144
    v_mfma_f32_16x16x32_bf16 v[52:55], a[4:7], v[176:179], v[52:55]
    ds_read_b128 a[36:39], v7 offset:7168
    v_mfma_f32_16x16x32_bf16 v[80:83], a[4:7], v[180:183], v[80:83]
    ds_read_b128 a[40:43], v7 offset:8192
    v_mfma_f32_16x16x32_bf16 v[56:59], a[8:11], v[176:179], v[56:59]
    ds_read_b128 a[44:47], v7 offset:9216
    v_mfma_f32_16x16x32_bf16 v[84:87], a[8:11], v[180:183], v[84:87]
    ds_read_b128 a[48:51], v7 offset:10240
    v_mfma_f32_16x16x32_bf16 v[60:63], a[12:15], v[176:179], v[60:63]
    ds_read_b128 a[52:55], v7 offset:11264
    v_mfma_f32_16x16x32_bf16 v[88:91], a[12:15], v[180:183], v[88:91]
    buffer_load_dwordx4 v[168:171], v113, s[28:31], s84 offen offset:1024 sc1
    v_mfma_f32_16x16x32_bf16 v[64:67], a[16:19], v[176:179], v[64:67]
    v_mul_f32 v120, 0xbdd2d3e8, v107
    v_mfma_f32_16x16x32_bf16 v[92:95], a[16:19], v[180:183], v[92:95]
    v_add_f32_e64 v108, v108, v110
    v_mfma_f32_16x16x32_bf16 v[68:71], a[20:23], v[176:179], v[68:71]
    buffer_load_dwordx4 v[172:175], v115, s[28:31], s84 offen offset:1024 sc1
    v_mfma_f32_16x16x32_bf16 v[96:99], a[20:23], v[180:183], v[96:99]
    v_add_f32_e64 v109, v109, v111
    v_mfma_f32_16x16x32_bf16 v[72:75], a[24:27], v[176:179], v[72:75]
    s_waitcnt lgkmcnt(7)
    v_min_u32 v46, v46, v47
    v_cmp_gt_u32 vcc, 18, v46
    s_cbranch_vccz L92
    s_mov_b32 s60, 0
L91:
    ds_read_b64 v[46:47], v39 offset:16
    s_waitcnt lgkmcnt(0)
    v_min_u32 v46, v46, v47
    v_cmp_gt_u32 vcc, 18, v46
    s_cbranch_vccz L92
    s_add_u32 s60, s60, 1
    s_cmp_lt_u32 s60, 3200000
    s_cbranch_scc1 L91
L92:
    v_mfma_f32_16x16x32_bf16 v[100:103], a[24:27], v[180:183], v[100:103]
    v_mov_b32 v110, v108
    s_waitcnt vmcnt(12) lgkmcnt(0)
    v_mfma_f32_16x16x32_bf16 v[48:51], a[28:31], v[184:187], v[48:51]
    ds_read_b128 a[0:3], v7 offset:12288
    v_mfma_f32_16x16x32_bf16 v[76:79], a[28:31], v[188:191], v[76:79]
    ds_read_b128 a[4:7], v7 offset:13312
    v_mfma_f32_16x16x32_bf16 v[52:55], a[32:35], v[184:187], v[52:55]
    ds_read_b128 a[8:11], v7 offset:14336
    v_mfma_f32_16x16x32_bf16 v[80:83], a[32:35], v[188:191], v[80:83]
    ds_read_b128 a[12:15], v7 offset:15360
    v_mfma_f32_16x16x32_bf16 v[56:59], a[36:39], v[184:187], v[56:59]
    ds_read_b128 a[16:19], v7 offset:16384
    v_mfma_f32_16x16x32_bf16 v[84:87], a[36:39], v[188:191], v[84:87]
    ds_read_b128 a[20:23], v7 offset:17408
    v_mfma_f32_16x16x32_bf16 v[60:63], a[40:43], v[184:187], v[60:63]
    ds_read_b128 a[24:27], v7 offset:18432
    v_mfma_f32_16x16x32_bf16 v[88:91], a[40:43], v[188:191], v[88:91]
    buffer_load_dwordx4 v[176:179], v113, s[28:31], s84 offen offset:2048 sc1
    v_mfma_f32_16x16x32_bf16 v[64:67], a[44:47], v[184:187], v[64:67]
    v_mov_b32 v0, 16
    ds_write_b32 v45, v0
    v_mfma_f32_16x16x32_bf16 v[92:95], a[44:47], v[188:191], v[92:95]
    v_mov_b32_e64 v111, v109
    v_mfma_f32_16x16x32_bf16 v[68:71], a[48:51], v[184:187], v[68:71]
    buffer_load_dwordx4 v[180:183], v115, s[28:31], s84 offen offset:2048 sc1
    v_mfma_f32_16x16x32_bf16 v[96:99], a[48:51], v[188:191], v[96:99]
    v_permlane32_swap_b32 v108, v110
    v_mfma_f32_16x16x32_bf16 v[72:75], a[52:55], v[184:187], v[72:75]
    v_permlane32_swap_b32 v109, v111
    v_mfma_f32_16x16x32_bf16 v[100:103], a[52:55], v[188:191], v[100:103]
    v_add_f32 v108, v108, v110
    s_waitcnt vmcnt(12) lgkmcnt(1)
    v_mfma_f32_16x16x32_bf16 v[48:51], a[0:3], v[128:131], v[48:51]
    ds_read_b128 a[28:31], v7 offset:19456
    v_mfma_f32_16x16x32_bf16 v[76:79], a[0:3], v[132:135], v[76:79]
    ds_read_b128 a[32:35], v7 offset:20480
    v_mfma_f32_16x16x32_bf16 v[52:55], a[4:7], v[128:131], v[52:55]
    ds_read_b128 a[36:39], v7 offset:21504
    v_mfma_f32_16x16x32_bf16 v[80:83], a[4:7], v[132:135], v[80:83]
    ds_read_b128 a[40:43], v7 offset:22528
    v_mfma_f32_16x16x32_bf16 v[56:59], a[8:11], v[128:131], v[56:59]
    ds_read_b128 a[44:47], v7 offset:23552
    v_mfma_f32_16x16x32_bf16 v[84:87], a[8:11], v[132:135], v[84:87]
    ds_read_b128 a[48:51], v7 offset:24576
    v_mfma_f32_16x16x32_bf16 v[60:63], a[12:15], v[128:131], v[60:63]
    ds_read_b128 a[52:55], v7 offset:25600
    v_mfma_f32_16x16x32_bf16 v[88:91], a[12:15], v[132:135], v[88:91]
    buffer_load_dwordx4 v[184:187], v113, s[28:31], s84 offen offset:3072 sc1
    v_mfma_f32_16x16x32_bf16 v[64:67], a[16:19], v[128:131], v[64:67]
    v_add_f32_e64 v109, v109, v111
    v_mfma_f32_16x16x32_bf16 v[92:95], a[16:19], v[132:135], v[92:95]
    v_mov_b32_e64 v110, v108
    v_mfma_f32_16x16x32_bf16 v[68:71], a[20:23], v[128:131], v[68:71]
    buffer_load_dwordx4 v[188:191], v115, s[28:31], s84 offen offset:3072 sc1
    v_mfma_f32_16x16x32_bf16 v[96:99], a[20:23], v[132:135], v[96:99]
    v_mov_b32_e64 v111, v109
    v_mfma_f32_16x16x32_bf16 v[72:75], a[24:27], v[128:131], v[72:75]
    v_permlane16_swap_b32 v108, v110
    v_mfma_f32_16x16x32_bf16 v[100:103], a[24:27], v[132:135], v[100:103]
    v_permlane16_swap_b32 v109, v111
    s_waitcnt vmcnt(12) lgkmcnt(0)
    v_mfma_f32_16x16x32_bf16 v[48:51], a[28:31], v[136:139], v[48:51]
    ds_read_b128 a[0:3], v7 offset:26624
    v_mfma_f32_16x16x32_bf16 v[76:79], a[28:31], v[140:143], v[76:79]
    ds_read_b128 a[4:7], v7 offset:27648
    v_mfma_f32_16x16x32_bf16 v[52:55], a[32:35], v[136:139], v[52:55]
    ds_read_b128 a[8:11], v7 offset:28672
    v_mfma_f32_16x16x32_bf16 v[80:83], a[32:35], v[140:143], v[80:83]
    ds_read_b128 a[12:15], v7 offset:29696
    v_mfma_f32_16x16x32_bf16 v[56:59], a[36:39], v[136:139], v[56:59]
    ds_read_b128 a[16:19], v7 offset:30720
    v_mfma_f32_16x16x32_bf16 v[84:87], a[36:39], v[140:143], v[84:87]
    ds_read_b128 a[20:23], v7 offset:31744
    v_mfma_f32_16x16x32_bf16 v[60:63], a[40:43], v[136:139], v[60:63]
    ds_read_b128 a[24:27], v7 offset:32768
    v_mfma_f32_16x16x32_bf16 v[88:91], a[40:43], v[140:143], v[88:91]
    buffer_load_dwordx4 v[128:131], v113, s[28:31], s85 offen offset:0 sc1
    v_mfma_f32_16x16x32_bf16 v[64:67], a[44:47], v[136:139], v[64:67]
    v_add_f32 v108, v108, v110
    v_mfma_f32_16x16x32_bf16 v[92:95], a[44:47], v[140:143], v[92:95]
    v_add_f32_e64 v109, v109, v111
    v_mfma_f32_16x16x32_bf16 v[68:71], a[48:51], v[136:139], v[68:71]
    buffer_load_dwordx4 v[132:135], v115, s[28:31], s85 offen offset:0 sc1
    v_mfma_f32_16x16x32_bf16 v[96:99], a[48:51], v[140:143], v[96:99]
    v_mul_f32 v114, 0x3acccccd, v108
    v_mfma_f32_16x16x32_bf16 v[72:75], a[52:55], v[136:139], v[72:75]
    v_mul_f32 v109, 0x3acccccd, v109
    v_mfma_f32_16x16x32_bf16 v[100:103], a[52:55], v[140:143], v[100:103]
    v_fma_f32 v109, -v114, v114, v109
    s_waitcnt vmcnt(12) lgkmcnt(0)
    v_mfma_f32_16x16x32_bf16 v[48:51], a[0:3], v[144:147], v[48:51]
    ds_read_b64 v[46:47], v39 offset:16
    ds_read_b128 a[28:31], v7 offset:33792
    v_mfma_f32_16x16x32_bf16 v[76:79], a[0:3], v[148:151], v[76:79]
    ds_read_b128 a[32:35], v7 offset:34816
    v_mfma_f32_16x16x32_bf16 v[52:55], a[4:7], v[144:147], v[52:55]
    ds_read_b128 a[36:39], v7 offset:35840
    v_mfma_f32_16x16x32_bf16 v[80:83], a[4:7], v[148:151], v[80:83]
    ds_read_b128 a[40:43], v7 offset:36864
    v_mfma_f32_16x16x32_bf16 v[56:59], a[8:11], v[144:147], v[56:59]
    ds_read_b128 a[44:47], v7 offset:37888
    v_mfma_f32_16x16x32_bf16 v[84:87], a[8:11], v[148:151], v[84:87]
    ds_read_b128 a[48:51], v7 offset:38912
    v_mfma_f32_16x16x32_bf16 v[60:63], a[12:15], v[144:147], v[60:63]
    ds_read_b128 a[52:55], v7 offset:39936
    v_mfma_f32_16x16x32_bf16 v[88:91], a[12:15], v[148:151], v[88:91]
    buffer_load_dwordx4 v[136:139], v113, s[28:31], s85 offen offset:1024 sc1
    v_mfma_f32_16x16x32_bf16 v[64:67], a[16:19], v[144:147], v[64:67]
    v_max_f32 v109, 0, v109
    v_mfma_f32_16x16x32_bf16 v[92:95], a[16:19], v[148:151], v[92:95]
    v_add_f32 v108, 0x3727c5ac, v109
    v_mfma_f32_16x16x32_bf16 v[68:71], a[20:23], v[144:147], v[68:71]
    buffer_load_dwordx4 v[140:143], v115, s[28:31], s85 offen offset:1024 sc1
    v_mfma_f32_16x16x32_bf16 v[96:99], a[20:23], v[148:151], v[96:99]
    v_rsq_f32_e64 v110, v108
    v_mfma_f32_16x16x32_bf16 v[72:75], a[24:27], v[144:147], v[72:75]
    s_waitcnt lgkmcnt(7)
    v_min_u32 v46, v46, v47
    v_cmp_gt_u32 vcc, 19, v46
    s_cbranch_vccz L94
    s_mov_b32 s60, 0
L93:
    ds_read_b64 v[46:47], v39 offset:16
    s_waitcnt lgkmcnt(0)
    v_min_u32 v46, v46, v47
    v_cmp_gt_u32 vcc, 19, v46
    s_cbranch_vccz L94
    s_add_u32 s60, s60, 1
    s_cmp_lt_u32 s60, 3200000
    s_cbranch_scc1 L93
L94:
    v_mfma_f32_16x16x32_bf16 v[100:103], a[24:27], v[148:151], v[100:103]
    v_sqrt_f32 v126, v108
    s_waitcnt vmcnt(12) lgkmcnt(0)
    v_mfma_f32_16x16x32_bf16 v[48:51], a[28:31], v[152:155], v[48:51]
    ds_read_b128 a[0:3], v7 offset:40960
    v_mfma_f32_16x16x32_bf16 v[76:79], a[28:31], v[156:159], v[76:79]
    ds_read_b128 a[4:7], v7 offset:41984
    v_mfma_f32_16x16x32_bf16 v[52:55], a[32:35], v[152:155], v[52:55]
    ds_read_b128 a[8:11], v7 offset:43008
    v_mfma_f32_16x16x32_bf16 v[80:83], a[32:35], v[156:159], v[80:83]
    ds_read_b128 a[12:15], v7 offset:44032
    v_mfma_f32_16x16x32_bf16 v[56:59], a[36:39], v[152:155], v[56:59]
    ds_read_b128 a[16:19], v7 offset:45056
    v_mfma_f32_16x16x32_bf16 v[84:87], a[36:39], v[156:159], v[84:87]
    ds_read_b128 a[20:23], v7 offset:46080
    v_mfma_f32_16x16x32_bf16 v[60:63], a[40:43], v[152:155], v[60:63]
    ds_read_b128 a[24:27], v7 offset:47104
    v_mfma_f32_16x16x32_bf16 v[88:91], a[40:43], v[156:159], v[88:91]
    buffer_load_dwordx4 v[144:147], v113, s[28:31], s85 offen offset:2048 sc1
    v_mfma_f32_16x16x32_bf16 v[64:67], a[44:47], v[152:155], v[64:67]
    v_mov_b32 v0, 17
    ds_write_b32 v45, v0
    v_mfma_f32_16x16x32_bf16 v[92:95], a[44:47], v[156:159], v[92:95]
    v_mul_f32 v118, 0xc0135761, v110
    v_mfma_f32_16x16x32_bf16 v[68:71], a[48:51], v[152:155], v[68:71]
    buffer_load_dwordx4 v[148:151], v115, s[28:31], s85 offen offset:2048 sc1
    v_mfma_f32_16x16x32_bf16 v[96:99], a[48:51], v[156:159], v[96:99]
    v_mul_f32_e64 v111, v110, v110
    v_mfma_f32_16x16x32_bf16 v[72:75], a[52:55], v[152:155], v[72:75]
    v_mul_f32_e64 v111, v111, v110
    v_mfma_f32_16x16x32_bf16 v[100:103], a[52:55], v[156:159], v[100:103]
    v_mul_f32 v122, 0xbdd2d3e8, v111
    s_waitcnt vmcnt(12) lgkmcnt(1)
    v_mfma_f32_16x16x32_bf16 v[48:51], a[0:3], v[160:163], v[48:51]
    ds_read_b128 a[28:31], v7 offset:48128
    v_mfma_f32_16x16x32_bf16 v[76:79], a[0:3], v[164:167], v[76:79]
    ds_read_b128 a[32:35], v7 offset:49152
    v_mfma_f32_16x16x32_bf16 v[52:55], a[4:7], v[160:163], v[52:55]
    ds_read_b128 a[36:39], v7 offset:50176
    v_mfma_f32_16x16x32_bf16 v[80:83], a[4:7], v[164:167], v[80:83]
    ds_read_b128 a[40:43], v7 offset:51200
    v_mfma_f32_16x16x32_bf16 v[56:59], a[8:11], v[160:163], v[56:59]
    ds_read_b128 a[44:47], v7 offset:52224
    v_mfma_f32_16x16x32_bf16 v[84:87], a[8:11], v[164:167], v[84:87]
    ds_read_b128 a[48:51], v7 offset:53248
    v_mfma_f32_16x16x32_bf16 v[60:63], a[12:15], v[160:163], v[60:63]
    ds_read_b128 a[52:55], v7 offset:54272
    v_mfma_f32_16x16x32_bf16 v[88:91], a[12:15], v[164:167], v[88:91]
    buffer_load_dwordx4 v[152:155], v113, s[28:31], s85 offen offset:3072 sc1
    v_mfma_f32_16x16x32_bf16 v[64:67], a[16:19], v[160:163], v[64:67]
    v_mfma_f32_16x16x32_bf16 v[92:95], a[16:19], v[164:167], v[92:95]
    v_mfma_f32_16x16x32_bf16 v[68:71], a[20:23], v[160:163], v[68:71]
    buffer_load_dwordx4 v[156:159], v115, s[28:31], s85 offen offset:3072 sc1
    v_mfma_f32_16x16x32_bf16 v[96:99], a[20:23], v[164:167], v[96:99]
    v_mfma_f32_16x16x32_bf16 v[72:75], a[24:27], v[160:163], v[72:75]
    v_mfma_f32_16x16x32_bf16 v[100:103], a[24:27], v[164:167], v[100:103]
    s_waitcnt vmcnt(12) lgkmcnt(0)
    v_mfma_f32_16x16x32_bf16 v[48:51], a[28:31], v[168:171], v[48:51]
    ds_read_b128 a[0:3], v7 offset:55296
    v_mfma_f32_16x16x32_bf16 v[76:79], a[28:31], v[172:175], v[76:79]
    ds_read_b128 a[4:7], v7 offset:56320
    v_mfma_f32_16x16x32_bf16 v[52:55], a[32:35], v[168:171], v[52:55]
    ds_read_b128 a[8:11], v7 offset:57344
    v_mfma_f32_16x16x32_bf16 v[80:83], a[32:35], v[172:175], v[80:83]
    ds_read_b128 a[12:15], v7 offset:58368
    v_mfma_f32_16x16x32_bf16 v[56:59], a[36:39], v[168:171], v[56:59]
    ds_read_b128 a[16:19], v7 offset:59392
    v_mfma_f32_16x16x32_bf16 v[84:87], a[36:39], v[172:175], v[84:87]
    ds_read_b128 a[20:23], v7 offset:60416
    v_mfma_f32_16x16x32_bf16 v[60:63], a[40:43], v[168:171], v[60:63]
    ds_read_b128 a[24:27], v7 offset:61440
    v_mfma_f32_16x16x32_bf16 v[88:91], a[40:43], v[172:175], v[88:91]
    v_mfma_f32_16x16x32_bf16 v[64:67], a[44:47], v[168:171], v[64:67]
    v_mfma_f32_16x16x32_bf16 v[92:95], a[44:47], v[172:175], v[92:95]
    v_mfma_f32_16x16x32_bf16 v[68:71], a[48:51], v[168:171], v[68:71]
    v_mfma_f32_16x16x32_bf16 v[96:99], a[48:51], v[172:175], v[96:99]
    v_mfma_f32_16x16x32_bf16 v[72:75], a[52:55], v[168:171], v[72:75]
    v_mfma_f32_16x16x32_bf16 v[100:103], a[52:55], v[172:175], v[100:103]
    s_waitcnt vmcnt(10) lgkmcnt(0)
    v_mfma_f32_16x16x32_bf16 v[48:51], a[0:3], v[176:179], v[48:51]
    ds_read_b64 v[46:47], v39 offset:16
    ds_read_b128 a[28:31], v7 offset:62464
    v_mfma_f32_16x16x32_bf16 v[76:79], a[0:3], v[180:183], v[76:79]
    ds_read_b128 a[32:35], v7 offset:63488
    v_mfma_f32_16x16x32_bf16 v[52:55], a[4:7], v[176:179], v[52:55]
    ds_read_b128 a[36:39], v7 offset:64512
    v_mfma_f32_16x16x32_bf16 v[80:83], a[4:7], v[180:183], v[80:83]
    ds_read_b128 a[40:43], v8 offset:0
    v_mfma_f32_16x16x32_bf16 v[56:59], a[8:11], v[176:179], v[56:59]
    ds_read_b128 a[44:47], v8 offset:1024
    v_mfma_f32_16x16x32_bf16 v[84:87], a[8:11], v[180:183], v[84:87]
    ds_read_b128 a[48:51], v8 offset:2048
    v_mfma_f32_16x16x32_bf16 v[60:63], a[12:15], v[176:179], v[60:63]
    ds_read_b128 a[52:55], v8 offset:3072
    v_mfma_f32_16x16x32_bf16 v[88:91], a[12:15], v[180:183], v[88:91]
    v_mfma_f32_16x16x32_bf16 v[64:67], a[16:19], v[176:179], v[64:67]
    v_mfma_f32_16x16x32_bf16 v[92:95], a[16:19], v[180:183], v[92:95]
    v_mfma_f32_16x16x32_bf16 v[68:71], a[20:23], v[176:179], v[68:71]
    v_mfma_f32_16x16x32_bf16 v[96:99], a[20:23], v[180:183], v[96:99]
    v_mfma_f32_16x16x32_bf16 v[72:75], a[24:27], v[176:179], v[72:75]
    s_waitcnt lgkmcnt(7)
    v_min_u32 v46, v46, v47
    v_cmp_gt_u32 vcc, 20, v46
    s_cbranch_vccz L96
    s_mov_b32 s60, 0
L95:
    ds_read_b64 v[46:47], v39 offset:16
    s_waitcnt lgkmcnt(0)
    v_min_u32 v46, v46, v47
    v_cmp_gt_u32 vcc, 20, v46
    s_cbranch_vccz L96
    s_add_u32 s60, s60, 1
    s_cmp_lt_u32 s60, 3200000
    s_cbranch_scc1 L95
L96:
    v_mfma_f32_16x16x32_bf16 v[100:103], a[24:27], v[180:183], v[100:103]
    s_waitcnt vmcnt(8) lgkmcnt(0)
    v_mfma_f32_16x16x32_bf16 v[48:51], a[28:31], v[184:187], v[48:51]
    ds_read_b128 a[0:3], v2 offset:0
    v_mfma_f32_16x16x32_bf16 v[76:79], a[28:31], v[188:191], v[76:79]
    ds_read_b128 a[4:7], v2 offset:1024
    v_mfma_f32_16x16x32_bf16 v[52:55], a[32:35], v[184:187], v[52:55]
    ds_read_b128 a[8:11], v2 offset:2048
    v_mfma_f32_16x16x32_bf16 v[80:83], a[32:35], v[188:191], v[80:83]
    ds_read_b128 a[12:15], v2 offset:3072
    v_mfma_f32_16x16x32_bf16 v[56:59], a[36:39], v[184:187], v[56:59]
    ds_read_b128 a[16:19], v2 offset:4096
    v_mfma_f32_16x16x32_bf16 v[84:87], a[36:39], v[188:191], v[84:87]
    ds_read_b128 a[20:23], v2 offset:5120
    v_mfma_f32_16x16x32_bf16 v[60:63], a[40:43], v[184:187], v[60:63]
    ds_read_b128 a[24:27], v2 offset:6144
    v_mfma_f32_16x16x32_bf16 v[88:91], a[40:43], v[188:191], v[88:91]
    v_mfma_f32_16x16x32_bf16 v[64:67], a[44:47], v[184:187], v[64:67]
    v_mov_b32 v0, 18
    ds_write_b32 v45, v0
    v_mfma_f32_16x16x32_bf16 v[92:95], a[44:47], v[188:191], v[92:95]
    v_mfma_f32_16x16x32_bf16 v[68:71], a[48:51], v[184:187], v[68:71]
    v_mfma_f32_16x16x32_bf16 v[96:99], a[48:51], v[188:191], v[96:99]
    v_mfma_f32_16x16x32_bf16 v[72:75], a[52:55], v[184:187], v[72:75]
    v_mfma_f32_16x16x32_bf16 v[100:103], a[52:55], v[188:191], v[100:103]
    s_waitcnt vmcnt(6) lgkmcnt(1)
    v_mfma_f32_16x16x32_bf16 v[48:51], a[0:3], v[128:131], v[48:51]
    ds_read_b64 v[46:47], v39 offset:24
    ds_read_b128 a[28:31], v2 offset:7168
    v_mfma_f32_16x16x32_bf16 v[76:79], a[0:3], v[132:135], v[76:79]
    ds_read_b128 a[32:35], v2 offset:8192
    v_mfma_f32_16x16x32_bf16 v[52:55], a[4:7], v[128:131], v[52:55]
    ds_read_b128 a[36:39], v2 offset:9216
    v_mfma_f32_16x16x32_bf16 v[80:83], a[4:7], v[132:135], v[80:83]
    ds_read_b128 a[40:43], v2 offset:10240
    v_mfma_f32_16x16x32_bf16 v[56:59], a[8:11], v[128:131], v[56:59]
    ds_read_b128 a[44:47], v2 offset:11264
    v_mfma_f32_16x16x32_bf16 v[84:87], a[8:11], v[132:135], v[84:87]
    ds_read_b128 a[48:51], v2 offset:12288
    v_mfma_f32_16x16x32_bf16 v[60:63], a[12:15], v[128:131], v[60:63]
    ds_read_b128 a[52:55], v2 offset:13312
    v_mfma_f32_16x16x32_bf16 v[88:91], a[12:15], v[132:135], v[88:91]
    v_mfma_f32_16x16x32_bf16 v[64:67], a[16:19], v[128:131], v[64:67]
    v_mfma_f32_16x16x32_bf16 v[92:95], a[16:19], v[132:135], v[92:95]
    v_lshlrev_b32 v127, 4, v6
    v_add_u32 v127, 163264, v127
    v_mfma_f32_16x16x32_bf16 v[68:71], a[20:23], v[128:131], v[68:71]
    v_mfma_f32_16x16x32_bf16 v[96:99], a[20:23], v[132:135], v[96:99]
    v_mfma_f32_16x16x32_bf16 v[72:75], a[24:27], v[128:131], v[72:75]
    s_waitcnt lgkmcnt(7)
    v_min_u32 v46, v46, v47
    v_cmp_gt_u32 vcc, 6, v46
    s_cbranch_vccz L98
    s_mov_b32 s60, 0
L97:
    ds_read_b64 v[46:47], v39 offset:24
    s_waitcnt lgkmcnt(0)
    v_min_u32 v46, v46, v47
    v_cmp_gt_u32 vcc, 6, v46
    s_cbranch_vccz L98
    s_add_u32 s60, s60, 1
    s_cmp_lt_u32 s60, 3200000
    s_cbranch_scc1 L97
L98:
    v_mfma_f32_16x16x32_bf16 v[100:103], a[24:27], v[132:135], v[100:103]
    s_waitcnt vmcnt(4) lgkmcnt(0)
    v_mfma_f32_16x16x32_bf16 v[48:51], a[28:31], v[136:139], v[48:51]
    ds_read_b128 a[0:3], v2 offset:14336
    v_mfma_f32_16x16x32_bf16 v[76:79], a[28:31], v[140:143], v[76:79]
    ds_read_b128 a[4:7], v2 offset:15360
    v_mfma_f32_16x16x32_bf16 v[52:55], a[32:35], v[136:139], v[52:55]
    ds_read_b128 a[8:11], v2 offset:16384
    v_mfma_f32_16x16x32_bf16 v[80:83], a[32:35], v[140:143], v[80:83]
    ds_read_b128 a[12:15], v2 offset:17408
    v_mfma_f32_16x16x32_bf16 v[56:59], a[36:39], v[136:139], v[56:59]
    ds_read_b128 a[16:19], v2 offset:18432
    v_mfma_f32_16x16x32_bf16 v[84:87], a[36:39], v[140:143], v[84:87]
    ds_read_b128 a[20:23], v2 offset:19456
    v_mfma_f32_16x16x32_bf16 v[60:63], a[40:43], v[136:139], v[60:63]
    ds_read_b128 a[24:27], v8 offset:4096
    v_mfma_f32_16x16x32_bf16 v[88:91], a[40:43], v[140:143], v[88:91]
    v_mfma_f32_16x16x32_bf16 v[64:67], a[44:47], v[136:139], v[64:67]
    v_mfma_f32_16x16x32_bf16 v[92:95], a[44:47], v[140:143], v[92:95]
    v_mfma_f32_16x16x32_bf16 v[68:71], a[48:51], v[136:139], v[68:71]
    v_mfma_f32_16x16x32_bf16 v[96:99], a[48:51], v[140:143], v[96:99]
    v_mfma_f32_16x16x32_bf16 v[72:75], a[52:55], v[136:139], v[72:75]
    v_mfma_f32_16x16x32_bf16 v[100:103], a[52:55], v[140:143], v[100:103]
    s_waitcnt vmcnt(2) lgkmcnt(0)
    v_mfma_f32_16x16x32_bf16 v[48:51], a[0:3], v[144:147], v[48:51]
    ds_read_b128 a[28:31], v8 offset:5120
    v_mfma_f32_16x16x32_bf16 v[76:79], a[0:3], v[148:151], v[76:79]
    ds_read_b128 a[32:35], v8 offset:6144
    v_mfma_f32_16x16x32_bf16 v[52:55], a[4:7], v[144:147], v[52:55]
    ds_read_b128 a[36:39], v8 offset:7168
    v_mfma_f32_16x16x32_bf16 v[80:83], a[4:7], v[148:151], v[80:83]
    ds_read_b128 a[40:43], v8 offset:8192
    v_mfma_f32_16x16x32_bf16 v[56:59], a[8:11], v[144:147], v[56:59]
    ds_read_b128 a[44:47], v8 offset:9216
    v_mfma_f32_16x16x32_bf16 v[84:87], a[8:11], v[148:151], v[84:87]
    ds_read_b128 a[48:51], v8 offset:10240
    v_mfma_f32_16x16x32_bf16 v[60:63], a[12:15], v[144:147], v[60:63]
    ds_read_b128 a[52:55], v8 offset:11264
    v_mfma_f32_16x16x32_bf16 v[88:91], a[12:15], v[148:151], v[88:91]
    v_mfma_f32_16x16x32_bf16 v[64:67], a[16:19], v[144:147], v[64:67]
    v_mfma_f32_16x16x32_bf16 v[92:95], a[16:19], v[148:151], v[92:95]
    v_mfma_f32_16x16x32_bf16 v[68:71], a[20:23], v[144:147], v[68:71]
    v_mfma_f32_16x16x32_bf16 v[96:99], a[20:23], v[148:151], v[96:99]
    v_mfma_f32_16x16x32_bf16 v[72:75], a[24:27], v[144:147], v[72:75]
    v_mfma_f32_16x16x32_bf16 v[100:103], a[24:27], v[148:151], v[100:103]
    s_waitcnt vmcnt(0) lgkmcnt(0)
    v_mfma_f32_16x16x32_bf16 v[48:51], a[28:31], v[152:155], v[48:51]
    ds_read_b128 v[160:163], v127 offset:0
    v_mfma_f32_16x16x32_bf16 v[76:79], a[28:31], v[156:159], v[76:79]
    ds_read_b128 v[164:167], v127 offset:64
    v_mfma_f32_16x16x32_bf16 v[52:55], a[32:35], v[152:155], v[52:55]
    ds_read_b128 v[168:171], v127 offset:128
    v_mfma_f32_16x16x32_bf16 v[80:83], a[32:35], v[156:159], v[80:83]
    ds_read_b128 v[172:175], v127 offset:192
    v_mfma_f32_16x16x32_bf16 v[56:59], a[36:39], v[152:155], v[56:59]
    ds_read_b128 v[176:179], v127 offset:256
    v_mfma_f32_16x16x32_bf16 v[84:87], a[36:39], v[156:159], v[84:87]
    ds_read_b128 v[180:183], v127 offset:320
    v_mfma_f32_16x16x32_bf16 v[60:63], a[40:43], v[152:155], v[60:63]
    ds_read_b128 v[184:187], v127 offset:384
    v_mfma_f32_16x16x32_bf16 v[88:91], a[40:43], v[156:159], v[88:91]
    v_mfma_f32_16x16x32_bf16 v[64:67], a[44:47], v[152:155], v[64:67]
    v_mfma_f32_16x16x32_bf16 v[92:95], a[44:47], v[156:159], v[92:95]
    v_mfma_f32_16x16x32_bf16 v[68:71], a[48:51], v[152:155], v[68:71]
    v_mfma_f32_16x16x32_bf16 v[96:99], a[48:51], v[156:159], v[96:99]
    v_mfma_f32_16x16x32_bf16 v[72:75], a[52:55], v[152:155], v[72:75]
    v_mfma_f32_16x16x32_bf16 v[100:103], a[52:55], v[156:159], v[100:103]
    v_mov_b32_e64 v0, 19
    ds_write_b32 v45, v0
    s_waitcnt lgkmcnt(1)
    v_pk_fma_f32 v[48:49], v[160:161], v[112:113], v[48:49] op_sel_hi:[1,0,1] neg_lo:[0,1,0] neg_hi:[0,1,0]
    v_pk_fma_f32 v[50:51], v[162:163], v[112:113], v[50:51] op_sel_hi:[1,0,1] neg_lo:[0,1,0] neg_hi:[0,1,0]
    v_pk_fma_f32 v[52:53], v[164:165], v[112:113], v[52:53] op_sel_hi:[1,0,1] neg_lo:[0,1,0] neg_hi:[0,1,0]
    v_pk_fma_f32 v[54:55], v[166:167], v[112:113], v[54:55] op_sel_hi:[1,0,1] neg_lo:[0,1,0] neg_hi:[0,1,0]
    v_pk_mul_f32 v[128:129], v[48:49], v[48:49]
    v_pk_mul_f32 v[130:131], v[50:51], v[50:51]
    v_pk_mul_f32 v[132:133], v[52:53], v[52:53]
    v_pk_mul_f32 v[134:135], v[54:55], v[54:55]
    v_pk_fma_f32 v[128:129], v[128:129], v[120:121], v[116:117] op_sel_hi:[1,0,0]
    v_pk_fma_f32 v[130:131], v[130:131], v[120:121], v[116:117] op_sel_hi:[1,0,0]
    v_pk_fma_f32 v[132:133], v[132:133], v[120:121], v[116:117] op_sel_hi:[1,0,0]
    v_pk_fma_f32 v[134:135], v[134:135], v[120:121], v[116:117] op_sel_hi:[1,0,0]
    v_pk_mul_f32 v[128:129], v[128:129], v[48:49]
    v_pk_mul_f32 v[130:131], v[130:131], v[50:51]
    v_pk_mul_f32 v[132:133], v[132:133], v[52:53]
    v_pk_mul_f32 v[134:135], v[134:135], v[54:55]
    v_exp_f32 v128, v128
    v_exp_f32 v129, v129
    v_exp_f32 v130, v130
    v_exp_f32 v131, v131
    v_exp_f32 v132, v132
    v_exp_f32 v133, v133
    v_exp_f32 v134, v134
    v_exp_f32_e64 v135, v135
    v_pk_fma_f32 v[128:129], v[128:129], v[124:125], v[124:125] op_sel_hi:[1,0,0]
    v_pk_fma_f32 v[130:131], v[130:131], v[124:125], v[124:125] op_sel_hi:[1,0,0]
    v_pk_fma_f32 v[132:133], v[132:133], v[124:125], v[124:125] op_sel_hi:[1,0,0]
    v_pk_fma_f32 v[134:135], v[134:135], v[124:125], v[124:125] op_sel_hi:[1,0,0]
    v_rcp_f32 v128, v128
    v_rcp_f32 v129, v129
    v_rcp_f32 v130, v130
    v_rcp_f32 v131, v131
    v_rcp_f32 v132, v132
    v_rcp_f32 v133, v133
    v_rcp_f32 v134, v134
    v_rcp_f32 v135, v135
    v_pk_mul_f32 v[128:129], v[128:129], v[48:49]
    v_pk_mul_f32 v[130:131], v[130:131], v[50:51]
    v_pk_mul_f32 v[132:133], v[132:133], v[52:53]
    v_pk_mul_f32 v[134:135], v[134:135], v[54:55]
    v_cvt_pk_bf16_f32 v140, v128, v129
    v_cvt_pk_bf16_f32 v141, v130, v131
    v_cvt_pk_bf16_f32 v142, v132, v133
    v_cvt_pk_bf16_f32 v143, v134, v135
    s_nop 0
    v_permlane16_swap_b32 v140, v142
    v_permlane16_swap_b32 v141, v143
    buffer_store_dwordx4 v[140:143], v117, s[28:31], 0 offen offset:0 sc1
    v_pk_fma_f32 v[56:57], v[168:169], v[112:113], v[56:57] op_sel_hi:[1,0,1] neg_lo:[0,1,0] neg_hi:[0,1,0]
    v_pk_fma_f32 v[58:59], v[170:171], v[112:113], v[58:59] op_sel_hi:[1,0,1] neg_lo:[0,1,0] neg_hi:[0,1,0]
    v_pk_fma_f32 v[60:61], v[172:173], v[112:113], v[60:61] op_sel_hi:[1,0,1] neg_lo:[0,1,0] neg_hi:[0,1,0]
    v_pk_fma_f32 v[62:63], v[174:175], v[112:113], v[62:63] op_sel_hi:[1,0,1] neg_lo:[0,1,0] neg_hi:[0,1,0]
    v_pk_mul_f32 v[128:129], v[56:57], v[56:57]
    v_pk_mul_f32 v[130:131], v[58:59], v[58:59]
    v_pk_mul_f32 v[132:133], v[60:61], v[60:61]
    v_pk_mul_f32 v[134:135], v[62:63], v[62:63]
    v_pk_fma_f32 v[128:129], v[128:129], v[120:121], v[116:117] op_sel_hi:[1,0,0]
    v_pk_fma_f32 v[130:131], v[130:131], v[120:121], v[116:117] op_sel_hi:[1,0,0]
    v_pk_fma_f32 v[132:133], v[132:133], v[120:121], v[116:117] op_sel_hi:[1,0,0]
    v_pk_fma_f32 v[134:135], v[134:135], v[120:121], v[116:117] op_sel_hi:[1,0,0]
    v_pk_mul_f32 v[128:129], v[128:129], v[56:57]
    v_pk_mul_f32 v[130:131], v[130:131], v[58:59]
    v_pk_mul_f32 v[132:133], v[132:133], v[60:61]
    v_pk_mul_f32 v[134:135], v[134:135], v[62:63]
    v_exp_f32 v128, v128
    v_exp_f32 v129, v129
    v_exp_f32 v130, v130
    v_exp_f32 v131, v131
    v_exp_f32 v132, v132
    v_exp_f32 v133, v133
    v_exp_f32 v134, v134
    v_exp_f32_e64 v135, v135
    v_pk_fma_f32 v[128:129], v[128:129], v[124:125], v[124:125] op_sel_hi:[1,0,0]
    v_pk_fma_f32 v[130:131], v[130:131], v[124:125], v[124:125] op_sel_hi:[1,0,0]
    v_pk_fma_f32 v[132:133], v[132:133], v[124:125], v[124:125] op_sel_hi:[1,0,0]
    v_pk_fma_f32 v[134:135], v[134:135], v[124:125], v[124:125] op_sel_hi:[1,0,0]
    v_rcp_f32 v128, v128
    v_rcp_f32 v129, v129
    v_rcp_f32 v130, v130
    v_rcp_f32 v131, v131
    v_rcp_f32 v132, v132
    v_rcp_f32 v133, v133
    v_rcp_f32 v134, v134
    v_rcp_f32 v135, v135
    v_pk_mul_f32 v[128:129], v[128:129], v[56:57]
    v_pk_mul_f32 v[130:131], v[130:131], v[58:59]
    v_pk_mul_f32 v[132:133], v[132:133], v[60:61]
    v_pk_mul_f32 v[134:135], v[134:135], v[62:63]
    v_cvt_pk_bf16_f32 v144, v128, v129
    v_cvt_pk_bf16_f32 v145, v130, v131
    v_cvt_pk_bf16_f32 v146, v132, v133
    v_cvt_pk_bf16_f32 v147, v134, v135
    s_nop 0
    v_permlane16_swap_b32 v144, v146
    v_permlane16_swap_b32 v145, v147
    buffer_store_dwordx4 v[144:147], v117, s[28:31], 0 offen offset:1024 sc1
    v_pk_fma_f32 v[64:65], v[176:177], v[112:113], v[64:65] op_sel_hi:[1,0,1] neg_lo:[0,1,0] neg_hi:[0,1,0]
    v_pk_fma_f32 v[66:67], v[178:179], v[112:113], v[66:67] op_sel_hi:[1,0,1] neg_lo:[0,1,0] neg_hi:[0,1,0]
    v_pk_fma_f32 v[68:69], v[180:181], v[112:113], v[68:69] op_sel_hi:[1,0,1] neg_lo:[0,1,0] neg_hi:[0,1,0]
    v_pk_fma_f32 v[70:71], v[182:183], v[112:113], v[70:71] op_sel_hi:[1,0,1] neg_lo:[0,1,0] neg_hi:[0,1,0]
    v_pk_fma_f32 v[72:73], v[184:185], v[112:113], v[72:73] op_sel_hi:[1,0,1] neg_lo:[0,1,0] neg_hi:[0,1,0]
    v_pk_fma_f32 v[74:75], v[186:187], v[112:113], v[74:75] op_sel_hi:[1,0,1] neg_lo:[0,1,0] neg_hi:[0,1,0]
    v_pk_mul_f32 v[128:129], v[64:65], v[64:65]
    v_pk_mul_f32 v[130:131], v[66:67], v[66:67]
    v_pk_mul_f32 v[132:133], v[68:69], v[68:69]
    v_pk_mul_f32 v[134:135], v[70:71], v[70:71]
    v_pk_mul_f32 v[136:137], v[72:73], v[72:73]
    v_pk_mul_f32 v[138:139], v[74:75], v[74:75]
    v_pk_fma_f32 v[128:129], v[128:129], v[120:121], v[116:117] op_sel_hi:[1,0,0]
    v_pk_fma_f32 v[130:131], v[130:131], v[120:121], v[116:117] op_sel_hi:[1,0,0]
    v_pk_fma_f32 v[132:133], v[132:133], v[120:121], v[116:117] op_sel_hi:[1,0,0]
    v_pk_fma_f32 v[134:135], v[134:135], v[120:121], v[116:117] op_sel_hi:[1,0,0]
    v_pk_fma_f32 v[136:137], v[136:137], v[120:121], v[116:117] op_sel_hi:[1,0,0]
    v_pk_fma_f32 v[138:139], v[138:139], v[120:121], v[116:117] op_sel_hi:[1,0,0]
    v_pk_mul_f32 v[128:129], v[128:129], v[64:65]
    v_pk_mul_f32 v[130:131], v[130:131], v[66:67]
    v_pk_mul_f32 v[132:133], v[132:133], v[68:69]
    v_pk_mul_f32 v[134:135], v[134:135], v[70:71]
    v_pk_mul_f32 v[136:137], v[136:137], v[72:73]
    v_pk_mul_f32 v[138:139], v[138:139], v[74:75]
    v_exp_f32 v128, v128
    v_exp_f32 v129, v129
    v_exp_f32 v130, v130
    v_exp_f32 v131, v131
    v_exp_f32 v132, v132
    v_exp_f32 v133, v133
    v_exp_f32 v134, v134
    v_exp_f32 v135, v135
    v_exp_f32 v136, v136
    v_exp_f32 v137, v137
    v_exp_f32 v138, v138
    v_exp_f32_e64 v139, v139
    v_pk_fma_f32 v[128:129], v[128:129], v[124:125], v[124:125] op_sel_hi:[1,0,0]
    v_pk_fma_f32 v[130:131], v[130:131], v[124:125], v[124:125] op_sel_hi:[1,0,0]
    v_pk_fma_f32 v[132:133], v[132:133], v[124:125], v[124:125] op_sel_hi:[1,0,0]
    v_pk_fma_f32 v[134:135], v[134:135], v[124:125], v[124:125] op_sel_hi:[1,0,0]
    v_pk_fma_f32 v[136:137], v[136:137], v[124:125], v[124:125] op_sel_hi:[1,0,0]
    v_pk_fma_f32 v[138:139], v[138:139], v[124:125], v[124:125] op_sel_hi:[1,0,0]
    v_rcp_f32 v128, v128
    v_rcp_f32 v129, v129
    v_rcp_f32 v130, v130
    v_rcp_f32 v131, v131
    v_rcp_f32 v132, v132
    v_rcp_f32 v133, v133
    v_rcp_f32 v134, v134
    v_rcp_f32 v135, v135
    v_rcp_f32 v136, v136
    v_rcp_f32 v137, v137
    v_rcp_f32 v138, v138
    v_rcp_f32 v139, v139
    v_pk_mul_f32 v[128:129], v[128:129], v[64:65]
    v_pk_mul_f32 v[130:131], v[130:131], v[66:67]
    v_pk_mul_f32 v[132:133], v[132:133], v[68:69]
    v_pk_mul_f32 v[134:135], v[134:135], v[70:71]
    v_pk_mul_f32 v[136:137], v[136:137], v[72:73]
    v_pk_mul_f32 v[138:139], v[138:139], v[74:75]
    v_cvt_pk_bf16_f32 v140, v128, v129
    v_cvt_pk_bf16_f32 v141, v130, v131
    v_cvt_pk_bf16_f32 v142, v132, v133
    v_cvt_pk_bf16_f32 v143, v134, v135
    v_cvt_pk_bf16_f32 v148, v136, v137
    v_cvt_pk_bf16_f32 v149, v138, v139
    v_permlane16_swap_b32 v140, v142
    v_permlane16_swap_b32 v141, v143
    buffer_store_dwordx4 v[140:143], v117, s[28:31], 0 offen offset:2048 sc1
    v_pk_fma_f32 v[76:77], v[160:161], v[114:115], v[76:77] op_sel_hi:[1,0,1] neg_lo:[0,1,0] neg_hi:[0,1,0]
    v_pk_fma_f32 v[78:79], v[162:163], v[114:115], v[78:79] op_sel_hi:[1,0,1] neg_lo:[0,1,0] neg_hi:[0,1,0]
    v_pk_fma_f32 v[80:81], v[164:165], v[114:115], v[80:81] op_sel_hi:[1,0,1] neg_lo:[0,1,0] neg_hi:[0,1,0]
    v_pk_fma_f32 v[82:83], v[166:167], v[114:115], v[82:83] op_sel_hi:[1,0,1] neg_lo:[0,1,0] neg_hi:[0,1,0]
    v_pk_mul_f32 v[128:129], v[76:77], v[76:77]
    v_pk_mul_f32 v[130:131], v[78:79], v[78:79]
    v_pk_mul_f32 v[132:133], v[80:81], v[80:81]
    v_pk_mul_f32 v[134:135], v[82:83], v[82:83]
    v_pk_fma_f32 v[128:129], v[128:129], v[122:123], v[118:119] op_sel_hi:[1,0,0]
    v_pk_fma_f32 v[130:131], v[130:131], v[122:123], v[118:119] op_sel_hi:[1,0,0]
    v_pk_fma_f32 v[132:133], v[132:133], v[122:123], v[118:119] op_sel_hi:[1,0,0]
    v_pk_fma_f32 v[134:135], v[134:135], v[122:123], v[118:119] op_sel_hi:[1,0,0]
    v_pk_mul_f32 v[128:129], v[128:129], v[76:77]
    v_pk_mul_f32 v[130:131], v[130:131], v[78:79]
    v_pk_mul_f32 v[132:133], v[132:133], v[80:81]
    v_pk_mul_f32 v[134:135], v[134:135], v[82:83]
    v_exp_f32 v128, v128
    v_exp_f32 v129, v129
    v_exp_f32 v130, v130
    v_exp_f32 v131, v131
    v_exp_f32 v132, v132
    v_exp_f32 v133, v133
    v_exp_f32 v134, v134
    v_exp_f32 v135, v135
    v_pk_fma_f32 v[128:129], v[128:129], v[126:127], v[126:127] op_sel_hi:[1,0,0]
    v_pk_fma_f32 v[130:131], v[130:131], v[126:127], v[126:127] op_sel_hi:[1,0,0]
    v_pk_fma_f32 v[132:133], v[132:133], v[126:127], v[126:127] op_sel_hi:[1,0,0]
    v_pk_fma_f32 v[134:135], v[134:135], v[126:127], v[126:127] op_sel_hi:[1,0,0]
    v_rcp_f32 v128, v128
    v_rcp_f32 v129, v129
    v_rcp_f32 v130, v130
    v_rcp_f32 v131, v131
    v_rcp_f32 v132, v132
    v_rcp_f32 v133, v133
    v_rcp_f32 v134, v134
    v_rcp_f32 v135, v135
    v_pk_mul_f32 v[128:129], v[128:129], v[76:77]
    v_pk_mul_f32 v[130:131], v[130:131], v[78:79]
    v_pk_mul_f32 v[132:133], v[132:133], v[80:81]
    v_pk_mul_f32 v[134:135], v[134:135], v[82:83]
    v_cvt_pk_bf16_f32 v144, v128, v129
    v_cvt_pk_bf16_f32 v145, v130, v131
    v_cvt_pk_bf16_f32 v146, v132, v133
    v_cvt_pk_bf16_f32 v147, v134, v135
    s_nop 0
    v_permlane16_swap_b32 v144, v146
    v_permlane16_swap_b32 v145, v147
    buffer_store_dwordx4 v[144:147], v119, s[28:31], 0 offen offset:0 sc1
    v_pk_fma_f32 v[84:85], v[168:169], v[114:115], v[84:85] op_sel_hi:[1,0,1] neg_lo:[0,1,0] neg_hi:[0,1,0]
    v_pk_fma_f32 v[86:87], v[170:171], v[114:115], v[86:87] op_sel_hi:[1,0,1] neg_lo:[0,1,0] neg_hi:[0,1,0]
    v_pk_fma_f32 v[88:89], v[172:173], v[114:115], v[88:89] op_sel_hi:[1,0,1] neg_lo:[0,1,0] neg_hi:[0,1,0]
    v_pk_fma_f32 v[90:91], v[174:175], v[114:115], v[90:91] op_sel_hi:[1,0,1] neg_lo:[0,1,0] neg_hi:[0,1,0]
    v_pk_mul_f32 v[128:129], v[84:85], v[84:85]
    v_pk_mul_f32 v[130:131], v[86:87], v[86:87]
    v_pk_mul_f32 v[132:133], v[88:89], v[88:89]
    v_pk_mul_f32 v[134:135], v[90:91], v[90:91]
    v_pk_fma_f32 v[128:129], v[128:129], v[122:123], v[118:119] op_sel_hi:[1,0,0]
    v_pk_fma_f32 v[130:131], v[130:131], v[122:123], v[118:119] op_sel_hi:[1,0,0]
    v_pk_fma_f32 v[132:133], v[132:133], v[122:123], v[118:119] op_sel_hi:[1,0,0]
    v_pk_fma_f32 v[134:135], v[134:135], v[122:123], v[118:119] op_sel_hi:[1,0,0]
    v_pk_mul_f32 v[128:129], v[128:129], v[84:85]
    v_pk_mul_f32 v[130:131], v[130:131], v[86:87]
    v_pk_mul_f32 v[132:133], v[132:133], v[88:89]
    v_pk_mul_f32 v[134:135], v[134:135], v[90:91]
    v_exp_f32 v128, v128
    v_exp_f32 v129, v129
    v_exp_f32 v130, v130
    v_exp_f32 v131, v131
    v_exp_f32 v132, v132
    v_exp_f32 v133, v133
    v_exp_f32 v134, v134
    v_exp_f32_e64 v135, v135
    v_pk_fma_f32 v[128:129], v[128:129], v[126:127], v[126:127] op_sel_hi:[1,0,0]
    v_pk_fma_f32 v[130:131], v[130:131], v[126:127], v[126:127] op_sel_hi:[1,0,0]
    v_pk_fma_f32 v[132:133], v[132:133], v[126:127], v[126:127] op_sel_hi:[1,0,0]
    v_pk_fma_f32 v[134:135], v[134:135], v[126:127], v[126:127] op_sel_hi:[1,0,0]
    v_rcp_f32 v128, v128
    v_rcp_f32 v129, v129
    v_rcp_f32 v130, v130
    v_rcp_f32 v131, v131
    v_rcp_f32 v132, v132
    v_rcp_f32 v133, v133
    v_rcp_f32 v134, v134
    v_rcp_f32 v135, v135
    v_pk_mul_f32 v[128:129], v[128:129], v[84:85]
    v_pk_mul_f32 v[130:131], v[130:131], v[86:87]
    v_pk_mul_f32 v[132:133], v[132:133], v[88:89]
    v_pk_mul_f32 v[134:135], v[134:135], v[90:91]
    v_cvt_pk_bf16_f32 v140, v128, v129
    v_cvt_pk_bf16_f32 v141, v130, v131
    v_cvt_pk_bf16_f32 v142, v132, v133
    v_cvt_pk_bf16_f32 v143, v134, v135
    s_nop 0
    v_permlane16_swap_b32 v140, v142
    v_permlane16_swap_b32 v141, v143
    buffer_store_dwordx4 v[140:143], v119, s[28:31], 0 offen offset:1024 sc1
    v_pk_fma_f32 v[92:93], v[176:177], v[114:115], v[92:93] op_sel_hi:[1,0,1] neg_lo:[0,1,0] neg_hi:[0,1,0]
    v_pk_fma_f32 v[94:95], v[178:179], v[114:115], v[94:95] op_sel_hi:[1,0,1] neg_lo:[0,1,0] neg_hi:[0,1,0]
    v_pk_fma_f32 v[96:97], v[180:181], v[114:115], v[96:97] op_sel_hi:[1,0,1] neg_lo:[0,1,0] neg_hi:[0,1,0]
    v_pk_fma_f32 v[98:99], v[182:183], v[114:115], v[98:99] op_sel_hi:[1,0,1] neg_lo:[0,1,0] neg_hi:[0,1,0]
    v_pk_fma_f32 v[100:101], v[184:185], v[114:115], v[100:101] op_sel_hi:[1,0,1] neg_lo:[0,1,0] neg_hi:[0,1,0]
    v_pk_fma_f32 v[102:103], v[186:187], v[114:115], v[102:103] op_sel_hi:[1,0,1] neg_lo:[0,1,0] neg_hi:[0,1,0]
    v_pk_mul_f32 v[128:129], v[92:93], v[92:93]
    v_pk_mul_f32 v[130:131], v[94:95], v[94:95]
    v_pk_mul_f32 v[132:133], v[96:97], v[96:97]
    v_pk_mul_f32 v[134:135], v[98:99], v[98:99]
    v_pk_mul_f32 v[136:137], v[100:101], v[100:101]
    v_pk_mul_f32 v[138:139], v[102:103], v[102:103]
    v_pk_fma_f32 v[128:129], v[128:129], v[122:123], v[118:119] op_sel_hi:[1,0,0]
    v_pk_fma_f32 v[130:131], v[130:131], v[122:123], v[118:119] op_sel_hi:[1,0,0]
    v_pk_fma_f32 v[132:133], v[132:133], v[122:123], v[118:119] op_sel_hi:[1,0,0]
    v_pk_fma_f32 v[134:135], v[134:135], v[122:123], v[118:119] op_sel_hi:[1,0,0]
    v_pk_fma_f32 v[136:137], v[136:137], v[122:123], v[118:119] op_sel_hi:[1,0,0]
    v_pk_fma_f32 v[138:139], v[138:139], v[122:123], v[118:119] op_sel_hi:[1,0,0]
    v_pk_mul_f32 v[128:129], v[128:129], v[92:93]
    v_pk_mul_f32 v[130:131], v[130:131], v[94:95]
    v_pk_mul_f32 v[132:133], v[132:133], v[96:97]
    v_pk_mul_f32 v[134:135], v[134:135], v[98:99]
    v_pk_mul_f32 v[136:137], v[136:137], v[100:101]
    v_pk_mul_f32 v[138:139], v[138:139], v[102:103]
    v_exp_f32 v128, v128
    v_exp_f32 v129, v129
    v_exp_f32 v130, v130
    v_exp_f32 v131, v131
    v_exp_f32 v132, v132
    v_exp_f32 v133, v133
    v_exp_f32 v134, v134
    v_exp_f32 v135, v135
    v_exp_f32 v136, v136
    v_exp_f32 v137, v137
    v_exp_f32 v138, v138
    v_exp_f32_e64 v139, v139
    v_pk_fma_f32 v[128:129], v[128:129], v[126:127], v[126:127] op_sel_hi:[1,0,0]
    v_pk_fma_f32 v[130:131], v[130:131], v[126:127], v[126:127] op_sel_hi:[1,0,0]
    v_pk_fma_f32 v[132:133], v[132:133], v[126:127], v[126:127] op_sel_hi:[1,0,0]
    v_pk_fma_f32 v[134:135], v[134:135], v[126:127], v[126:127] op_sel_hi:[1,0,0]
    v_pk_fma_f32 v[136:137], v[136:137], v[126:127], v[126:127] op_sel_hi:[1,0,0]
    v_pk_fma_f32 v[138:139], v[138:139], v[126:127], v[126:127] op_sel_hi:[1,0,0]
    v_rcp_f32 v128, v128
    v_rcp_f32 v129, v129
    v_rcp_f32 v130, v130
    v_rcp_f32 v131, v131
    v_rcp_f32 v132, v132
    v_rcp_f32 v133, v133
    v_rcp_f32 v134, v134
    v_rcp_f32 v135, v135
    v_rcp_f32 v136, v136
    v_rcp_f32 v137, v137
    v_rcp_f32 v138, v138
    v_rcp_f32 v139, v139
    v_pk_mul_f32 v[128:129], v[128:129], v[92:93]
    v_pk_mul_f32 v[130:131], v[130:131], v[94:95]
    v_pk_mul_f32 v[132:133], v[132:133], v[96:97]
    v_pk_mul_f32 v[134:135], v[134:135], v[98:99]
    v_pk_mul_f32 v[136:137], v[136:137], v[100:101]
    v_pk_mul_f32 v[138:139], v[138:139], v[102:103]
    v_cvt_pk_bf16_f32 v144, v128, v129
    v_cvt_pk_bf16_f32 v145, v130, v131
    v_cvt_pk_bf16_f32 v146, v132, v133
    v_cvt_pk_bf16_f32 v147, v134, v135
    v_cvt_pk_bf16_f32 v150, v136, v137
    v_cvt_pk_bf16_f32 v151, v138, v139
    v_permlane16_swap_b32 v144, v146
    v_permlane16_swap_b32 v145, v147
    buffer_store_dwordx4 v[144:147], v119, s[28:31], 0 offen offset:2048 sc1
    v_permlane16_swap_b32 v148, v150
    v_permlane16_swap_b32 v149, v151
    buffer_store_dwordx4 v[148:151], v121, s[28:31], 0 offen sc1
    v_lshlrev_b32_e64 v52, 16, v10
    v_and_b32 v53, 0xffff0000, v10
    v_lshlrev_b32_e64 v54, 16, v11
    v_and_b32 v55, 0xffff0000, v11
    v_lshlrev_b32_e64 v56, 16, v12
    v_and_b32 v57, 0xffff0000, v12
    v_lshlrev_b32_e64 v58, 16, v13
    v_and_b32 v59, 0xffff0000, v13
    v_lshlrev_b32_e64 v60, 16, v14
    v_and_b32 v61, 0xffff0000, v14
    v_lshlrev_b32_e64 v62, 16, v15
    v_and_b32 v63, 0xffff0000, v15
    v_lshlrev_b32_e64 v64, 16, v16
    v_and_b32 v65, 0xffff0000, v16
    v_lshlrev_b32_e64 v66, 16, v17
    v_and_b32 v67, 0xffff0000, v17
    v_lshlrev_b32_e64 v68, 16, v18
    v_and_b32 v69, 0xffff0000, v18
    v_lshlrev_b32_e64 v70, 16, v19
    v_and_b32 v71, 0xffff0000, v19
    v_permlane16_swap_b32 v22, v24
    v_permlane16_swap_b32 v23, v25
    v_permlane16_swap_b32 v26, v28
    v_permlane16_swap_b32 v27, v29
    v_permlane16_swap_b32 v30, v32
    v_permlane16_swap_b32 v31, v33
    v_lshlrev_b32_e64 v84, 16, v22
    v_and_b32 v85, 0xffff0000, v22
    v_pk_add_f32 v[52:53], v[52:53], v[84:85]
    v_lshlrev_b32_e64 v86, 16, v23
    v_and_b32 v87, 0xffff0000, v23
    v_pk_add_f32 v[54:55], v[54:55], v[86:87]
    v_lshlrev_b32_e64 v88, 16, v24
    v_and_b32 v89, 0xffff0000, v24
    v_pk_add_f32 v[56:57], v[56:57], v[88:89]
    v_lshlrev_b32_e64 v90, 16, v25
    v_and_b32 v91, 0xffff0000, v25
    v_pk_add_f32 v[58:59], v[58:59], v[90:91]
    v_lshlrev_b32_e64 v84, 16, v26
    v_and_b32 v85, 0xffff0000, v26
    v_pk_add_f32 v[60:61], v[60:61], v[84:85]
    v_lshlrev_b32_e64 v86, 16, v27
    v_and_b32 v87, 0xffff0000, v27
    v_pk_add_f32 v[62:63], v[62:63], v[86:87]
    v_lshlrev_b32_e64 v88, 16, v28
    v_and_b32 v89, 0xffff0000, v28
    v_pk_add_f32 v[64:65], v[64:65], v[88:89]
    v_lshlrev_b32_e64 v90, 16, v29
    v_and_b32 v91, 0xffff0000, v29
    v_pk_add_f32 v[66:67], v[66:67], v[90:91]
    v_lshlrev_b32_e64 v84, 16, v30
    v_and_b32 v85, 0xffff0000, v30
    v_pk_add_f32 v[68:69], v[68:69], v[84:85]
    v_lshlrev_b32_e64 v86, 16, v31
    v_and_b32 v87, 0xffff0000, v31
    v_pk_add_f32 v[70:71], v[70:71], v[86:87]
    s_lshr_b32 s61, s63, 1
    s_lshl_b32 s60, s61, 7
    s_add_u32 s60, s60, 0x2218000
    v_and_b32_e64 v104, 15, v1
    v_lshl_add_u32 v104, v104, 2, s60
    s_mul_i32 s60, s63, 57344
    s_add_u32 s60, s60, 0xf00000
    v_add_u32 v48, s60, v2
    s_and_b32 s61, s40, 1
    s_lshl_b32 s62, s61, 10
    v_add_u32 v48, s62, v48
    s_cmp_eq_u32 s61, 0
    s_cselect_b32 s62, 1, -1
    s_mul_i32 s62, s62, 57344
    v_add_u32_e64 v49, s62, v48
    s_mul_i32 s62, s61, 5120
    v_add_u32 v92, s62, v2
    v_add_u32 v93, s62, v7
    v_add_u32_e64 v94, s62, v8
    s_mul_i32 s62, s40, 5120
    s_add_u32 s62, s62, 20480
    v_add_u32 v100, s62, v2
    s_xor_b32 s62, s40, 1
    s_mul_i32 s62, s62, 5120
    s_add_u32 s62, s62, 20480
    v_add_u32 v101, s62, v2
    v_xor_b32 v102, 4, v45
    s_mov_b32 s36, s20
    s_mov_b32 s37, s21
    s_mov_b32 s38, 2621440
    s_mov_b32 s66, 53248
    s_waitcnt vmcnt(0)
    s_cmp_eq_u32 s6, 0
    s_cbranch_scc1 L99
    s_mov_b64 exec, 1
    buffer_store_dword v3, v123, s[28:31], 0 offen
    s_mov_b64 exec, -1
    s_branch L100
L99:
    s_mov_b64 exec, 1
    buffer_store_dword v3, v123, s[28:31], 0 offen sc1
    s_mov_b64 exec, -1
L100:
    s_mov_b32 s60, 0
    v_not_b32 v0, v3
L101:
    v_mov_b32_e64 v4, v0
    buffer_load_dword v4, v104, s[28:31], 0 offen sc1
    s_mov_b32 s61, 0
L102:
    v_cmp_eq_u32 vcc, v4, v0
    s_cbranch_vccz L103
    s_add_u32 s61, s61, 1
    s_cmp_lt_u32 s61, 200
    s_cbranch_scc1 L102
L103:
    v_cmp_ne_u32 vcc, v4, v3
    s_cbranch_vccz L104
    s_add_u32 s60, s60, 1
    s_cmp_lt_u32 s60, 400000
    s_cbranch_scc1 L101
L104:
    buffer_load_dwordx4 v[112:115], v48, s[28:31], s86 offen offset:0 sc1
    buffer_load_dwordx4 v[116:119], v49, s[28:31], s86 offen offset:0 sc1
    buffer_load_dwordx4 v[120:123], v48, s[28:31], s86 offen offset:2048 sc1
    buffer_load_dwordx4 v[124:127], v49, s[28:31], s86 offen offset:2048 sc1
    buffer_load_dwordx4 v[128:131], v48, s[28:31], s87 offen offset:0 sc1
    buffer_load_dwordx4 v[132:135], v49, s[28:31], s87 offen offset:0 sc1
    buffer_load_dwordx4 v[136:139], v48, s[28:31], s87 offen offset:2048 sc1
    buffer_load_dwordx4 v[140:143], v49, s[28:31], s87 offen offset:2048 sc1
    buffer_load_dwordx4 v[144:147], v48, s[28:31], s88 offen offset:0 sc1
    buffer_load_dwordx4 v[148:151], v49, s[28:31], s88 offen offset:0 sc1
    s_mov_b32 s60, 0
L105:
    ds_read_b64 v[46:47], v39 offset:16
    s_waitcnt lgkmcnt(0)
    v_min_u32 v46, v46, v47
    v_cmp_gt_u32 vcc, 22, v46
    s_cbranch_vccz L106
    s_add_u32 s60, s60, 1
    s_cmp_lt_u32 s60, 3200000
    s_cbranch_scc1 L105
L106:
    ds_read_b128 a[0:3], v92 offset:20480
    ds_read_b128 a[4:7], v92 offset:21504
    ds_read_b128 a[8:11], v92 offset:22528
    ds_read_b128 a[12:15], v92 offset:23552
    ds_read_b128 a[16:19], v92 offset:24576
    ds_read_b128 a[20:23], v92 offset:30720
    ds_read_b128 a[24:27], v92 offset:31744
    ds_read_b128 a[28:31], v92 offset:32768
    ds_read_b128 a[32:35], v92 offset:33792
    ds_read_b128 a[36:39], v92 offset:34816
    ds_read_b64 v[46:47], v39 offset:16
    s_waitcnt vmcnt(8) lgkmcnt(6)
    v_mfma_f32_16x16x32_bf16 v[52:55], a[0:3], v[112:115], v[52:55]
    ds_read_b128 a[40:43], v92 offset:40960
    v_mfma_f32_16x16x32_bf16 v[72:75], a[0:3], v[116:119], 0
    ds_read_b128 a[44:47], v92 offset:41984
    v_mfma_f32_16x16x32_bf16 v[56:59], a[4:7], v[112:115], v[56:59]
    ds_read_b128 a[48:51], v92 offset:43008
    v_mfma_f32_16x16x32_bf16 v[76:79], a[4:7], v[116:119], 0
    ds_read_b128 a[52:55], v92 offset:44032
    v_mfma_f32_16x16x32_bf16 v[60:63], a[8:11], v[112:115], v[60:63]
    ds_read_b128 a[56:59], v92 offset:45056
    v_mfma_f32_16x16x32_bf16 v[80:83], a[8:11], v[116:119], 0
    buffer_load_dwordx4 v[152:155], v48, s[28:31], s88 offen offset:2048 sc1
    v_mfma_f32_16x16x32_bf16 v[64:67], a[12:15], v[112:115], v[64:67]
    v_mfma_f32_16x16x32_bf16 v[84:87], a[12:15], v[116:119], 0
    v_mov_b32 v0, 20
    ds_write_b32 v45, v0
    v_mfma_f32_16x16x32_bf16 v[68:71], a[16:19], v[112:115], v[68:71]
    buffer_load_dwordx4 v[156:159], v49, s[28:31], s88 offen offset:2048 sc1
    v_mfma_f32_16x16x32_bf16 v[88:91], a[16:19], v[116:119], 0
    s_waitcnt vmcnt(8) lgkmcnt(7)
    v_mfma_f32_16x16x32_bf16 v[52:55], a[20:23], v[120:123], v[52:55]
    ds_read_b128 a[0:3], v92 offset:51200
    v_mfma_f32_16x16x32_bf16 v[72:75], a[20:23], v[124:127], v[72:75]
    ds_read_b128 a[4:7], v92 offset:52224
    v_mfma_f32_16x16x32_bf16 v[56:59], a[24:27], v[120:123], v[56:59]
    ds_read_b128 a[8:11], v92 offset:53248
    v_mfma_f32_16x16x32_bf16 v[76:79], a[24:27], v[124:127], v[76:79]
    ds_read_b128 a[12:15], v92 offset:54272
    v_mfma_f32_16x16x32_bf16 v[60:63], a[28:31], v[120:123], v[60:63]
    ds_read_b128 a[16:19], v92 offset:55296
    v_mfma_f32_16x16x32_bf16 v[80:83], a[28:31], v[124:127], v[80:83]
    buffer_load_dwordx4 v[160:163], v48, s[28:31], s89 offen offset:0 sc1
    v_mfma_f32_16x16x32_bf16 v[64:67], a[32:35], v[120:123], v[64:67]
    s_waitcnt lgkmcnt(11)
    v_min_u32 v46, v46, v47
    v_cmp_gt_u32 vcc, 23, v46
    s_cbranch_vccz L108
    s_mov_b32 s60, 0
L107:
    ds_read_b64 v[46:47], v39 offset:16
    s_waitcnt lgkmcnt(0)
    v_min_u32 v46, v46, v47
    v_cmp_gt_u32 vcc, 23, v46
    s_cbranch_vccz L108
    s_add_u32 s60, s60, 1
    s_cmp_lt_u32 s60, 3200000
    s_cbranch_scc1 L107
L108:
    v_mfma_f32_16x16x32_bf16 v[84:87], a[32:35], v[124:127], v[84:87]
    v_mfma_f32_16x16x32_bf16 v[68:71], a[36:39], v[120:123], v[68:71]
    buffer_load_dwordx4 v[164:167], v49, s[28:31], s89 offen offset:0 sc1
    v_mfma_f32_16x16x32_bf16 v[88:91], a[36:39], v[124:127], v[88:91]
    s_waitcnt vmcnt(8) lgkmcnt(6)
    v_mfma_f32_16x16x32_bf16 v[52:55], a[40:43], v[128:131], v[52:55]
    ds_read_b64 v[46:47], v39 offset:16
    ds_read_b128 a[20:23], v92 offset:61440
    v_mfma_f32_16x16x32_bf16 v[72:75], a[40:43], v[132:135], v[72:75]
    ds_read_b128 a[24:27], v92 offset:62464
    v_mfma_f32_16x16x32_bf16 v[56:59], a[44:47], v[128:131], v[56:59]
    ds_read_b128 a[28:31], v92 offset:63488
    v_mfma_f32_16x16x32_bf16 v[76:79], a[44:47], v[132:135], v[76:79]
    ds_read_b128 a[32:35], v92 offset:64512
    v_mfma_f32_16x16x32_bf16 v[60:63], a[48:51], v[128:131], v[60:63]
    ds_read_b128 a[36:39], v93 offset:0
    v_mfma_f32_16x16x32_bf16 v[80:83], a[48:51], v[132:135], v[80:83]
    buffer_load_dwordx4 v[168:171], v48, s[28:31], s89 offen offset:2048 sc1
    v_mfma_f32_16x16x32_bf16 v[64:67], a[52:55], v[128:131], v[64:67]
    v_mfma_f32_16x16x32_bf16 v[84:87], a[52:55], v[132:135], v[84:87]
    v_mov_b32 v0, 21
    ds_write_b32 v45, v0
    v_mfma_f32_16x16x32_bf16 v[68:71], a[56:59], v[128:131], v[68:71]
    buffer_load_dwordx4 v[172:175], v49, s[28:31], s89 offen offset:2048 sc1
    v_mfma_f32_16x16x32_bf16 v[88:91], a[56:59], v[132:135], v[88:91]
    s_waitcnt vmcnt(8) lgkmcnt(7)
    v_mfma_f32_16x16x32_bf16 v[52:55], a[0:3], v[136:139], v[52:55]
    ds_read_b128 a[40:43], v93 offset:6144
    v_mfma_f32_16x16x32_bf16 v[72:75], a[0:3], v[140:143], v[72:75]
    ds_read_b128 a[44:47], v93 offset:7168
    v_mfma_f32_16x16x32_bf16 v[56:59], a[4:7], v[136:139], v[56:59]
    ds_read_b128 a[48:51], v93 offset:8192
    v_mfma_f32_16x16x32_bf16 v[76:79], a[4:7], v[140:143], v[76:79]
    ds_read_b128 a[52:55], v93 offset:9216
    v_mfma_f32_16x16x32_bf16 v[60:63], a[8:11], v[136:139], v[60:63]
    ds_read_b128 a[56:59], v93 offset:10240
    v_mfma_f32_16x16x32_bf16 v[80:83], a[8:11], v[140:143], v[80:83]
    buffer_load_dwordx4 v[176:179], v48, s[28:31], s90 offen offset:0 sc1
    v_mfma_f32_16x16x32_bf16 v[64:67], a[12:15], v[136:139], v[64:67]
    s_waitcnt lgkmcnt(11)
    v_min_u32 v46, v46, v47
    v_cmp_gt_u32 vcc, 24, v46
    s_cbranch_vccz L110
    s_mov_b32 s60, 0
L109:
    ds_read_b64 v[46:47], v39 offset:16
    s_waitcnt lgkmcnt(0)
    v_min_u32 v46, v46, v47
    v_cmp_gt_u32 vcc, 24, v46
    s_cbranch_vccz L110
    s_add_u32 s60, s60, 1
    s_cmp_lt_u32 s60, 3200000
    s_cbranch_scc1 L109
L110:
    v_mfma_f32_16x16x32_bf16 v[84:87], a[12:15], v[140:143], v[84:87]
    v_mfma_f32_16x16x32_bf16 v[68:71], a[16:19], v[136:139], v[68:71]
    buffer_load_dwordx4 v[180:183], v49, s[28:31], s90 offen offset:0 sc1
    v_mfma_f32_16x16x32_bf16 v[88:91], a[16:19], v[140:143], v[88:91]
    s_waitcnt vmcnt(8) lgkmcnt(6)
    v_mfma_f32_16x16x32_bf16 v[52:55], a[20:23], v[144:147], v[52:55]
    ds_read_b64 v[46:47], v39 offset:16
    ds_read_b128 a[0:3], v93 offset:16384
    v_mfma_f32_16x16x32_bf16 v[72:75], a[20:23], v[148:151], v[72:75]
    ds_read_b128 a[4:7], v93 offset:17408
    v_mfma_f32_16x16x32_bf16 v[56:59], a[24:27], v[144:147], v[56:59]
    ds_read_b128 a[8:11], v93 offset:18432
    v_mfma_f32_16x16x32_bf16 v[76:79], a[24:27], v[148:151], v[76:79]
    ds_read_b128 a[12:15], v93 offset:19456
    v_mfma_f32_16x16x32_bf16 v[60:63], a[28:31], v[144:147], v[60:63]
    ds_read_b128 a[16:19], v93 offset:20480
    v_mfma_f32_16x16x32_bf16 v[80:83], a[28:31], v[148:151], v[80:83]
    buffer_load_dwordx4 v[184:187], v48, s[28:31], s90 offen offset:2048 sc1
    v_mfma_f32_16x16x32_bf16 v[64:67], a[32:35], v[144:147], v[64:67]
    v_mfma_f32_16x16x32_bf16 v[84:87], a[32:35], v[148:151], v[84:87]
    v_mov_b32 v0, 22
    ds_write_b32 v45, v0
    v_mfma_f32_16x16x32_bf16 v[68:71], a[36:39], v[144:147], v[68:71]
    buffer_load_dwordx4 v[188:191], v49, s[28:31], s90 offen offset:2048 sc1
    v_mfma_f32_16x16x32_bf16 v[88:91], a[36:39], v[148:151], v[88:91]
    s_waitcnt vmcnt(8) lgkmcnt(7)
    v_mfma_f32_16x16x32_bf16 v[52:55], a[40:43], v[152:155], v[52:55]
    ds_read_b128 a[20:23], v93 offset:26624
    v_mfma_f32_16x16x32_bf16 v[72:75], a[40:43], v[156:159], v[72:75]
    ds_read_b128 a[24:27], v93 offset:27648
    v_mfma_f32_16x16x32_bf16 v[56:59], a[44:47], v[152:155], v[56:59]
    ds_read_b128 a[28:31], v93 offset:28672
    v_mfma_f32_16x16x32_bf16 v[76:79], a[44:47], v[156:159], v[76:79]
    ds_read_b128 a[32:35], v93 offset:29696
    v_mfma_f32_16x16x32_bf16 v[60:63], a[48:51], v[152:155], v[60:63]
    ds_read_b128 a[36:39], v93 offset:30720
    v_mfma_f32_16x16x32_bf16 v[80:83], a[48:51], v[156:159], v[80:83]
    buffer_load_dwordx4 v[112:115], v48, s[28:31], s91 offen offset:0 sc1
    v_mfma_f32_16x16x32_bf16 v[64:67], a[52:55], v[152:155], v[64:67]
    s_waitcnt lgkmcnt(11)
    v_min_u32 v46, v46, v47
    v_cmp_gt_u32 vcc, 25, v46
    s_cbranch_vccz L112
    s_mov_b32 s60, 0
L111:
    ds_read_b64 v[46:47], v39 offset:16
    s_waitcnt lgkmcnt(0)
    v_min_u32 v46, v46, v47
    v_cmp_gt_u32 vcc, 25, v46
    s_cbranch_vccz L112
    s_add_u32 s60, s60, 1
    s_cmp_lt_u32 s60, 3200000
    s_cbranch_scc1 L111
L112:
    v_mfma_f32_16x16x32_bf16 v[84:87], a[52:55], v[156:159], v[84:87]
    v_mfma_f32_16x16x32_bf16 v[68:71], a[56:59], v[152:155], v[68:71]
    buffer_load_dwordx4 v[116:119], v49, s[28:31], s91 offen offset:0 sc1
    v_mfma_f32_16x16x32_bf16 v[88:91], a[56:59], v[156:159], v[88:91]
    s_waitcnt vmcnt(8) lgkmcnt(6)
    v_mfma_f32_16x16x32_bf16 v[52:55], a[0:3], v[160:163], v[52:55]
    ds_read_b64 v[46:47], v39 offset:16
    ds_read_b128 a[40:43], v93 offset:36864
    v_mfma_f32_16x16x32_bf16 v[72:75], a[0:3], v[164:167], v[72:75]
    ds_read_b128 a[44:47], v93 offset:37888
    v_mfma_f32_16x16x32_bf16 v[56:59], a[4:7], v[160:163], v[56:59]
    ds_read_b128 a[48:51], v93 offset:38912
    v_mfma_f32_16x16x32_bf16 v[76:79], a[4:7], v[164:167], v[76:79]
    ds_read_b128 a[52:55], v93 offset:39936
    v_mfma_f32_16x16x32_bf16 v[60:63], a[8:11], v[160:163], v[60:63]
    ds_read_b128 a[56:59], v93 offset:40960
    v_mfma_f32_16x16x32_bf16 v[80:83], a[8:11], v[164:167], v[80:83]
    buffer_load_dwordx4 v[120:123], v48, s[28:31], s91 offen offset:2048 sc1
    v_mfma_f32_16x16x32_bf16 v[64:67], a[12:15], v[160:163], v[64:67]
    v_mfma_f32_16x16x32_bf16 v[84:87], a[12:15], v[164:167], v[84:87]
    v_mov_b32 v0, 23
    ds_write_b32 v45, v0
    v_mfma_f32_16x16x32_bf16 v[68:71], a[16:19], v[160:163], v[68:71]
    buffer_load_dwordx4 v[124:127], v49, s[28:31], s91 offen offset:2048 sc1
    v_mfma_f32_16x16x32_bf16 v[88:91], a[16:19], v[164:167], v[88:91]
    s_waitcnt vmcnt(8) lgkmcnt(7)
    v_mfma_f32_16x16x32_bf16 v[52:55], a[20:23], v[168:171], v[52:55]
    ds_read_b128 a[0:3], v93 offset:47104
    v_mfma_f32_16x16x32_bf16 v[72:75], a[20:23], v[172:175], v[72:75]
    ds_read_b128 a[4:7], v93 offset:48128
    v_mfma_f32_16x16x32_bf16 v[56:59], a[24:27], v[168:171], v[56:59]
    ds_read_b128 a[8:11], v93 offset:49152
    v_mfma_f32_16x16x32_bf16 v[76:79], a[24:27], v[172:175], v[76:79]
    ds_read_b128 a[12:15], v93 offset:50176
    v_mfma_f32_16x16x32_bf16 v[60:63], a[28:31], v[168:171], v[60:63]
    ds_read_b128 a[16:19], v93 offset:51200
    v_mfma_f32_16x16x32_bf16 v[80:83], a[28:31], v[172:175], v[80:83]
    buffer_load_dwordx4 v[128:131], v48, s[28:31], s92 offen offset:0 sc1
    v_mfma_f32_16x16x32_bf16 v[64:67], a[32:35], v[168:171], v[64:67]
    s_waitcnt lgkmcnt(11)
    v_min_u32 v46, v46, v47
    v_cmp_gt_u32 vcc, 26, v46
    s_cbranch_vccz L114
    s_mov_b32 s60, 0
L113:
    ds_read_b64 v[46:47], v39 offset:16
    s_waitcnt lgkmcnt(0)
    v_min_u32 v46, v46, v47
    v_cmp_gt_u32 vcc, 26, v46
    s_cbranch_vccz L114
    s_add_u32 s60, s60, 1
    s_cmp_lt_u32 s60, 3200000
    s_cbranch_scc1 L113
L114:
    v_mfma_f32_16x16x32_bf16 v[84:87], a[32:35], v[172:175], v[84:87]
    v_mfma_f32_16x16x32_bf16 v[68:71], a[36:39], v[168:171], v[68:71]
    buffer_load_dwordx4 v[132:135], v49, s[28:31], s92 offen offset:0 sc1
    v_mfma_f32_16x16x32_bf16 v[88:91], a[36:39], v[172:175], v[88:91]
    s_waitcnt vmcnt(8) lgkmcnt(6)
    v_mfma_f32_16x16x32_bf16 v[52:55], a[40:43], v[176:179], v[52:55]
    ds_read_b64 v[46:47], v39 offset:16
    ds_read_b128 a[20:23], v93 offset:57344
    v_mfma_f32_16x16x32_bf16 v[72:75], a[40:43], v[180:183], v[72:75]
    ds_read_b128 a[24:27], v93 offset:58368
    v_mfma_f32_16x16x32_bf16 v[56:59], a[44:47], v[176:179], v[56:59]
    ds_read_b128 a[28:31], v93 offset:59392
    v_mfma_f32_16x16x32_bf16 v[76:79], a[44:47], v[180:183], v[76:79]
    ds_read_b128 a[32:35], v93 offset:60416
    v_mfma_f32_16x16x32_bf16 v[60:63], a[48:51], v[176:179], v[60:63]
    ds_read_b128 a[36:39], v93 offset:61440
    v_mfma_f32_16x16x32_bf16 v[80:83], a[48:51], v[180:183], v[80:83]
    buffer_load_dwordx4 v[136:139], v48, s[28:31], s92 offen offset:2048 sc1
    v_mfma_f32_16x16x32_bf16 v[64:67], a[52:55], v[176:179], v[64:67]
    v_mfma_f32_16x16x32_bf16 v[84:87], a[52:55], v[180:183], v[84:87]
    v_mov_b32 v0, 24
    ds_write_b32 v45, v0
    v_mfma_f32_16x16x32_bf16 v[68:71], a[56:59], v[176:179], v[68:71]
    buffer_load_dwordx4 v[140:143], v49, s[28:31], s92 offen offset:2048 sc1
    v_mfma_f32_16x16x32_bf16 v[88:91], a[56:59], v[180:183], v[88:91]
    s_waitcnt vmcnt(8) lgkmcnt(7)
    v_mfma_f32_16x16x32_bf16 v[52:55], a[0:3], v[184:187], v[52:55]
    ds_read_b128 a[40:43], v94 offset:2048
    v_mfma_f32_16x16x32_bf16 v[72:75], a[0:3], v[188:191], v[72:75]
    ds_read_b128 a[44:47], v94 offset:3072
    v_mfma_f32_16x16x32_bf16 v[56:59], a[4:7], v[184:187], v[56:59]
    ds_read_b128 a[48:51], v94 offset:4096
    v_mfma_f32_16x16x32_bf16 v[76:79], a[4:7], v[188:191], v[76:79]
    ds_read_b128 a[52:55], v94 offset:5120
    v_mfma_f32_16x16x32_bf16 v[60:63], a[8:11], v[184:187], v[60:63]
    ds_read_b128 a[56:59], v94 offset:6144
    v_mfma_f32_16x16x32_bf16 v[80:83], a[8:11], v[188:191], v[80:83]
    buffer_load_dwordx4 v[144:147], v48, s[28:31], s93 offen offset:0 sc1
    v_mfma_f32_16x16x32_bf16 v[64:67], a[12:15], v[184:187], v[64:67]
    s_waitcnt lgkmcnt(11)
    v_min_u32 v46, v46, v47
    v_cmp_gt_u32 vcc, 27, v46
    s_cbranch_vccz L116
    s_mov_b32 s60, 0
L115:
    ds_read_b64 v[46:47], v39 offset:16
    s_waitcnt lgkmcnt(0)
    v_min_u32 v46, v46, v47
    v_cmp_gt_u32 vcc, 27, v46
    s_cbranch_vccz L116
    s_add_u32 s60, s60, 1
    s_cmp_lt_u32 s60, 3200000
    s_cbranch_scc1 L115
L116:
    v_mfma_f32_16x16x32_bf16 v[84:87], a[12:15], v[188:191], v[84:87]
    v_mfma_f32_16x16x32_bf16 v[68:71], a[16:19], v[184:187], v[68:71]
    buffer_load_dwordx4 v[148:151], v49, s[28:31], s93 offen offset:0 sc1
    v_mfma_f32_16x16x32_bf16 v[88:91], a[16:19], v[188:191], v[88:91]
    s_waitcnt vmcnt(8) lgkmcnt(6)
    v_mfma_f32_16x16x32_bf16 v[52:55], a[20:23], v[112:115], v[52:55]
    ds_read_b64 v[46:47], v39 offset:16
    ds_read_b128 a[0:3], v92 offset:0
    v_mfma_f32_16x16x32_bf16 v[72:75], a[20:23], v[116:119], v[72:75]
    ds_read_b128 a[4:7], v92 offset:1024
    v_mfma_f32_16x16x32_bf16 v[56:59], a[24:27], v[112:115], v[56:59]
    ds_read_b128 a[8:11], v92 offset:2048
    v_mfma_f32_16x16x32_bf16 v[76:79], a[24:27], v[116:119], v[76:79]
    ds_read_b128 a[12:15], v92 offset:3072
    v_mfma_f32_16x16x32_bf16 v[60:63], a[28:31], v[112:115], v[60:63]
    ds_read_b128 a[16:19], v92 offset:4096
    v_mfma_f32_16x16x32_bf16 v[80:83], a[28:31], v[116:119], v[80:83]
    buffer_load_dwordx4 v[152:155], v48, s[28:31], s93 offen offset:2048 sc1
    v_mfma_f32_16x16x32_bf16 v[64:67], a[32:35], v[112:115], v[64:67]
    v_mfma_f32_16x16x32_bf16 v[84:87], a[32:35], v[116:119], v[84:87]
    v_mov_b32 v0, 25
    ds_write_b32 v45, v0
    v_mfma_f32_16x16x32_bf16 v[68:71], a[36:39], v[112:115], v[68:71]
    buffer_load_dwordx4 v[156:159], v49, s[28:31], s93 offen offset:2048 sc1
    v_mfma_f32_16x16x32_bf16 v[88:91], a[36:39], v[116:119], v[88:91]
    s_waitcnt vmcnt(8) lgkmcnt(7)
    v_mfma_f32_16x16x32_bf16 v[52:55], a[40:43], v[120:123], v[52:55]
    ds_read_b128 a[20:23], v92 offset:10240
    v_mfma_f32_16x16x32_bf16 v[72:75], a[40:43], v[124:127], v[72:75]
    ds_read_b128 a[24:27], v92 offset:11264
    v_mfma_f32_16x16x32_bf16 v[56:59], a[44:47], v[120:123], v[56:59]
    ds_read_b128 a[28:31], v92 offset:12288
    v_mfma_f32_16x16x32_bf16 v[76:79], a[44:47], v[124:127], v[76:79]
    ds_read_b128 a[32:35], v92 offset:13312
    v_mfma_f32_16x16x32_bf16 v[60:63], a[48:51], v[120:123], v[60:63]
    ds_read_b128 a[36:39], v92 offset:14336
    v_mfma_f32_16x16x32_bf16 v[80:83], a[48:51], v[124:127], v[80:83]
    buffer_load_dwordx4 v[160:163], v48, s[28:31], s94 offen offset:0 sc1
    v_mfma_f32_16x16x32_bf16 v[64:67], a[52:55], v[120:123], v[64:67]
    s_waitcnt lgkmcnt(11)
    v_min_u32 v46, v46, v47
    v_cmp_gt_u32 vcc, 28, v46
    s_cbranch_vccz L118
    s_mov_b32 s60, 0
L117:
    ds_read_b64 v[46:47], v39 offset:16
    s_waitcnt lgkmcnt(0)
    v_min_u32 v46, v46, v47
    v_cmp_gt_u32 vcc, 28, v46
    s_cbranch_vccz L118
    s_add_u32 s60, s60, 1
    s_cmp_lt_u32 s60, 3200000
    s_cbranch_scc1 L117
L118:
    v_mfma_f32_16x16x32_bf16 v[84:87], a[52:55], v[124:127], v[84:87]
    v_mfma_f32_16x16x32_bf16 v[68:71], a[56:59], v[120:123], v[68:71]
    buffer_load_dwordx4 v[164:167], v49, s[28:31], s94 offen offset:0 sc1
    v_mfma_f32_16x16x32_bf16 v[88:91], a[56:59], v[124:127], v[88:91]
    s_waitcnt vmcnt(8) lgkmcnt(6)
    v_mfma_f32_16x16x32_bf16 v[52:55], a[0:3], v[128:131], v[52:55]
    ds_read_b64 v[46:47], v39 offset:24
    ds_read_b128 a[40:43], v92 offset:20480
    v_mfma_f32_16x16x32_bf16 v[72:75], a[0:3], v[132:135], v[72:75]
    ds_read_b128 a[44:47], v92 offset:21504
    v_mfma_f32_16x16x32_bf16 v[56:59], a[4:7], v[128:131], v[56:59]
    ds_read_b128 a[48:51], v92 offset:22528
    v_mfma_f32_16x16x32_bf16 v[76:79], a[4:7], v[132:135], v[76:79]
    ds_read_b128 a[52:55], v92 offset:23552
    v_mfma_f32_16x16x32_bf16 v[60:63], a[8:11], v[128:131], v[60:63]
    ds_read_b128 a[56:59], v92 offset:24576
    v_mfma_f32_16x16x32_bf16 v[80:83], a[8:11], v[132:135], v[80:83]
    buffer_load_dwordx4 v[168:171], v48, s[28:31], s94 offen offset:2048 sc1
    v_mfma_f32_16x16x32_bf16 v[64:67], a[12:15], v[128:131], v[64:67]
    v_mfma_f32_16x16x32_bf16 v[84:87], a[12:15], v[132:135], v[84:87]
    v_mfma_f32_16x16x32_bf16 v[68:71], a[16:19], v[128:131], v[68:71]
    buffer_load_dwordx4 v[172:175], v49, s[28:31], s94 offen offset:2048 sc1
    v_mfma_f32_16x16x32_bf16 v[88:91], a[16:19], v[132:135], v[88:91]
    s_waitcnt vmcnt(8) lgkmcnt(6)
    v_mfma_f32_16x16x32_bf16 v[52:55], a[20:23], v[136:139], v[52:55]
    ds_read_b128 a[0:3], v92 offset:30720
    v_mfma_f32_16x16x32_bf16 v[72:75], a[20:23], v[140:143], v[72:75]
    ds_read_b128 a[4:7], v92 offset:31744
    v_mfma_f32_16x16x32_bf16 v[56:59], a[24:27], v[136:139], v[56:59]
    ds_read_b128 a[8:11], v92 offset:32768
    v_mfma_f32_16x16x32_bf16 v[76:79], a[24:27], v[140:143], v[76:79]
    ds_read_b128 a[12:15], v92 offset:33792
    v_mfma_f32_16x16x32_bf16 v[60:63], a[28:31], v[136:139], v[60:63]
    ds_read_b128 a[16:19], v92 offset:34816
    v_mfma_f32_16x16x32_bf16 v[80:83], a[28:31], v[140:143], v[80:83]
    buffer_load_dwordx4 v[176:179], v48, s[28:31], s95 offen offset:0 sc1
    v_mfma_f32_16x16x32_bf16 v[64:67], a[32:35], v[136:139], v[64:67]
    s_waitcnt lgkmcnt(10)
    v_min_u32 v46, v46, v47
    v_cmp_gt_u32 vcc, 11, v46
    s_cbranch_vccz L120
    s_mov_b32 s60, 0
L119:
    ds_read_b64 v[46:47], v39 offset:24
    s_waitcnt lgkmcnt(0)
    v_min_u32 v46, v46, v47
    v_cmp_gt_u32 vcc, 11, v46
    s_cbranch_vccz L120
    s_add_u32 s60, s60, 1
    s_cmp_lt_u32 s60, 3200000
    s_cbranch_scc1 L119
L120:
    v_mfma_f32_16x16x32_bf16 v[84:87], a[32:35], v[140:143], v[84:87]
    v_mfma_f32_16x16x32_bf16 v[68:71], a[36:39], v[136:139], v[68:71]
    buffer_load_dwordx4 v[180:183], v49, s[28:31], s95 offen offset:0 sc1
    v_mfma_f32_16x16x32_bf16 v[88:91], a[36:39], v[140:143], v[88:91]
    s_waitcnt vmcnt(8) lgkmcnt(5)
    v_mfma_f32_16x16x32_bf16 v[52:55], a[40:43], v[144:147], v[52:55]
    ds_read_b64 v[46:47], v39 offset:24
    ds_read_b128 a[20:23], v92 offset:40960
    v_mfma_f32_16x16x32_bf16 v[72:75], a[40:43], v[148:151], v[72:75]
    ds_read_b128 a[24:27], v92 offset:41984
    v_mfma_f32_16x16x32_bf16 v[56:59], a[44:47], v[144:147], v[56:59]
    ds_read_b128 a[28:31], v92 offset:43008
    v_mfma_f32_16x16x32_bf16 v[76:79], a[44:47], v[148:151], v[76:79]
    ds_read_b128 a[32:35], v92 offset:44032
    v_mfma_f32_16x16x32_bf16 v[60:63], a[48:51], v[144:147], v[60:63]
    ds_read_b128 a[36:39], v92 offset:45056
    v_mfma_f32_16x16x32_bf16 v[80:83], a[48:51], v[148:151], v[80:83]
    buffer_load_dwordx4 v[184:187], v48, s[28:31], s95 offen offset:2048 sc1
    v_mfma_f32_16x16x32_bf16 v[64:67], a[52:55], v[144:147], v[64:67]
    v_mfma_f32_16x16x32_bf16 v[84:87], a[52:55], v[148:151], v[84:87]
    v_mfma_f32_16x16x32_bf16 v[68:71], a[56:59], v[144:147], v[68:71]
    buffer_load_dwordx4 v[188:191], v49, s[28:31], s95 offen offset:2048 sc1
    v_mfma_f32_16x16x32_bf16 v[88:91], a[56:59], v[148:151], v[88:91]
    s_waitcnt vmcnt(8) lgkmcnt(6)
    v_mfma_f32_16x16x32_bf16 v[52:55], a[0:3], v[152:155], v[52:55]
    ds_read_b128 a[40:43], v92 offset:51200
    v_mfma_f32_16x16x32_bf16 v[72:75], a[0:3], v[156:159], v[72:75]
    ds_read_b128 a[44:47], v92 offset:52224
    v_mfma_f32_16x16x32_bf16 v[56:59], a[4:7], v[152:155], v[56:59]
    ds_read_b128 a[48:51], v92 offset:53248
    v_mfma_f32_16x16x32_bf16 v[76:79], a[4:7], v[156:159], v[76:79]
    ds_read_b128 a[52:55], v92 offset:54272
    v_mfma_f32_16x16x32_bf16 v[60:63], a[8:11], v[152:155], v[60:63]
    ds_read_b128 a[56:59], v92 offset:55296
    v_mfma_f32_16x16x32_bf16 v[80:83], a[8:11], v[156:159], v[80:83]
    buffer_load_dwordx4 v[112:115], v48, s[28:31], s96 offen offset:0 sc1
    v_mfma_f32_16x16x32_bf16 v[64:67], a[12:15], v[152:155], v[64:67]
    s_waitcnt lgkmcnt(10)
    v_min_u32 v46, v46, v47
    v_cmp_gt_u32 vcc, 12, v46
    s_cbranch_vccz L122
    s_mov_b32 s60, 0
L121:
    ds_read_b64 v[46:47], v39 offset:24
    s_waitcnt lgkmcnt(0)
    v_min_u32 v46, v46, v47
    v_cmp_gt_u32 vcc, 12, v46
    s_cbranch_vccz L122
    s_add_u32 s60, s60, 1
    s_cmp_lt_u32 s60, 3200000
    s_cbranch_scc1 L121
L122:
    v_mfma_f32_16x16x32_bf16 v[84:87], a[12:15], v[156:159], v[84:87]
    v_mfma_f32_16x16x32_bf16 v[68:71], a[16:19], v[152:155], v[68:71]
    buffer_load_dwordx4 v[116:119], v49, s[28:31], s96 offen offset:0 sc1
    v_mfma_f32_16x16x32_bf16 v[88:91], a[16:19], v[156:159], v[88:91]
    s_waitcnt vmcnt(8) lgkmcnt(5)
    v_mfma_f32_16x16x32_bf16 v[52:55], a[20:23], v[160:163], v[52:55]
    ds_read_b64 v[46:47], v39 offset:24
    ds_read_b128 a[0:3], v92 offset:61440
    v_mfma_f32_16x16x32_bf16 v[72:75], a[20:23], v[164:167], v[72:75]
    ds_read_b128 a[4:7], v92 offset:62464
    v_mfma_f32_16x16x32_bf16 v[56:59], a[24:27], v[160:163], v[56:59]
    ds_read_b128 a[8:11], v92 offset:63488
    v_mfma_f32_16x16x32_bf16 v[76:79], a[24:27], v[164:167], v[76:79]
    ds_read_b128 a[12:15], v92 offset:64512
    v_mfma_f32_16x16x32_bf16 v[60:63], a[28:31], v[160:163], v[60:63]
    ds_read_b128 a[16:19], v93 offset:0
    v_mfma_f32_16x16x32_bf16 v[80:83], a[28:31], v[164:167], v[80:83]
    buffer_load_dwordx4 v[120:123], v48, s[28:31], s96 offen offset:2048 sc1
    v_mfma_f32_16x16x32_bf16 v[64:67], a[32:35], v[160:163], v[64:67]
    v_mfma_f32_16x16x32_bf16 v[84:87], a[32:35], v[164:167], v[84:87]
    v_mov_b32 v0, 26
    ds_write_b32 v45, v0
    v_mfma_f32_16x16x32_bf16 v[68:71], a[36:39], v[160:163], v[68:71]
    buffer_load_dwordx4 v[124:127], v49, s[28:31], s96 offen offset:2048 sc1
    v_mfma_f32_16x16x32_bf16 v[88:91], a[36:39], v[164:167], v[88:91]
    s_waitcnt vmcnt(8) lgkmcnt(7)
    v_mfma_f32_16x16x32_bf16 v[52:55], a[40:43], v[168:171], v[52:55]
    ds_read_b128 a[20:23], v93 offset:6144
    v_mfma_f32_16x16x32_bf16 v[72:75], a[40:43], v[172:175], v[72:75]
    ds_read_b128 a[24:27], v93 offset:7168
    v_mfma_f32_16x16x32_bf16 v[56:59], a[44:47], v[168:171], v[56:59]
    ds_read_b128 a[28:31], v93 offset:8192
    v_mfma_f32_16x16x32_bf16 v[76:79], a[44:47], v[172:175], v[76:79]
    ds_read_b128 a[32:35], v93 offset:9216
    v_mfma_f32_16x16x32_bf16 v[60:63], a[48:51], v[168:171], v[60:63]
    ds_read_b128 a[36:39], v93 offset:10240
    v_mfma_f32_16x16x32_bf16 v[80:83], a[48:51], v[172:175], v[80:83]
    buffer_load_dwordx4 v[128:131], v48, s[28:31], s97 offen offset:0 sc1
    v_mfma_f32_16x16x32_bf16 v[64:67], a[52:55], v[168:171], v[64:67]
    s_waitcnt lgkmcnt(11)
    v_min_u32 v46, v46, v47
    v_cmp_gt_u32 vcc, 13, v46
    s_cbranch_vccz L124
    s_mov_b32 s60, 0
L123:
    ds_read_b64 v[46:47], v39 offset:24
    s_waitcnt lgkmcnt(0)
    v_min_u32 v46, v46, v47
    v_cmp_gt_u32 vcc, 13, v46
    s_cbranch_vccz L124
    s_add_u32 s60, s60, 1
    s_cmp_lt_u32 s60, 3200000
    s_cbranch_scc1 L123
L124:
    v_mfma_f32_16x16x32_bf16 v[84:87], a[52:55], v[172:175], v[84:87]
    v_mfma_f32_16x16x32_bf16 v[68:71], a[56:59], v[168:171], v[68:71]
    buffer_load_dwordx4 v[132:135], v49, s[28:31], s97 offen offset:0 sc1
    v_mfma_f32_16x16x32_bf16 v[88:91], a[56:59], v[172:175], v[88:91]
    s_waitcnt vmcnt(8) lgkmcnt(6)
    v_mfma_f32_16x16x32_bf16 v[52:55], a[0:3], v[176:179], v[52:55]
    ds_read_b64 v[46:47], v39 offset:16
    ds_read_b128 a[40:43], v93 offset:16384
    v_mfma_f32_16x16x32_bf16 v[72:75], a[0:3], v[180:183], v[72:75]
    ds_read_b128 a[44:47], v93 offset:17408
    v_mfma_f32_16x16x32_bf16 v[56:59], a[4:7], v[176:179], v[56:59]
    ds_read_b128 a[48:51], v93 offset:18432
    v_mfma_f32_16x16x32_bf16 v[76:79], a[4:7], v[180:183], v[76:79]
    ds_read_b128 a[52:55], v93 offset:19456
    v_mfma_f32_16x16x32_bf16 v[60:63], a[8:11], v[176:179], v[60:63]
    ds_read_b128 a[56:59], v93 offset:20480
    v_mfma_f32_16x16x32_bf16 v[80:83], a[8:11], v[180:183], v[80:83]
    buffer_load_dwordx4 v[136:139], v48, s[28:31], s97 offen offset:2048 sc1
    v_mfma_f32_16x16x32_bf16 v[64:67], a[12:15], v[176:179], v[64:67]
    v_mfma_f32_16x16x32_bf16 v[84:87], a[12:15], v[180:183], v[84:87]
    v_mfma_f32_16x16x32_bf16 v[68:71], a[16:19], v[176:179], v[68:71]
    buffer_load_dwordx4 v[140:143], v49, s[28:31], s97 offen offset:2048 sc1
    v_mfma_f32_16x16x32_bf16 v[88:91], a[16:19], v[180:183], v[88:91]
    s_waitcnt vmcnt(8) lgkmcnt(6)
    v_mfma_f32_16x16x32_bf16 v[52:55], a[20:23], v[184:187], v[52:55]
    ds_read_b128 a[0:3], v93 offset:26624
    v_mfma_f32_16x16x32_bf16 v[72:75], a[20:23], v[188:191], v[72:75]
    ds_read_b128 a[4:7], v93 offset:27648
    v_mfma_f32_16x16x32_bf16 v[56:59], a[24:27], v[184:187], v[56:59]
    ds_read_b128 a[8:11], v93 offset:28672
    v_mfma_f32_16x16x32_bf16 v[76:79], a[24:27], v[188:191], v[76:79]
    ds_read_b128 a[12:15], v93 offset:29696
    v_mfma_f32_16x16x32_bf16 v[60:63], a[28:31], v[184:187], v[60:63]
    ds_read_b128 a[16:19], v93 offset:30720
    v_mfma_f32_16x16x32_bf16 v[80:83], a[28:31], v[188:191], v[80:83]
    buffer_load_dwordx4 v[144:147], v48, s[28:31], s98 offen offset:0 sc1
    v_mfma_f32_16x16x32_bf16 v[64:67], a[32:35], v[184:187], v[64:67]
    s_waitcnt lgkmcnt(10)
    v_min_u32 v46, v46, v47
    v_cmp_gt_u32 vcc, 32, v46
    s_cbranch_vccz L126
    s_mov_b32 s60, 0
L125:
    ds_read_b64 v[46:47], v39 offset:16
    s_waitcnt lgkmcnt(0)
    v_min_u32 v46, v46, v47
    v_cmp_gt_u32 vcc, 32, v46
    s_cbranch_vccz L126
    s_add_u32 s60, s60, 1
    s_cmp_lt_u32 s60, 3200000
    s_cbranch_scc1 L125
L126:
    v_mfma_f32_16x16x32_bf16 v[84:87], a[32:35], v[188:191], v[84:87]
    v_mfma_f32_16x16x32_bf16 v[68:71], a[36:39], v[184:187], v[68:71]
    buffer_load_dwordx4 v[148:151], v49, s[28:31], s98 offen offset:0 sc1
    v_mfma_f32_16x16x32_bf16 v[88:91], a[36:39], v[188:191], v[88:91]
    s_waitcnt vmcnt(8) lgkmcnt(5)
    v_mfma_f32_16x16x32_bf16 v[52:55], a[40:43], v[112:115], v[52:55]
    ds_read_b64 v[46:47], v39 offset:16
    ds_read_b128 a[20:23], v93 offset:36864
    v_mfma_f32_16x16x32_bf16 v[72:75], a[40:43], v[116:119], v[72:75]
    ds_read_b128 a[24:27], v93 offset:37888
    v_mfma_f32_16x16x32_bf16 v[56:59], a[44:47], v[112:115], v[56:59]
    ds_read_b128 a[28:31], v93 offset:38912
    v_mfma_f32_16x16x32_bf16 v[76:79], a[44:47], v[116:119], v[76:79]
    ds_read_b128 a[32:35], v93 offset:39936
    v_mfma_f32_16x16x32_bf16 v[60:63], a[48:51], v[112:115], v[60:63]
    ds_read_b128 a[36:39], v93 offset:40960
    v_mfma_f32_16x16x32_bf16 v[80:83], a[48:51], v[116:119], v[80:83]
    buffer_load_dwordx4 v[152:155], v48, s[28:31], s98 offen offset:2048 sc1
    v_mfma_f32_16x16x32_bf16 v[64:67], a[52:55], v[112:115], v[64:67]
    v_mfma_f32_16x16x32_bf16 v[84:87], a[52:55], v[116:119], v[84:87]
    v_mfma_f32_16x16x32_bf16 v[68:71], a[56:59], v[112:115], v[68:71]
    buffer_load_dwordx4 v[156:159], v49, s[28:31], s98 offen offset:2048 sc1
    v_mfma_f32_16x16x32_bf16 v[88:91], a[56:59], v[116:119], v[88:91]
    s_waitcnt vmcnt(8) lgkmcnt(6)
    v_mfma_f32_16x16x32_bf16 v[52:55], a[0:3], v[120:123], v[52:55]
    ds_read_b128 a[40:43], v93 offset:47104
    v_mfma_f32_16x16x32_bf16 v[72:75], a[0:3], v[124:127], v[72:75]
    ds_read_b128 a[44:47], v93 offset:48128
    v_mfma_f32_16x16x32_bf16 v[56:59], a[4:7], v[120:123], v[56:59]
    ds_read_b128 a[48:51], v93 offset:49152
    v_mfma_f32_16x16x32_bf16 v[76:79], a[4:7], v[124:127], v[76:79]
    ds_read_b128 a[52:55], v93 offset:50176
    v_mfma_f32_16x16x32_bf16 v[60:63], a[8:11], v[120:123], v[60:63]
    ds_read_b128 a[56:59], v93 offset:51200
    v_mfma_f32_16x16x32_bf16 v[80:83], a[8:11], v[124:127], v[80:83]
    buffer_load_dwordx4 v[160:163], v48, s[28:31], s66 offen offset:0 sc1
    v_mfma_f32_16x16x32_bf16 v[64:67], a[12:15], v[120:123], v[64:67]
    s_waitcnt lgkmcnt(10)
    v_min_u32 v46, v46, v47
    v_cmp_gt_u32 vcc, 33, v46
    s_cbranch_vccz L128
    s_mov_b32 s60, 0
L127:
    ds_read_b64 v[46:47], v39 offset:16
    s_waitcnt lgkmcnt(0)
    v_min_u32 v46, v46, v47
    v_cmp_gt_u32 vcc, 33, v46
    s_cbranch_vccz L128
    s_add_u32 s60, s60, 1
    s_cmp_lt_u32 s60, 3200000
    s_cbranch_scc1 L127
L128:
    v_mfma_f32_16x16x32_bf16 v[84:87], a[12:15], v[124:127], v[84:87]
    v_mfma_f32_16x16x32_bf16 v[68:71], a[16:19], v[120:123], v[68:71]
    buffer_load_dwordx4 v[164:167], v49, s[28:31], s66 offen offset:0 sc1
    v_mfma_f32_16x16x32_bf16 v[88:91], a[16:19], v[124:127], v[88:91]
    s_waitcnt vmcnt(8) lgkmcnt(5)
    v_mfma_f32_16x16x32_bf16 v[52:55], a[20:23], v[128:131], v[52:55]
    ds_read_b128 a[0:3], v93 offset:57344
    v_mfma_f32_16x16x32_bf16 v[72:75], a[20:23], v[132:135], v[72:75]
    ds_read_b128 a[4:7], v93 offset:58368
    v_mfma_f32_16x16x32_bf16 v[56:59], a[24:27], v[128:131], v[56:59]
    ds_read_b128 a[8:11], v93 offset:59392
    v_mfma_f32_16x16x32_bf16 v[76:79], a[24:27], v[132:135], v[76:79]
    ds_read_b128 a[12:15], v93 offset:60416
    v_mfma_f32_16x16x32_bf16 v[60:63], a[28:31], v[128:131], v[60:63]
    ds_read_b128 a[16:19], v93 offset:61440
    v_mfma_f32_16x16x32_bf16 v[80:83], a[28:31], v[132:135], v[80:83]
    v_mfma_f32_16x16x32_bf16 v[64:67], a[32:35], v[128:131], v[64:67]
    v_mfma_f32_16x16x32_bf16 v[84:87], a[32:35], v[132:135], v[84:87]
    v_mfma_f32_16x16x32_bf16 v[68:71], a[36:39], v[128:131], v[68:71]
    v_mfma_f32_16x16x32_bf16 v[88:91], a[36:39], v[132:135], v[88:91]
    s_waitcnt vmcnt(6) lgkmcnt(5)
    v_mfma_f32_16x16x32_bf16 v[52:55], a[40:43], v[136:139], v[52:55]
    ds_read_b128 a[20:23], v94 offset:2048
    v_mfma_f32_16x16x32_bf16 v[72:75], a[40:43], v[140:143], v[72:75]
    ds_read_b128 a[24:27], v94 offset:3072
    v_mfma_f32_16x16x32_bf16 v[56:59], a[44:47], v[136:139], v[56:59]
    ds_read_b128 a[28:31], v94 offset:4096
    v_mfma_f32_16x16x32_bf16 v[76:79], a[44:47], v[140:143], v[76:79]
    ds_read_b128 a[32:35], v94 offset:5120
    v_mfma_f32_16x16x32_bf16 v[60:63], a[48:51], v[136:139], v[60:63]
    ds_read_b128 a[36:39], v94 offset:6144
    v_mfma_f32_16x16x32_bf16 v[80:83], a[48:51], v[140:143], v[80:83]
    v_mfma_f32_16x16x32_bf16 v[64:67], a[52:55], v[136:139], v[64:67]
    v_mfma_f32_16x16x32_bf16 v[84:87], a[52:55], v[140:143], v[84:87]
    v_mfma_f32_16x16x32_bf16 v[68:71], a[56:59], v[136:139], v[68:71]
    v_mfma_f32_16x16x32_bf16 v[88:91], a[56:59], v[140:143], v[88:91]
    s_waitcnt vmcnt(4) lgkmcnt(5)
    v_mfma_f32_16x16x32_bf16 v[52:55], a[0:3], v[144:147], v[52:55]
    ds_read_b128 a[40:43], v94 offset:12288
    v_mfma_f32_16x16x32_bf16 v[72:75], a[0:3], v[148:151], v[72:75]
    ds_read_b128 a[44:47], v94 offset:13312
    v_mfma_f32_16x16x32_bf16 v[56:59], a[4:7], v[144:147], v[56:59]
    ds_read_b128 a[48:51], v94 offset:14336
    v_mfma_f32_16x16x32_bf16 v[76:79], a[4:7], v[148:151], v[76:79]
    ds_read_b128 a[52:55], v94 offset:15360
    v_mfma_f32_16x16x32_bf16 v[60:63], a[8:11], v[144:147], v[60:63]
    ds_read_b128 a[56:59], v94 offset:16384
    v_mfma_f32_16x16x32_bf16 v[80:83], a[8:11], v[148:151], v[80:83]
    v_mfma_f32_16x16x32_bf16 v[64:67], a[12:15], v[144:147], v[64:67]
    v_mfma_f32_16x16x32_bf16 v[84:87], a[12:15], v[148:151], v[84:87]
    ds_read_b128 v[96:99], v39
    v_mfma_f32_16x16x32_bf16 v[68:71], a[16:19], v[144:147], v[68:71]
    v_mfma_f32_16x16x32_bf16 v[88:91], a[16:19], v[148:151], v[88:91]
    s_waitcnt vmcnt(2) lgkmcnt(6)
    v_mfma_f32_16x16x32_bf16 v[52:55], a[20:23], v[152:155], v[52:55]
    v_mfma_f32_16x16x32_bf16 v[72:75], a[20:23], v[156:159], v[72:75]
    v_mfma_f32_16x16x32_bf16 v[56:59], a[24:27], v[152:155], v[56:59]
    v_mfma_f32_16x16x32_bf16 v[76:79], a[24:27], v[156:159], v[76:79]
    v_mfma_f32_16x16x32_bf16 v[60:63], a[28:31], v[152:155], v[60:63]
    v_mfma_f32_16x16x32_bf16 v[80:83], a[28:31], v[156:159], v[80:83]
    v_mfma_f32_16x16x32_bf16 v[64:67], a[32:35], v[152:155], v[64:67]
    v_mfma_f32_16x16x32_bf16 v[84:87], a[32:35], v[156:159], v[84:87]
    v_mfma_f32_16x16x32_bf16 v[68:71], a[36:39], v[152:155], v[68:71]
    v_mfma_f32_16x16x32_bf16 v[88:91], a[36:39], v[156:159], v[88:91]
    s_waitcnt vmcnt(0) lgkmcnt(1)
    v_mfma_f32_16x16x32_bf16 v[72:75], a[40:43], v[164:167], v[72:75]
    v_mfma_f32_16x16x32_bf16 v[76:79], a[44:47], v[164:167], v[76:79]
    s_waitcnt lgkmcnt(0)
    v_min_u32_e64 v96, v96, v97
    v_min3_u32 v46, v96, v98, v99
    v_cmp_gt_u32 vcc, 26, v46
    s_cbranch_vccz L130
    s_mov_b32 s60, 0
L129:
    ds_read_b128 v[96:99], v39 offset:0
    s_waitcnt lgkmcnt(0)
    v_min_u32_e64 v96, v96, v97
    v_min3_u32 v46, v96, v98, v99
    v_cmp_gt_u32 vcc, 26, v46
    s_cbranch_vccz L130
    s_add_u32 s60, s60, 1
    s_cmp_lt_u32 s60, 3200000
    s_cbranch_scc1 L129
L130:
    v_mfma_f32_16x16x32_bf16 v[80:83], a[48:51], v[164:167], v[80:83]
    v_mfma_f32_16x16x32_bf16 v[84:87], a[52:55], v[164:167], v[84:87]
    v_mfma_f32_16x16x32_bf16 v[88:91], a[56:59], v[164:167], v[88:91]
    v_mfma_f32_16x16x32_bf16 v[52:55], a[40:43], v[160:163], v[52:55]
    v_mfma_f32_16x16x32_bf16 v[56:59], a[44:47], v[160:163], v[56:59]
    v_mfma_f32_16x16x32_bf16 v[60:63], a[48:51], v[160:163], v[60:63]
    ds_write_b128 v100, v[72:75] offset:0
    v_mfma_f32_16x16x32_bf16 v[64:67], a[52:55], v[160:163], v[64:67]
    ds_write_b128 v100, v[76:79] offset:1024
    v_mfma_f32_16x16x32_bf16 v[68:71], a[56:59], v[160:163], v[68:71]
    ds_write_b128 v100, v[80:83] offset:2048
    ds_write_b128 v100, v[84:87] offset:3072
    ds_write_b128 v100, v[88:91] offset:4096
    v_mov_b32_e64 v0, 27
    ds_write_b32 v45, v0
    s_mov_b32 s60, 0
L131:
    ds_read_b32 v46, v102
    s_waitcnt lgkmcnt(0)
    v_cmp_gt_u32 vcc, 27, v46
    s_cbranch_vccz L132
    s_add_u32 s60, s60, 1
    s_cmp_lt_u32 s60, 3200000
    s_cbranch_scc1 L131
L132:
    ds_read_b128 v[72:75], v101 offset:0
    ds_read_b128 v[76:79], v101 offset:1024
    ds_read_b128 v[80:83], v101 offset:2048
    ds_read_b128 v[84:87], v101 offset:3072
    ds_read_b128 v[88:91], v101 offset:4096
    s_waitcnt lgkmcnt(4)
    v_pk_add_f32 v[52:53], v[52:53], v[72:73]
    v_pk_add_f32 v[54:55], v[54:55], v[74:75]
    s_waitcnt lgkmcnt(3)
    v_pk_add_f32 v[56:57], v[56:57], v[76:77]
    v_pk_add_f32 v[58:59], v[58:59], v[78:79]
    s_waitcnt lgkmcnt(2)
    v_pk_add_f32 v[60:61], v[60:61], v[80:81]
    v_pk_add_f32 v[62:63], v[62:63], v[82:83]
    s_waitcnt lgkmcnt(1)
    v_pk_add_f32 v[64:65], v[64:65], v[84:85]
    v_pk_add_f32 v[66:67], v[66:67], v[86:87]
    s_waitcnt lgkmcnt(0)
    v_pk_add_f32 v[68:69], v[68:69], v[88:89]
    v_pk_add_f32 v[70:71], v[70:71], v[90:91]
    v_cvt_pk_bf16_f32 v92, v52, v53
    v_cvt_pk_bf16_f32 v93, v54, v55
    v_cvt_pk_bf16_f32 v94, v56, v57
    v_cvt_pk_bf16_f32 v95, v58, v59
    v_cvt_pk_bf16_f32 v96, v60, v61
    v_cvt_pk_bf16_f32 v97, v62, v63
    v_cvt_pk_bf16_f32 v98, v64, v65
    v_cvt_pk_bf16_f32 v99, v66, v67
    v_cvt_pk_bf16_f32 v100, v68, v69
    v_cvt_pk_bf16_f32 v101, v70, v71
    v_permlane16_swap_b32 v92, v94
    v_permlane16_swap_b32 v93, v95
    buffer_store_dwordx4 v[92:95], v37, s[36:39], 0 offen
    v_permlane16_swap_b32 v96, v98
    v_permlane16_swap_b32 v97, v99
    buffer_store_dwordx4 v[96:99], v37, s[36:39], 0 offen offset:64
    v_permlane16_swap_b32 v100, v102
    v_permlane16_swap_b32 v101, v103
    buffer_store_dwordx4 v[100:103], v38, s[36:39], 0 offen
    s_branch L_fin
L1:
    s_lshl_b32 s60, s42, 2
    s_add_u32 s60, s60, s40
    s_min_u32 s60, s60, CODE_KB-1
    s_lshl_b32 s60, s60, 10
    v_add_u32 v44, s60, v2
    v_mov_b32_e64 v48, 0
    v_lshl_add_u32 v49, v5, 2, v39
    ds_write_b32 v49, v48
    s_and_b32 s60, s45, 0
    s_lshl_b32 s60, s60, 1
    s_add_u32 s60, s60, s46
    s_mul_i32 s61, s60, 52
    s_lshr_b32 s61, s61, 8
    s_mul_i32 s61, s61, 5
    s_sub_u32 s60, s60, s61
    s_lshl_b32 s81, s60, 12
    s_add_u32 s82, s81, 4096
    s_cmp_eq_u32 s82, 20480
    s_cselect_b32 s82, 0, s82
    s_add_u32 s83, s82, 4096
    s_cmp_eq_u32 s83, 20480
    s_cselect_b32 s83, 0, s83
    s_add_u32 s84, s83, 4096
    s_cmp_eq_u32 s84, 20480
    s_cselect_b32 s84, 0, s84
    s_add_u32 s85, s84, 4096
    s_cmp_eq_u32 s85, 20480
    s_cselect_b32 s85, 0, s85
    s_bitcmp1_b32 s43, 1
    s_cselect_b32 s77, 0, 1
    s_cselect_b32 s78, 2, 3
    s_cselect_b32 s79, 1, 0
    s_cselect_b32 s80, 3, 2
    s_lshl_b32 s77, s77, 12
    s_lshl_b32 s78, s78, 12
    s_lshl_b32 s79, s79, 12
    s_lshl_b32 s80, s80, 12
    s_mov_b32 s60, 0
    s_and_b32 s60, s60, 3
    s_mul_i32 s60, s60, 3
    s_lshl_b32 s86, s60, 12
    s_add_u32 s87, s86, 4096
    s_cmp_eq_u32 s87, 53248
    s_cselect_b32 s87, 0, s87
    s_add_u32 s88, s87, 4096
    s_cmp_eq_u32 s88, 53248
    s_cselect_b32 s88, 0, s88
    s_add_u32 s89, s88, 4096
    s_cmp_eq_u32 s89, 53248
    s_cselect_b32 s89, 0, s89
    s_add_u32 s90, s89, 4096
    s_cmp_eq_u32 s90, 53248
    s_cselect_b32 s90, 0, s90
    s_add_u32 s91, s90, 4096
    s_cmp_eq_u32 s91, 53248
    s_cselect_b32 s91, 0, s91
    s_add_u32 s92, s91, 4096
    s_cmp_eq_u32 s92, 53248
    s_cselect_b32 s92, 0, s92
    s_add_u32 s93, s92, 4096
    s_cmp_eq_u32 s93, 53248
    s_cselect_b32 s93, 0, s93
    s_add_u32 s94, s93, 4096
    s_cmp_eq_u32 s94, 53248
    s_cselect_b32 s94, 0, s94
    s_add_u32 s95, s94, 4096
    s_cmp_eq_u32 s95, 53248
    s_cselect_b32 s95, 0, s95
    s_add_u32 s96, s95, 4096
    s_cmp_eq_u32 s96, 53248
    s_cselect_b32 s96, 0, s96
    s_add_u32 s97, s96, 4096
    s_cmp_eq_u32 s97, 53248
    s_cselect_b32 s97, 0, s97
    s_add_u32 s98, s97, 4096
    s_cmp_eq_u32 s98, 53248
    s_cselect_b32 s98, 0, s98
    s_cmp_gt_u32 s40, 1
    s_cbranch_scc1 L133
    s_mov_b32 s62, 0x80000000
    s_and_b32 s60, s41, 1
    s_lshl_b32 s60, s60, 1
    s_and_b32 s61, s42, 1
    s_add_u32 s60, s60, s61
    s_lshl_b32 s60, s60, 12
    s_lshr_b32 s61, s42, 1
    s_lshl_b32 s61, s61, 2
    s_lshr_b32 s63, s41, 1
    s_add_u32 s61, s61, s63
    s_lshl_b32 s61, s61, 7
    s_add_u32 s60, s60, s61
    s_add_u32 s60, s60, 0x2204000
    s_cmp_lt_u32 s2, 80
    s_cselect_b32 s62, s60, s62
    s_lshl_b32 s60, s2, 7
    s_add_u32 s60, s60, 0x21fc000
    s_cmp_ge_u32 s2, 128
    s_cselect_b32 s62, s60, s62
    v_mov_b32 v50, s62
    s_lshr_b32 s60, s46, 2
    s_lshl_b32 s60, s60, 12
    s_add_u32 s60, s60, 0x2204000
    v_lshl_add_u32 v52, v1, 7, s60
    v_min_u32 v53, 28, v1
    s_lshl_b32 s61, s45, 3
    s_sub_u32 s61, s61, 21
    v_add_u32 v53, s61, v53
    v_max_i32 v53, 0, v53
    v_lshlrev_b32 v53, 7, v53
    v_add_u32 v53, 0x2200000, v53
    v_cmp_gt_u32 vcc, 20, v1
    s_nop 1
    v_cndmask_b32_e64 v52, v53, v52, vcc
    s_waitcnt vmcnt(0) lgkmcnt(0)
    s_barrier
    s_mov_b32 s60, 0x9E3779B1
    v_mul_lo_u32 v3, v3, s60
    v_add_u32 v3, 0x7F4A7C15, v3
    s_mov_b32 s60, 0
L136:
    ds_read_b128 v[188:191], v39 offset:0
    s_waitcnt lgkmcnt(0)
    v_min_u32_e64 v188, v188, v189
    v_min3_u32 v46, v188, v190, v191
    v_cmp_gt_u32 vcc, 3, v46
    s_cbranch_vccz L137
    s_sleep 1
    s_add_u32 s60, s60, 1
    s_cmp_lt_u32 s60, 3200000
    s_cbranch_scc1 L136
L137:
    s_cmp_lg_u32 s40, 0
    s_cbranch_scc1 L134
    s_mov_b64 exec, 1
    buffer_store_dword v3, v50, s[28:31], 0 offen sc1
    s_mov_b64 exec, -1
    v_mov_b32 v0, 1
    ds_write_b32 v45, v0
    s_mov_b32 s60, 0
    v_not_b32 v0, v3
L138:
    v_mov_b32_e64 v4, v0
    buffer_load_dword v4, v52, s[28:31], 0 offen sc1
    s_mov_b32 s61, 0
L139:
    v_cmp_eq_u32 vcc, v4, v0
    s_cbranch_vccz L140
    s_add_u32 s61, s61, 1
    s_cmp_lt_u32 s61, 200
    s_cbranch_scc1 L139
L140:
    v_cmp_ne_u32 vcc, v4, v3
    s_cbranch_vccz L141
    s_add_u32 s60, s60, 1
    s_cmp_lt_u32 s60, 400000
    s_cbranch_scc1 L138
L141:
    s_branch L135
L134:
    v_mov_b32_e64 v0, 1
    ds_write_b32 v45, v0
    s_mov_b32 s60, 0
L142:
    ds_read_b32 v46, v39 offset:16
    s_waitcnt lgkmcnt(0)
    v_cmp_gt_u32 vcc, 2, v46
    s_cbranch_vccz L135
    s_add_u32 s60, s60, 1
    s_cmp_lt_u32 s60, 3200000
    s_cbranch_scc1 L142
L135:
    v_mov_b32_e64 v0, 2
    ds_write_b32 v45, v0
    s_mul_i32 s60, s46, 153600
    s_add_u32 s60, s60, 0x1600000
    v_add_u32 v176, s60, v2
    s_lshr_b32 s62, s81, 1
    s_mul_i32 s62, s62, 15
    s_add_u32 s62, s62, 0x0
    v_add_u32_e64 v178, s62, v176
    s_mul_i32 s62, s40, 15360
    s_add_u32 m0, s62, 0
    s_nop 0
    buffer_load_dwordx4 v178, s[28:31], m0 offen offset:0 sc1 lds
    buffer_load_dwordx4 v178, s[28:31], m0 offen offset:1024 sc1 lds
    buffer_load_dwordx4 v178, s[28:31], m0 offen offset:2048 sc1 lds
    buffer_load_dwordx4 v178, s[28:31], m0 offen offset:3072 sc1 lds
    s_add_u32 m0, m0, 4096
    s_nop 0
    buffer_load_dwordx4 v178, s[28:31], m0 offen offset:0 sc1 lds
    buffer_load_dwordx4 v178, s[28:31], m0 offen offset:1024 sc1 lds
    buffer_load_dwordx4 v178, s[28:31], m0 offen offset:2048 sc1 lds
    buffer_load_dwordx4 v178, s[28:31], m0 offen offset:3072 sc1 lds
    s_add_u32 m0, m0, 4096
    s_nop 0
    buffer_load_dwordx4 v178, s[28:31], m0 offen offset:0 sc1 lds
    buffer_load_dwordx4 v178, s[28:31], m0 offen offset:1024 sc1 lds
    buffer_load_dwordx4 v178, s[28:31], m0 offen offset:2048 sc1 lds
    buffer_load_dwordx4 v178, s[28:31], m0 offen offset:3072 sc1 lds
    s_add_u32 m0, m0, 4096
    s_nop 0
    buffer_load_dwordx4 v178, s[28:31], m0 offen offset:0 sc1 lds
    buffer_load_dwordx4 v178, s[28:31], m0 offen offset:1024 sc1 lds
    buffer_load_dwordx4 v178, s[28:31], m0 offen offset:2048 sc1 lds
    s_lshr_b32 s62, s82, 1
    s_mul_i32 s62, s62, 15
    s_add_u32 s62, s62, 0xffff8800
    v_add_u32 v178, s62, v176
    s_mul_i32 s62, s40, 15360
    s_add_u32 m0, s62, 30720
    s_waitcnt vmcnt(14)
    buffer_load_dwordx4 v178, s[28:31], m0 offen offset:0 sc1 lds
    s_waitcnt vmcnt(14)
    buffer_load_dwordx4 v178, s[28:31], m0 offen offset:1024 sc1 lds
    s_waitcnt vmcnt(14)
    buffer_load_dwordx4 v178, s[28:31], m0 offen offset:2048 sc1 lds
    s_waitcnt vmcnt(14)
    buffer_load_dwordx4 v178, s[28:31], m0 offen offset:3072 sc1 lds
    s_add_u32 m0, m0, 4096
    s_waitcnt vmcnt(14)
    buffer_load_dwordx4 v178, s[28:31], m0 offen offset:0 sc1 lds
    s_waitcnt vmcnt(14)
    buffer_load_dwordx4 v178, s[28:31], m0 offen offset:1024 sc1 lds
    s_waitcnt vmcnt(14)
    buffer_load_dwordx4 v178, s[28:31], m0 offen offset:2048 sc1 lds
    s_waitcnt vmcnt(14)
    buffer_load_dwordx4 v178, s[28:31], m0 offen offset:3072 sc1 lds
    s_add_u32 m0, m0, 4096
    s_waitcnt vmcnt(14)
    buffer_load_dwordx4 v178, s[28:31], m0 offen offset:0 sc1 lds
    s_waitcnt vmcnt(14)
    buffer_load_dwordx4 v178, s[28:31], m0 offen offset:1024 sc1 lds
    s_waitcnt vmcnt(14)
    buffer_load_dwordx4 v178, s[28:31], m0 offen offset:2048 sc1 lds
    s_waitcnt vmcnt(14)
    buffer_load_dwordx4 v178, s[28:31], m0 offen offset:3072 sc1 lds
    s_add_u32 m0, m0, 4096
    s_waitcnt vmcnt(14)
    buffer_load_dwordx4 v178, s[28:31], m0 offen offset:0 sc1 lds
    s_waitcnt vmcnt(14)
    buffer_load_dwordx4 v178, s[28:31], m0 offen offset:1024 sc1 lds
    s_waitcnt vmcnt(14)
    buffer_load_dwordx4 v178, s[28:31], m0 offen offset:2048 sc1 lds
    v_mov_b32 v0, 3
    ds_write_b32 v45, v0
    s_lshr_b32 s62, s83, 1
    s_mul_i32 s62, s62, 15
    s_add_u32 s62, s62, 0xffff1000
    v_add_u32_e64 v178, s62, v176
    s_mul_i32 s62, s40, 15360
    s_add_u32 m0, s62, 61440
    s_waitcnt vmcnt(14)
    buffer_load_dwordx4 v178, s[28:31], m0 offen offset:0 sc1 lds
    s_waitcnt vmcnt(14)
    buffer_load_dwordx4 v178, s[28:31], m0 offen offset:1024 sc1 lds
    s_waitcnt vmcnt(14)
    buffer_load_dwordx4 v178, s[28:31], m0 offen offset:2048 sc1 lds
    s_waitcnt vmcnt(14)
    buffer_load_dwordx4 v178, s[28:31], m0 offen offset:3072 sc1 lds
    s_add_u32 m0, m0, 4096
    s_waitcnt vmcnt(14)
    buffer_load_dwordx4 v178, s[28:31], m0 offen offset:0 sc1 lds
    s_waitcnt vmcnt(14)
    buffer_load_dwordx4 v178, s[28:31], m0 offen offset:1024 sc1 lds
    s_waitcnt vmcnt(14)
    buffer_load_dwordx4 v178, s[28:31], m0 offen offset:2048 sc1 lds
    s_waitcnt vmcnt(14)
    buffer_load_dwordx4 v178, s[28:31], m0 offen offset:3072 sc1 lds
    s_add_u32 m0, m0, 4096
    s_waitcnt vmcnt(14)
    buffer_load_dwordx4 v178, s[28:31], m0 offen offset:0 sc1 lds
    s_waitcnt vmcnt(14)
    buffer_load_dwordx4 v178, s[28:31], m0 offen offset:1024 sc1 lds
    s_waitcnt vmcnt(14)
    buffer_load_dwordx4 v178, s[28:31], m0 offen offset:2048 sc1 lds
    s_waitcnt vmcnt(14)
    buffer_load_dwordx4 v178, s[28:31], m0 offen offset:3072 sc1 lds
    s_add_u32 m0, m0, 4096
    s_waitcnt vmcnt(14)
    buffer_load_dwordx4 v178, s[28:31], m0 offen offset:0 sc1 lds
    s_waitcnt vmcnt(14)
    buffer_load_dwordx4 v178, s[28:31], m0 offen offset:1024 sc1 lds
    s_waitcnt vmcnt(14)
    buffer_load_dwordx4 v178, s[28:31], m0 offen offset:2048 sc1 lds
    v_mov_b32 v0, 4
    ds_write_b32 v45, v0
    s_mov_b32 s60, 0
L143:
    ds_read_b64 v[46:47], v39 offset:24
    s_waitcnt lgkmcnt(0)
    v_min_u32 v46, v46, v47
    v_cmp_gt_u32 vcc, 1, v46
    s_cbranch_vccz L144
    s_sleep 1
    s_add_u32 s60, s60, 1
    s_cmp_lt_u32 s60, 3200000
    s_cbranch_scc1 L143
L144:
    s_lshr_b32 s62, s84, 1
    s_mul_i32 s62, s62, 15
    s_add_u32 s62, s62, 0xfffe9800
    v_add_u32_e64 v178, s62, v176
    s_mul_i32 s62, s40, 15360
    s_add_u32 m0, s62, 92160
    s_waitcnt vmcnt(14)
    buffer_load_dwordx4 v178, s[28:31], m0 offen offset:0 sc1 lds
    s_waitcnt vmcnt(14)
    buffer_load_dwordx4 v178, s[28:31], m0 offen offset:1024 sc1 lds
    s_waitcnt vmcnt(14)
    buffer_load_dwordx4 v178, s[28:31], m0 offen offset:2048 sc1 lds
    s_waitcnt vmcnt(14)
    buffer_load_dwordx4 v178, s[28:31], m0 offen offset:3072 sc1 lds
    s_add_u32 m0, m0, 4096
    s_waitcnt vmcnt(14)
    buffer_load_dwordx4 v178, s[28:31], m0 offen offset:0 sc1 lds
    s_waitcnt vmcnt(14)
    buffer_load_dwordx4 v178, s[28:31], m0 offen offset:1024 sc1 lds
    s_waitcnt vmcnt(14)
    buffer_load_dwordx4 v178, s[28:31], m0 offen offset:2048 sc1 lds
    s_waitcnt vmcnt(14)
    buffer_load_dwordx4 v178, s[28:31], m0 offen offset:3072 sc1 lds
    s_add_u32 m0, m0, 4096
    s_waitcnt vmcnt(14)
    buffer_load_dwordx4 v178, s[28:31], m0 offen offset:0 sc1 lds
    s_waitcnt vmcnt(14)
    buffer_load_dwordx4 v178, s[28:31], m0 offen offset:1024 sc1 lds
    s_waitcnt vmcnt(14)
    buffer_load_dwordx4 v178, s[28:31], m0 offen offset:2048 sc1 lds
    s_waitcnt vmcnt(14)
    buffer_load_dwordx4 v178, s[28:31], m0 offen offset:3072 sc1 lds
    s_add_u32 m0, m0, 4096
    s_waitcnt vmcnt(14)
    buffer_load_dwordx4 v178, s[28:31], m0 offen offset:0 sc1 lds
    s_waitcnt vmcnt(14)
    buffer_load_dwordx4 v178, s[28:31], m0 offen offset:1024 sc1 lds
    s_waitcnt vmcnt(14)
    buffer_load_dwordx4 v178, s[28:31], m0 offen offset:2048 sc1 lds
    v_mov_b32 v0, 5
    ds_write_b32 v45, v0
    s_lshr_b32 s62, s85, 1
    s_mul_i32 s62, s62, 15
    s_add_u32 s62, s62, 0xfffe2000
    v_add_u32_e64 v178, s62, v176
    s_mul_i32 s62, s40, 15360
    s_add_u32 m0, s62, 122880
    s_waitcnt vmcnt(14)
    buffer_load_dwordx4 v178, s[28:31], m0 offen offset:0 sc1 lds
    s_waitcnt vmcnt(14)
    buffer_load_dwordx4 v178, s[28:31], m0 offen offset:1024 sc1 lds
    s_waitcnt vmcnt(14)
    buffer_load_dwordx4 v178, s[28:31], m0 offen offset:2048 sc1 lds
    s_waitcnt vmcnt(14)
    buffer_load_dwordx4 v178, s[28:31], m0 offen offset:3072 sc1 lds
    s_add_u32 m0, m0, 4096
    s_waitcnt vmcnt(14)
    buffer_load_dwordx4 v178, s[28:31], m0 offen offset:0 sc1 lds
    s_waitcnt vmcnt(14)
    buffer_load_dwordx4 v178, s[28:31], m0 offen offset:1024 sc1 lds
    s_waitcnt vmcnt(14)
    buffer_load_dwordx4 v178, s[28:31], m0 offen offset:2048 sc1 lds
    s_waitcnt vmcnt(14)
    buffer_load_dwordx4 v178, s[28:31], m0 offen offset:3072 sc1 lds
    s_add_u32 m0, m0, 4096
    s_waitcnt vmcnt(14)
    buffer_load_dwordx4 v178, s[28:31], m0 offen offset:0 sc1 lds
    s_waitcnt vmcnt(14)
    buffer_load_dwordx4 v178, s[28:31], m0 offen offset:1024 sc1 lds
    s_waitcnt vmcnt(14)
    buffer_load_dwordx4 v178, s[28:31], m0 offen offset:2048 sc1 lds
    s_waitcnt vmcnt(14)
    buffer_load_dwordx4 v178, s[28:31], m0 offen offset:3072 sc1 lds
    s_add_u32 m0, m0, 4096
    s_waitcnt vmcnt(14)
    buffer_load_dwordx4 v178, s[28:31], m0 offen offset:0 sc1 lds
    s_waitcnt vmcnt(14)
    buffer_load_dwordx4 v178, s[28:31], m0 offen offset:1024 sc1 lds
    s_waitcnt vmcnt(14)
    buffer_load_dwordx4 v178, s[28:31], m0 offen offset:2048 sc1 lds
    v_mov_b32 v0, 6
    ds_write_b32 v45, v0
    s_waitcnt vmcnt(0)
    v_mov_b32 v0, 7
    ds_write_b32 v45, v0
    s_lshl_b32 s61, s44, 12
    s_add_u32 s61, s61, 0x2220000
    v_min_u32 v179, 7, v1
    v_lshl_add_u32 v179, v179, 7, s61
    s_mov_b32 s60, 0
L145:
    buffer_load_dword v4, v179, s[28:31], 0 offen sc1
    s_waitcnt vmcnt(0)
    v_xor_b32 v0, v4, v3
    v_cmp_ne_u32 vcc, 0, v0
    s_cbranch_vccz L146
    s_sleep 8
    s_add_u32 s60, s60, 1
    s_cmp_lt_u32 s60, 400000
    s_cbranch_scc1 L145
L146:
    s_lshl_b32 s61, s44, 12
    s_add_u32 s61, s61, 0x2228000
    v_min_u32 v179, 7, v1
    v_lshl_add_u32 v179, v179, 7, s61
    s_mov_b32 s60, 0
L147:
    buffer_load_dword v4, v179, s[28:31], 0 offen sc1
    s_waitcnt vmcnt(0)
    v_xor_b32 v0, v4, v3
    v_cmp_ne_u32 vcc, 0, v0
    s_cbranch_vccz L148
    s_sleep 8
    s_add_u32 s60, s60, 1
    s_cmp_lt_u32 s60, 400000
    s_cbranch_scc1 L147
L148:
    s_mul_i32 s60, s44, 102400
    s_add_u32 s60, s60, 0x1880000
    v_add_u32 v176, s60, v2
    s_mov_b32 s60, 0
L149:
    ds_read_b128 v[188:191], v39 offset:0
    s_waitcnt lgkmcnt(0)
    v_min_u32 v188, v188, v189
    v_min3_u32 v46, v188, v190, v191
    v_cmp_gt_u32 vcc, 4, v46
    s_cbranch_vccz L150
    s_sleep 4
    s_add_u32 s60, s60, 1
    s_cmp_lt_u32 s60, 3200000
    s_cbranch_scc1 L149
L150:
    s_mul_i32 s62, s77, 5
    s_add_u32 s62, s62, 0x0
    v_add_u32 v178, s62, v176
    s_mul_i32 s62, s40, 10240
    s_add_u32 m0, s62, 0
    s_nop 0
    buffer_load_dwordx4 v178, s[28:31], m0 offen offset:0 sc1 lds
    buffer_load_dwordx4 v178, s[28:31], m0 offen offset:1024 sc1 lds
    buffer_load_dwordx4 v178, s[28:31], m0 offen offset:2048 sc1 lds
    buffer_load_dwordx4 v178, s[28:31], m0 offen offset:3072 sc1 lds
    s_add_u32 m0, m0, 4096
    s_nop 0
    buffer_load_dwordx4 v178, s[28:31], m0 offen offset:0 sc1 lds
    buffer_load_dwordx4 v178, s[28:31], m0 offen offset:1024 sc1 lds
    buffer_load_dwordx4 v178, s[28:31], m0 offen offset:2048 sc1 lds
    buffer_load_dwordx4 v178, s[28:31], m0 offen offset:3072 sc1 lds
    s_add_u32 m0, m0, 4096
    s_nop 0
    buffer_load_dwordx4 v178, s[28:31], m0 offen offset:0 sc1 lds
    buffer_load_dwordx4 v178, s[28:31], m0 offen offset:1024 sc1 lds
    s_cmp_eq_u32 s40, 0
    s_cselect_b32 s62, s77, s79
    s_lshr_b32 s62, s62, 2
    s_mul_i32 s62, s62, 5
    s_mul_i32 s61, s40, 10240
    s_add_u32 s61, s61, 40960
    s_sub_u32 s62, s62, s61
    s_add_u32 s62, s62, 81920
    v_add_u32 v178, s62, v176
    s_mov_b32 m0, s61
    s_nop 0
    buffer_load_dwordx4 v178, s[28:31], m0 offen offset:0 sc1 lds
    buffer_load_dwordx4 v178, s[28:31], m0 offen offset:1024 sc1 lds
    buffer_load_dwordx4 v178, s[28:31], m0 offen offset:2048 sc1 lds
    buffer_load_dwordx4 v178, s[28:31], m0 offen offset:3072 sc1 lds
    s_add_u32 m0, m0, 4096
    s_waitcnt vmcnt(13)
    buffer_load_dwordx4 v178, s[28:31], m0 offen offset:0 sc1 lds
    s_cmp_eq_u32 s40, 0
    s_cselect_b32 s62, s78, s80
    s_lshr_b32 s62, s62, 2
    s_mul_i32 s62, s62, 5
    s_mul_i32 s61, s40, 10240
    s_add_u32 s61, s61, 46080
    s_sub_u32 s62, s62, s61
    s_add_u32 s62, s62, 81920
    v_add_u32 v178, s62, v176
    s_mov_b32 m0, s61
    s_waitcnt vmcnt(13)
    buffer_load_dwordx4 v178, s[28:31], m0 offen offset:0 sc1 lds
    s_waitcnt vmcnt(13)
    buffer_load_dwordx4 v178, s[28:31], m0 offen offset:1024 sc1 lds
    s_waitcnt vmcnt(13)
    buffer_load_dwordx4 v178, s[28:31], m0 offen offset:2048 sc1 lds
    s_waitcnt vmcnt(13)
    buffer_load_dwordx4 v178, s[28:31], m0 offen offset:3072 sc1 lds
    s_add_u32 m0, m0, 4096
    s_waitcnt vmcnt(13)
    buffer_load_dwordx4 v178, s[28:31], m0 offen offset:0 sc1 lds
    s_mul_i32 s62, s78, 5
    s_add_u32 s62, s62, 0xffffb000
    v_add_u32_e64 v178, s62, v176
    s_mul_i32 s62, s40, 10240
    s_add_u32 m0, s62, 20480
    s_waitcnt vmcnt(13)
    buffer_load_dwordx4 v178, s[28:31], m0 offen offset:0 sc1 lds
    s_waitcnt vmcnt(13)
    buffer_load_dwordx4 v178, s[28:31], m0 offen offset:1024 sc1 lds
    s_waitcnt vmcnt(13)
    buffer_load_dwordx4 v178, s[28:31], m0 offen offset:2048 sc1 lds
    s_waitcnt vmcnt(13)
    buffer_load_dwordx4 v178, s[28:31], m0 offen offset:3072 sc1 lds
    s_add_u32 m0, m0, 4096
    s_waitcnt vmcnt(13)
    buffer_load_dwordx4 v178, s[28:31], m0 offen offset:0 sc1 lds
    s_waitcnt vmcnt(13)
    buffer_load_dwordx4 v178, s[28:31], m0 offen offset:1024 sc1 lds
    s_waitcnt vmcnt(13)
    buffer_load_dwordx4 v178, s[28:31], m0 offen offset:2048 sc1 lds
    s_waitcnt vmcnt(13)
    buffer_load_dwordx4 v178, s[28:31], m0 offen offset:3072 sc1 lds
    s_add_u32 m0, m0, 4096
    s_waitcnt vmcnt(13)
    buffer_load_dwordx4 v178, s[28:31], m0 offen offset:0 sc1 lds
    s_waitcnt vmcnt(13)
    buffer_load_dwordx4 v178, s[28:31], m0 offen offset:1024 sc1 lds
    s_mul_i32 s62, s79, 5
    s_mul_i32 s61, s40, 10240
    s_add_u32 s62, s62, s61
    v_add_u32 v178, s62, v176
    s_waitcnt vmcnt(13)
    buffer_load_dwordx4 a[0:3], v178, s[28:31], 0 offen offset:0 sc1
    s_waitcnt vmcnt(13)
    buffer_load_dwordx4 a[4:7], v178, s[28:31], 0 offen offset:1024 sc1
    s_waitcnt vmcnt(13)
    buffer_load_dwordx4 a[8:11], v178, s[28:31], 0 offen offset:2048 sc1
    s_waitcnt vmcnt(13)
    buffer_load_dwordx4 a[12:15], v178, s[28:31], 0 offen offset:3072 sc1
    v_add_u32 v178, 4096, v178
    s_waitcnt vmcnt(13)
    buffer_load_dwordx4 a[16:19], v178, s[28:31], 0 offen offset:0 sc1
    s_waitcnt vmcnt(13)
    buffer_load_dwordx4 a[20:23], v178, s[28:31], 0 offen offset:1024 sc1
    s_waitcnt vmcnt(13)
    buffer_load_dwordx4 a[24:27], v178, s[28:31], 0 offen offset:2048 sc1
    s_waitcnt vmcnt(13)
    buffer_load_dwordx4 a[28:31], v178, s[28:31], 0 offen offset:3072 sc1
    v_add_u32 v178, 4096, v178
    s_waitcnt vmcnt(13)
    buffer_load_dwordx4 a[32:35], v178, s[28:31], 0 offen offset:0 sc1
    s_waitcnt vmcnt(13)
    buffer_load_dwordx4 a[36:39], v178, s[28:31], 0 offen offset:1024 sc1
    s_mul_i32 s62, s80, 5
    s_mul_i32 s61, s40, 10240
    s_add_u32 s62, s62, s61
    v_add_u32 v178, s62, v176
    s_waitcnt vmcnt(13)
    buffer_load_dwordx4 a[40:43], v178, s[28:31], 0 offen offset:0 sc1
    s_waitcnt vmcnt(13)
    buffer_load_dwordx4 a[44:47], v178, s[28:31], 0 offen offset:1024 sc1
    s_waitcnt vmcnt(13)
    buffer_load_dwordx4 a[48:51], v178, s[28:31], 0 offen offset:2048 sc1
    s_waitcnt vmcnt(13)
    buffer_load_dwordx4 a[52:55], v178, s[28:31], 0 offen offset:3072 sc1
    v_add_u32 v178, 4096, v178
    s_waitcnt vmcnt(13)
    buffer_load_dwordx4 a[56:59], v178, s[28:31], 0 offen offset:0 sc1
    s_waitcnt vmcnt(13)
    buffer_load_dwordx4 a[60:63], v178, s[28:31], 0 offen offset:1024 sc1
    s_waitcnt vmcnt(13)
    buffer_load_dwordx4 v[10:13], v178, s[28:31], 0 offen offset:2048 sc1
    s_waitcnt vmcnt(13)
    buffer_load_dwordx4 v[14:17], v178, s[28:31], 0 offen offset:3072 sc1
    v_add_u32 v178, 4096, v178
    s_waitcnt vmcnt(13)
    buffer_load_dwordx4 v[18:21], v178, s[28:31], 0 offen offset:0 sc1
    s_waitcnt vmcnt(13)
    buffer_load_dwordx4 v[22:25], v178, s[28:31], 0 offen offset:1024 sc1
    s_mul_i32 s60, s44, 102400
    s_add_u32 s60, s60, 0x1980000
    v_add_u32 v176, s60, v2
    s_mul_i32 s62, s78, 5
    s_mul_i32 s61, s40, 10240
    s_add_u32 s62, s62, s61
    v_add_u32 v178, s62, v176
    s_waitcnt vmcnt(13)
    buffer_load_dwordx4 v[26:29], v178, s[28:31], 0 offen offset:0 sc1
    s_waitcnt vmcnt(13)
    buffer_load_dwordx4 v[30:33], v178, s[28:31], 0 offen offset:1024 sc1
    s_waitcnt vmcnt(13)
    buffer_load_dwordx4 v[34:37], v178, s[28:31], 0 offen offset:2048 sc1
    s_waitcnt vmcnt(13)
    buffer_load_dwordx4 v[40:43], v178, s[28:31], 0 offen offset:3072 sc1
    v_add_u32 v178, 4096, v178
    s_waitcnt vmcnt(13)
    buffer_load_dwordx4 v[48:51], v178, s[28:31], 0 offen offset:0 sc1
    s_waitcnt vmcnt(13)
    buffer_load_dwordx4 v[52:55], v178, s[28:31], 0 offen offset:1024 sc1
    s_waitcnt vmcnt(13)
    buffer_load_dwordx4 v[56:59], v178, s[28:31], 0 offen offset:2048 sc1
    s_waitcnt vmcnt(13)
    buffer_load_dwordx4 v[60:63], v178, s[28:31], 0 offen offset:3072 sc1
    v_add_u32 v178, 4096, v178
    s_waitcnt vmcnt(13)
    buffer_load_dwordx4 v[64:67], v178, s[28:31], 0 offen offset:0 sc1
    s_waitcnt vmcnt(13)
    buffer_load_dwordx4 v[68:71], v178, s[28:31], 0 offen offset:1024 sc1
    s_mul_i32 s62, s79, 5
    s_mul_i32 s61, s40, 10240
    s_add_u32 s62, s62, s61
    v_add_u32 v178, s62, v176
    s_waitcnt vmcnt(13)
    buffer_load_dwordx4 v[72:75], v178, s[28:31], 0 offen offset:0 sc1
    s_waitcnt vmcnt(13)
    buffer_load_dwordx4 v[76:79], v178, s[28:31], 0 offen offset:1024 sc1
    s_waitcnt vmcnt(13)
    buffer_load_dwordx4 v[80:83], v178, s[28:31], 0 offen offset:2048 sc1
    s_waitcnt vmcnt(13)
    buffer_load_dwordx4 v[84:87], v178, s[28:31], 0 offen offset:3072 sc1
    v_add_u32 v178, 4096, v178
    s_waitcnt vmcnt(13)
    buffer_load_dwordx4 v[88:91], v178, s[28:31], 0 offen offset:0 sc1
    s_waitcnt vmcnt(13)
    buffer_load_dwordx4 v[92:95], v178, s[28:31], 0 offen offset:1024 sc1
    s_waitcnt vmcnt(13)
    buffer_load_dwordx4 v[96:99], v178, s[28:31], 0 offen offset:2048 sc1
    s_waitcnt vmcnt(13)
    buffer_load_dwordx4 v[100:103], v178, s[28:31], 0 offen offset:3072 sc1
    v_add_u32 v178, 4096, v178
    s_waitcnt vmcnt(13)
    buffer_load_dwordx4 v[104:107], v178, s[28:31], 0 offen offset:0 sc1
    s_waitcnt vmcnt(13)
    buffer_load_dwordx4 v[108:111], v178, s[28:31], 0 offen offset:1024 sc1
    s_mul_i32 s62, s80, 5
    s_mul_i32 s61, s40, 10240
    s_add_u32 s62, s62, s61
    v_add_u32 v178, s62, v176
    s_waitcnt vmcnt(13)
    buffer_load_dwordx4 v[112:115], v178, s[28:31], 0 offen offset:0 sc1
    s_waitcnt vmcnt(13)
    buffer_load_dwordx4 v[116:119], v178, s[28:31], 0 offen offset:1024 sc1
    s_waitcnt vmcnt(13)
    buffer_load_dwordx4 v[120:123], v178, s[28:31], 0 offen offset:2048 sc1
    s_waitcnt vmcnt(13)
    buffer_load_dwordx4 v[124:127], v178, s[28:31], 0 offen offset:3072 sc1
    v_add_u32 v178, 4096, v178
    s_waitcnt vmcnt(13)
    buffer_load_dwordx4 v[128:131], v178, s[28:31], 0 offen offset:0 sc1
    s_waitcnt vmcnt(13)
    buffer_load_dwordx4 v[132:135], v178, s[28:31], 0 offen offset:1024 sc1
    s_waitcnt vmcnt(13)
    buffer_load_dwordx4 v[136:139], v178, s[28:31], 0 offen offset:2048 sc1
    s_waitcnt vmcnt(13)
    buffer_load_dwordx4 v[140:143], v178, s[28:31], 0 offen offset:3072 sc1
    v_add_u32 v178, 4096, v178
    s_waitcnt vmcnt(13)
    buffer_load_dwordx4 v[144:147], v178, s[28:31], 0 offen offset:0 sc1
    s_waitcnt vmcnt(13)
    buffer_load_dwordx4 v[148:151], v178, s[28:31], 0 offen offset:1024 sc1
    v_mov_b32_e64 v0, 8
    ds_write_b32 v45, v0
    s_mov_b32 s60, 0
L151:
    ds_read_b128 v[188:191], v39 offset:0
    s_waitcnt lgkmcnt(0)
    v_min_u32_e64 v188, v188, v189
    v_min3_u32 v46, v188, v190, v191
    v_cmp_gt_u32 vcc, 7, v46
    s_cbranch_vccz L152
    s_sleep 4
    s_add_u32 s60, s60, 1
    s_cmp_lt_u32 s60, 3200000
    s_cbranch_scc1 L151
L152:
    s_mul_i32 s62, s40, 10240
    s_add_u32 s62, s62, 61440
    v_add_u32 v180, s62, v2
    ds_write_b128 v180, a[0:3] offset:0
    ds_write_b128 v180, a[4:7] offset:1024
    ds_write_b128 v180, a[8:11] offset:2048
    ds_write_b128 v180, a[12:15] offset:3072
    ds_write_b128 v180, a[16:19] offset:4096
    ds_write_b128 v180, a[20:23] offset:5120
    ds_write_b128 v180, a[24:27] offset:6144
    ds_write_b128 v180, a[28:31] offset:7168
    ds_write_b128 v180, a[32:35] offset:8192
    ds_write_b128 v180, a[36:39] offset:9216
    v_mov_b32_e64 v0, 9
    ds_write_b32 v45, v0
    s_mul_i32 s62, s40, 10240
    s_add_u32 s62, s62, 81920
    v_add_u32_e64 v180, s62, v2
    ds_write_b128 v180, a[40:43] offset:0
    ds_write_b128 v180, a[44:47] offset:1024
    ds_write_b128 v180, a[48:51] offset:2048
    s_waitcnt lgkmcnt(8)
    ds_write_b128 v180, a[52:55] offset:3072
    ds_write_b128 v180, a[56:59] offset:4096
    ds_write_b128 v180, a[60:63] offset:5120
    ds_write_b128 v180, v[10:13] offset:6144
    ds_write_b128 v180, v[14:17] offset:7168
    ds_write_b128 v180, v[18:21] offset:8192
    s_waitcnt lgkmcnt(8)
    ds_write_b128 v180, v[22:25] offset:9216
    v_mov_b32_e64 v0, 10
    ds_write_b32 v45, v0
    s_waitcnt vmcnt(0)
    s_mov_b32 s60, 0
L153:
    ds_read_b128 v[188:191], v39 offset:0
    s_waitcnt lgkmcnt(0)
    v_min_u32 v188, v188, v189
    v_min3_u32 v46, v188, v190, v191
    v_cmp_gt_u32 vcc, 8, v46
    s_cbranch_vccz L154
    s_sleep 4
    s_add_u32 s60, s60, 1
    s_cmp_lt_u32 s60, 3200000
    s_cbranch_scc1 L153
L154:
    s_mul_i32 s62, s77, 5
    s_add_u32 s62, s62, 0xfffe7000
    v_add_u32_e64 v178, s62, v176
    s_mul_i32 s62, s40, 10240
    s_add_u32 m0, s62, 102400
    s_nop 0
    buffer_load_dwordx4 v178, s[28:31], m0 offen offset:0 sc1 lds
    buffer_load_dwordx4 v178, s[28:31], m0 offen offset:1024 sc1 lds
    buffer_load_dwordx4 v178, s[28:31], m0 offen offset:2048 sc1 lds
    buffer_load_dwordx4 v178, s[28:31], m0 offen offset:3072 sc1 lds
    s_add_u32 m0, m0, 4096
    s_nop 0
    buffer_load_dwordx4 v178, s[28:31], m0 offen offset:0 sc1 lds
    buffer_load_dwordx4 v178, s[28:31], m0 offen offset:1024 sc1 lds
    buffer_load_dwordx4 v178, s[28:31], m0 offen offset:2048 sc1 lds
    buffer_load_dwordx4 v178, s[28:31], m0 offen offset:3072 sc1 lds
    s_add_u32 m0, m0, 4096
    s_nop 0
    buffer_load_dwordx4 v178, s[28:31], m0 offen offset:0 sc1 lds
    buffer_load_dwordx4 v178, s[28:31], m0 offen offset:1024 sc1 lds
    s_cmp_eq_u32 s40, 0
    s_cselect_b32 s62, s77, s79
    s_lshr_b32 s62, s62, 2
    s_mul_i32 s62, s62, 5
    s_mul_i32 s61, s40, 10240
    s_add_u32 s61, s61, 122880
    s_sub_u32 s62, s62, s61
    s_add_u32 s62, s62, 81920
    v_add_u32 v178, s62, v176
    s_mov_b32 m0, s61
    s_nop 0
    buffer_load_dwordx4 v178, s[28:31], m0 offen offset:0 sc1 lds
    buffer_load_dwordx4 v178, s[28:31], m0 offen offset:1024 sc1 lds
    buffer_load_dwordx4 v178, s[28:31], m0 offen offset:2048 sc1 lds
    buffer_load_dwordx4 v178, s[28:31], m0 offen offset:3072 sc1 lds
    s_add_u32 m0, m0, 4096
    s_waitcnt vmcnt(13)
    buffer_load_dwordx4 v178, s[28:31], m0 offen offset:0 sc1 lds
    s_cmp_eq_u32 s40, 0
    s_cselect_b32 s62, s78, s80
    s_lshr_b32 s62, s62, 2
    s_mul_i32 s62, s62, 5
    s_mul_i32 s61, s40, 10240
    s_add_u32 s61, s61, 128000
    s_sub_u32 s62, s62, s61
    s_add_u32 s62, s62, 81920
    v_add_u32 v178, s62, v176
    s_mov_b32 m0, s61
    s_waitcnt vmcnt(13)
    buffer_load_dwordx4 v178, s[28:31], m0 offen offset:0 sc1 lds
    s_waitcnt vmcnt(13)
    buffer_load_dwordx4 v178, s[28:31], m0 offen offset:1024 sc1 lds
    s_waitcnt vmcnt(13)
    buffer_load_dwordx4 v178, s[28:31], m0 offen offset:2048 sc1 lds
    s_waitcnt vmcnt(13)
    buffer_load_dwordx4 v178, s[28:31], m0 offen offset:3072 sc1 lds
    s_add_u32 m0, m0, 4096
    s_waitcnt vmcnt(13)
    buffer_load_dwordx4 v178, s[28:31], m0 offen offset:0 sc1 lds
    s_mov_b32 s60, 0
L155:
    ds_read_b64 v[46:47], v39 offset:24
    s_waitcnt lgkmcnt(0)
    v_min_u32 v46, v46, v47
    v_cmp_gt_u32 vcc, 4, v46
    s_cbranch_vccz L156
    s_sleep 1
    s_add_u32 s60, s60, 1
    s_cmp_lt_u32 s60, 3200000
    s_cbranch_scc1 L155
L156:
    s_mul_i32 s60, s46, 143360
    s_add_u32 s60, s60, 0x1b80000
    v_add_u32 v176, s60, v2
    s_mul_i32 s62, s82, 7
    s_mul_i32 s61, s40, 14336
    s_add_u32 s62, s62, s61
    v_add_u32 v178, s62, v176
    s_waitcnt vmcnt(13)
    buffer_load_dwordx4 v[152:155], v178, s[28:31], 0 offen offset:0 sc1
    s_waitcnt vmcnt(13)
    buffer_load_dwordx4 v[156:159], v178, s[28:31], 0 offen offset:1024 sc1
    s_waitcnt vmcnt(13)
    buffer_load_dwordx4 v[160:163], v178, s[28:31], 0 offen offset:2048 sc1
    s_waitcnt vmcnt(13)
    buffer_load_dwordx4 v[164:167], v178, s[28:31], 0 offen offset:3072 sc1
    v_add_u32 v178, 4096, v178
    s_waitcnt vmcnt(13)
    buffer_load_dwordx4 v[168:171], v178, s[28:31], 0 offen offset:0 sc1
    s_waitcnt vmcnt(13)
    buffer_load_dwordx4 v[172:175], v178, s[28:31], 0 offen offset:1024 sc1
    s_waitcnt vmcnt(13)
    buffer_load_dwordx4 a[0:3], v178, s[28:31], 0 offen offset:2048 sc1
    s_waitcnt vmcnt(13)
    buffer_load_dwordx4 a[4:7], v178, s[28:31], 0 offen offset:3072 sc1
    v_add_u32 v178, 4096, v178
    s_waitcnt vmcnt(13)
    buffer_load_dwordx4 a[8:11], v178, s[28:31], 0 offen offset:0 sc1
    s_waitcnt vmcnt(13)
    buffer_load_dwordx4 a[12:15], v178, s[28:31], 0 offen offset:1024 sc1
    s_waitcnt vmcnt(13)
    buffer_load_dwordx4 a[16:19], v178, s[28:31], 0 offen offset:2048 sc1
    s_waitcnt vmcnt(13)
    buffer_load_dwordx4 a[20:23], v178, s[28:31], 0 offen offset:3072 sc1
    v_add_u32 v178, 4096, v178
    s_waitcnt vmcnt(13)
    buffer_load_dwordx4 a[24:27], v178, s[28:31], 0 offen offset:0 sc1
    s_waitcnt vmcnt(13)
    buffer_load_dwordx4 a[28:31], v178, s[28:31], 0 offen offset:1024 sc1
    s_mul_i32 s60, s44, 102400
    s_add_u32 s60, s60, 0x1a80000
    v_add_u32 v176, s60, v2
    s_mov_b32 s60, 0
L157:
    ds_read_b128 v[188:191], v39 offset:0
    s_waitcnt lgkmcnt(0)
    v_min_u32 v188, v188, v189
    v_min3_u32 v46, v188, v190, v191
    v_cmp_gt_u32 vcc, 9, v46
    s_cbranch_vccz L158
    s_sleep 1
    s_add_u32 s60, s60, 1
    s_cmp_lt_u32 s60, 3200000
    s_cbranch_scc1 L157
L158:
    s_mul_i32 s62, s40, 10240
    s_add_u32 s62, s62, 40960
    v_add_u32 v180, s62, v2
    ds_write_b128 v180, v[26:29] offset:0
    ds_write_b128 v180, v[30:33] offset:1024
    ds_write_b128 v180, v[34:37] offset:2048
    ds_write_b128 v180, v[40:43] offset:3072
    ds_write_b128 v180, v[48:51] offset:4096
    ds_write_b128 v180, v[52:55] offset:5120
    ds_write_b128 v180, v[56:59] offset:6144
    ds_write_b128 v180, v[60:63] offset:7168
    ds_write_b128 v180, v[64:67] offset:8192
    ds_write_b128 v180, v[68:71] offset:9216
    v_mov_b32_e64 v0, 11
    ds_write_b32 v45, v0
    s_mul_i32 s62, s40, 10240
    s_add_u32 s62, s62, 0
    v_add_u32 v180, s62, v2
    ds_write_b128 v180, v[72:75] offset:0
    ds_write_b128 v180, v[76:79] offset:1024
    ds_write_b128 v180, v[80:83] offset:2048
    s_waitcnt lgkmcnt(8)
    ds_write_b128 v180, v[84:87] offset:3072
    ds_write_b128 v180, v[88:91] offset:4096
    ds_write_b128 v180, v[92:95] offset:5120
    ds_write_b128 v180, v[96:99] offset:6144
    ds_write_b128 v180, v[100:103] offset:7168
    ds_write_b128 v180, v[104:107] offset:8192
    s_waitcnt lgkmcnt(8)
    ds_write_b128 v180, v[108:111] offset:9216
    v_mov_b32_e64 v0, 12
    ds_write_b32 v45, v0
    s_mul_i32 s62, s40, 10240
    s_add_u32 s62, s62, 20480
    v_add_u32_e64 v180, s62, v2
    ds_write_b128 v180, v[112:115] offset:0
    ds_write_b128 v180, v[116:119] offset:1024
    ds_write_b128 v180, v[120:123] offset:2048
    ds_write_b128 v180, v[124:127] offset:3072
    s_waitcnt lgkmcnt(8)
    ds_write_b128 v180, v[128:131] offset:4096
    ds_write_b128 v180, v[132:135] offset:5120
    ds_write_b128 v180, v[136:139] offset:6144
    ds_write_b128 v180, v[140:143] offset:7168
    ds_write_b128 v180, v[144:147] offset:8192
    ds_write_b128 v180, v[148:151] offset:9216
    v_mov_b32 v0, 13
    ds_write_b32 v45, v0
    s_waitcnt lgkmcnt(0)
    v_mov_b32 v0, 14
    ds_write_b32 v45, v0
    s_mov_b32 s60, 0
L159:
    ds_read_b128 v[188:191], v39 offset:0
    s_waitcnt lgkmcnt(0)
    v_min_u32_e64 v188, v188, v189
    v_min3_u32 v46, v188, v190, v191
    v_cmp_gt_u32 vcc, 10, v46
    s_cbranch_vccz L160
    s_sleep 4
    s_add_u32 s60, s60, 1
    s_cmp_lt_u32 s60, 3200000
    s_cbranch_scc1 L159
L160:
    s_mul_i32 s62, s77, 5
    s_add_u32 s62, s62, 0xffff1000
    v_add_u32_e64 v178, s62, v176
    s_mul_i32 s62, s40, 10240
    s_add_u32 m0, s62, 61440
    s_waitcnt vmcnt(13)
    buffer_load_dwordx4 v178, s[28:31], m0 offen offset:0 sc1 lds
    s_waitcnt vmcnt(13)
    buffer_load_dwordx4 v178, s[28:31], m0 offen offset:1024 sc1 lds
    s_waitcnt vmcnt(13)
    buffer_load_dwordx4 v178, s[28:31], m0 offen offset:2048 sc1 lds
    s_waitcnt vmcnt(13)
    buffer_load_dwordx4 v178, s[28:31], m0 offen offset:3072 sc1 lds
    s_add_u32 m0, m0, 4096
    s_waitcnt vmcnt(13)
    buffer_load_dwordx4 v178, s[28:31], m0 offen offset:0 sc1 lds
    s_waitcnt vmcnt(13)
    buffer_load_dwordx4 v178, s[28:31], m0 offen offset:1024 sc1 lds
    s_waitcnt vmcnt(13)
    buffer_load_dwordx4 v178, s[28:31], m0 offen offset:2048 sc1 lds
    s_waitcnt vmcnt(13)
    buffer_load_dwordx4 v178, s[28:31], m0 offen offset:3072 sc1 lds
    s_add_u32 m0, m0, 4096
    s_waitcnt vmcnt(13)
    buffer_load_dwordx4 v178, s[28:31], m0 offen offset:0 sc1 lds
    s_waitcnt vmcnt(13)
    buffer_load_dwordx4 v178, s[28:31], m0 offen offset:1024 sc1 lds
    s_cmp_eq_u32 s40, 0
    s_cselect_b32 s62, s77, s79
    s_lshr_b32 s62, s62, 2
    s_mul_i32 s62, s62, 5
    s_mul_i32 s61, s40, 10240
    s_add_u32 s61, s61, 81920
    s_sub_u32 s62, s62, s61
    s_add_u32 s62, s62, 81920
    v_add_u32 v178, s62, v176
    s_mov_b32 m0, s61
    s_waitcnt vmcnt(13)
    buffer_load_dwordx4 v178, s[28:31], m0 offen offset:0 sc1 lds
    s_waitcnt vmcnt(13)
    buffer_load_dwordx4 v178, s[28:31], m0 offen offset:1024 sc1 lds
    s_waitcnt vmcnt(13)
    buffer_load_dwordx4 v178, s[28:31], m0 offen offset:2048 sc1 lds
    s_waitcnt vmcnt(13)
    buffer_load_dwordx4 v178, s[28:31], m0 offen offset:3072 sc1 lds
    s_add_u32 m0, m0, 4096
    s_waitcnt vmcnt(13)
    buffer_load_dwordx4 v178, s[28:31], m0 offen offset:0 sc1 lds
    s_cmp_eq_u32 s40, 0
    s_cselect_b32 s62, s78, s80
    s_lshr_b32 s62, s62, 2
    s_mul_i32 s62, s62, 5
    s_mul_i32 s61, s40, 10240
    s_add_u32 s61, s61, 87040
    s_sub_u32 s62, s62, s61
    s_add_u32 s62, s62, 81920
    v_add_u32 v178, s62, v176
    s_mov_b32 m0, s61
    s_waitcnt vmcnt(13)
    buffer_load_dwordx4 v178, s[28:31], m0 offen offset:0 sc1 lds
    s_waitcnt vmcnt(13)
    buffer_load_dwordx4 v178, s[28:31], m0 offen offset:1024 sc1 lds
    s_waitcnt vmcnt(13)
    buffer_load_dwordx4 v178, s[28:31], m0 offen offset:2048 sc1 lds
    s_waitcnt vmcnt(13)
    buffer_load_dwordx4 v178, s[28:31], m0 offen offset:3072 sc1 lds
    s_add_u32 m0, m0, 4096
    s_waitcnt vmcnt(13)
    buffer_load_dwordx4 v178, s[28:31], m0 offen offset:0 sc1 lds
    s_mul_i32 s60, s46, 143360
    s_add_u32 s60, s60, 0x1b80000
    v_add_u32 v176, s60, v2
    s_mul_i32 s62, s83, 7
    s_mul_i32 s61, s40, 14336
    s_add_u32 s62, s62, s61
    v_add_u32 v178, s62, v176
    s_waitcnt vmcnt(13)
    buffer_load_dwordx4 a[32:35], v178, s[28:31], 0 offen offset:0 sc1
    s_waitcnt vmcnt(13)
    buffer_load_dwordx4 a[36:39], v178, s[28:31], 0 offen offset:1024 sc1
    s_waitcnt vmcnt(13)
    buffer_load_dwordx4 a[40:43], v178, s[28:31], 0 offen offset:2048 sc1
    s_waitcnt vmcnt(13)
    buffer_load_dwordx4 a[44:47], v178, s[28:31], 0 offen offset:3072 sc1
    v_add_u32 v178, 4096, v178
    s_waitcnt vmcnt(13)
    buffer_load_dwordx4 a[48:51], v178, s[28:31], 0 offen offset:0 sc1
    s_waitcnt vmcnt(13)
    buffer_load_dwordx4 a[52:55], v178, s[28:31], 0 offen offset:1024 sc1
    s_waitcnt vmcnt(13)
    buffer_load_dwordx4 a[56:59], v178, s[28:31], 0 offen offset:2048 sc1
    s_waitcnt vmcnt(13)
    buffer_load_dwordx4 a[60:63], v178, s[28:31], 0 offen offset:3072 sc1
    v_add_u32 v178, 4096, v178
    s_waitcnt vmcnt(13)
    buffer_load_dwordx4 v[10:13], v178, s[28:31], 0 offen offset:0 sc1
    s_waitcnt vmcnt(13)
    buffer_load_dwordx4 v[14:17], v178, s[28:31], 0 offen offset:1024 sc1
    s_waitcnt vmcnt(13)
    buffer_load_dwordx4 v[18:21], v178, s[28:31], 0 offen offset:2048 sc1
    s_waitcnt vmcnt(13)
    buffer_load_dwordx4 v[22:25], v178, s[28:31], 0 offen offset:3072 sc1
    v_add_u32 v178, 4096, v178
    s_waitcnt vmcnt(13)
    buffer_load_dwordx4 v[26:29], v178, s[28:31], 0 offen offset:0 sc1
    s_waitcnt vmcnt(13)
    buffer_load_dwordx4 v[30:33], v178, s[28:31], 0 offen offset:1024 sc1
    s_mul_i32 s62, s84, 7
    s_mul_i32 s61, s40, 14336
    s_add_u32 s62, s62, s61
    v_add_u32 v178, s62, v176
    s_waitcnt vmcnt(13)
    buffer_load_dwordx4 v[34:37], v178, s[28:31], 0 offen offset:0 sc1
    s_waitcnt vmcnt(13)
    buffer_load_dwordx4 v[40:43], v178, s[28:31], 0 offen offset:1024 sc1
    s_waitcnt vmcnt(13)
    buffer_load_dwordx4 v[48:51], v178, s[28:31], 0 offen offset:2048 sc1
    s_waitcnt vmcnt(13)
    buffer_load_dwordx4 v[52:55], v178, s[28:31], 0 offen offset:3072 sc1
    v_add_u32 v178, 4096, v178
    s_waitcnt vmcnt(13)
    buffer_load_dwordx4 v[56:59], v178, s[28:31], 0 offen offset:0 sc1
    s_waitcnt vmcnt(13)
    buffer_load_dwordx4 v[60:63], v178, s[28:31], 0 offen offset:1024 sc1
    s_waitcnt vmcnt(13)
    buffer_load_dwordx4 v[64:67], v178, s[28:31], 0 offen offset:2048 sc1
    s_waitcnt vmcnt(13)
    buffer_load_dwordx4 v[68:71], v178, s[28:31], 0 offen offset:3072 sc1
    v_add_u32 v178, 4096, v178
    s_waitcnt vmcnt(13)
    buffer_load_dwordx4 v[72:75], v178, s[28:31], 0 offen offset:0 sc1
    s_waitcnt vmcnt(13)
    buffer_load_dwordx4 v[76:79], v178, s[28:31], 0 offen offset:1024 sc1
    s_waitcnt vmcnt(13)
    buffer_load_dwordx4 v[80:83], v178, s[28:31], 0 offen offset:2048 sc1
    s_waitcnt vmcnt(13)
    buffer_load_dwordx4 v[84:87], v178, s[28:31], 0 offen offset:3072 sc1
    v_add_u32 v178, 4096, v178
    s_waitcnt vmcnt(13)
    buffer_load_dwordx4 v[88:91], v178, s[28:31], 0 offen offset:0 sc1
    s_waitcnt vmcnt(13)
    buffer_load_dwordx4 v[92:95], v178, s[28:31], 0 offen offset:1024 sc1
    v_mov_b32 v0, 15
    ds_write_b32 v45, v0
    s_waitcnt vmcnt(0)
    s_mov_b32 s60, 0
L161:
    ds_read_b128 v[188:191], v39 offset:0
    s_waitcnt lgkmcnt(0)
    v_min_u32 v188, v188, v189
    v_min3_u32 v46, v188, v190, v191
    v_cmp_gt_u32 vcc, 12, v46
    s_cbranch_vccz L162
    s_sleep 4
    s_add_u32 s60, s60, 1
    s_cmp_lt_u32 s60, 3200000
    s_cbranch_scc1 L161
L162:
    s_mul_i32 s62, s81, 7
    s_add_u32 s62, s62, 0xffffb000
    v_add_u32_e64 v178, s62, v176
    s_mul_i32 s62, s40, 14336
    s_add_u32 m0, s62, 20480
    s_nop 0
    buffer_load_dwordx4 v178, s[28:31], m0 offen offset:0 sc1 lds
    buffer_load_dwordx4 v178, s[28:31], m0 offen offset:1024 sc1 lds
    buffer_load_dwordx4 v178, s[28:31], m0 offen offset:2048 sc1 lds
    buffer_load_dwordx4 v178, s[28:31], m0 offen offset:3072 sc1 lds
    s_add_u32 m0, m0, 4096
    s_nop 0
    buffer_load_dwordx4 v178, s[28:31], m0 offen offset:0 sc1 lds
    buffer_load_dwordx4 v178, s[28:31], m0 offen offset:1024 sc1 lds
    buffer_load_dwordx4 v178, s[28:31], m0 offen offset:2048 sc1 lds
    buffer_load_dwordx4 v178, s[28:31], m0 offen offset:3072 sc1 lds
    s_add_u32 m0, m0, 4096
    s_nop 0
    buffer_load_dwordx4 v178, s[28:31], m0 offen offset:0 sc1 lds
    buffer_load_dwordx4 v178, s[28:31], m0 offen offset:1024 sc1 lds
    buffer_load_dwordx4 v178, s[28:31], m0 offen offset:2048 sc1 lds
    buffer_load_dwordx4 v178, s[28:31], m0 offen offset:3072 sc1 lds
    s_add_u32 m0, m0, 4096
    s_nop 0
    buffer_load_dwordx4 v178, s[28:31], m0 offen offset:0 sc1 lds
    buffer_load_dwordx4 v178, s[28:31], m0 offen offset:1024 sc1 lds
    s_mov_b32 s60, 0
L163:
    ds_read_b128 v[188:191], v39 offset:0
    s_waitcnt lgkmcnt(0)
    v_min_u32_e64 v188, v188, v189
    v_min3_u32 v46, v188, v190, v191
    v_cmp_gt_u32 vcc, 13, v46
    s_cbranch_vccz L164
    s_sleep 1
    s_add_u32 s60, s60, 1
    s_cmp_lt_u32 s60, 3200000
    s_cbranch_scc1 L163
L164:
    s_mul_i32 s62, s40, 14336
    s_add_u32 s62, s62, 49152
    v_add_u32 v180, s62, v2
    ds_write_b128 v180, v[152:155] offset:0
    ds_write_b128 v180, v[156:159] offset:1024
    ds_write_b128 v180, v[160:163] offset:2048
    ds_write_b128 v180, v[164:167] offset:3072
    ds_write_b128 v180, v[168:171] offset:4096
    ds_write_b128 v180, v[172:175] offset:5120
    ds_write_b128 v180, a[0:3] offset:6144
    ds_write_b128 v180, a[4:7] offset:7168
    ds_write_b128 v180, a[8:11] offset:8192
    ds_write_b128 v180, a[12:15] offset:9216
    ds_write_b128 v180, a[16:19] offset:10240
    ds_write_b128 v180, a[20:23] offset:11264
    ds_write_b128 v180, a[24:27] offset:12288
    ds_write_b128 v180, a[28:31] offset:13312
    v_mov_b32_e64 v0, 16
    ds_write_b32 v45, v0
    s_waitcnt lgkmcnt(0)
    s_waitcnt vmcnt(0)
    v_mov_b32_e64 v0, 17
    ds_write_b32 v45, v0
    s_mul_i32 s62, s40, 14336
    s_add_u32 s62, s62, 77824
    v_add_u32_e64 v180, s62, v2
    ds_write_b128 v180, a[32:35] offset:0
    ds_write_b128 v180, a[36:39] offset:1024
    ds_write_b128 v180, a[40:43] offset:2048
    ds_write_b128 v180, a[44:47] offset:3072
    ds_write_b128 v180, a[48:51] offset:4096
    ds_write_b128 v180, a[52:55] offset:5120
    ds_write_b128 v180, a[56:59] offset:6144
    ds_write_b128 v180, a[60:63] offset:7168
    ds_write_b128 v180, v[10:13] offset:8192
    ds_write_b128 v180, v[14:17] offset:9216
    ds_write_b128 v180, v[18:21] offset:10240
    ds_write_b128 v180, v[22:25] offset:11264
    ds_write_b128 v180, v[26:29] offset:12288
    s_waitcnt lgkmcnt(8)
    ds_write_b128 v180, v[30:33] offset:13312
    v_mov_b32 v0, 18
    ds_write_b32 v45, v0
    s_mul_i32 s62, s40, 14336
    s_add_u32 s62, s62, 106496
    v_add_u32_e64 v180, s62, v2
    ds_write_b128 v180, v[34:37] offset:0
    ds_write_b128 v180, v[40:43] offset:1024
    ds_write_b128 v180, v[48:51] offset:2048
    ds_write_b128 v180, v[52:55] offset:3072
    s_waitcnt lgkmcnt(8)
    ds_write_b128 v180, v[56:59] offset:4096
    ds_write_b128 v180, v[60:63] offset:5120
    ds_write_b128 v180, v[64:67] offset:6144
    ds_write_b128 v180, v[68:71] offset:7168
    ds_write_b128 v180, v[72:75] offset:8192
    ds_write_b128 v180, v[76:79] offset:9216
    s_waitcnt lgkmcnt(8)
    ds_write_b128 v180, v[80:83] offset:10240
    ds_write_b128 v180, v[84:87] offset:11264
    ds_write_b128 v180, v[88:91] offset:12288
    ds_write_b128 v180, v[92:95] offset:13312
    v_mov_b32_e64 v0, 19
    ds_write_b32 v45, v0
    s_waitcnt lgkmcnt(0)
    s_mov_b32 s60, 0
L165:
    ds_read_b128 v[188:191], v39 offset:0
    s_waitcnt lgkmcnt(0)
    v_min_u32 v188, v188, v189
    v_min3_u32 v46, v188, v190, v191
    v_cmp_gt_u32 vcc, 14, v46
    s_cbranch_vccz L166
    s_sleep 1
    s_add_u32 s60, s60, 1
    s_cmp_lt_u32 s60, 3200000
    s_cbranch_scc1 L165
L166:
    s_mul_i32 s60, s46, 143360
    s_add_u32 s60, s60, 0x1b80000
    v_add_u32 v176, s60, v2
    s_mul_i32 s62, s85, 7
    s_add_u32 s62, s62, 0x0
    v_add_u32_e64 v178, s62, v176
    s_mul_i32 s62, s40, 10240
    s_add_u32 m0, s62, 0
    s_nop 0
    buffer_load_dwordx4 v178, s[28:31], m0 offen offset:0 sc1 lds
    buffer_load_dwordx4 v178, s[28:31], m0 offen offset:1024 sc1 lds
    buffer_load_dwordx4 v178, s[28:31], m0 offen offset:2048 sc1 lds
    buffer_load_dwordx4 v178, s[28:31], m0 offen offset:3072 sc1 lds
    s_add_u32 m0, m0, 4096
    s_nop 0
    buffer_load_dwordx4 v178, s[28:31], m0 offen offset:0 sc1 lds
    buffer_load_dwordx4 v178, s[28:31], m0 offen offset:1024 sc1 lds
    buffer_load_dwordx4 v178, s[28:31], m0 offen offset:2048 sc1 lds
    buffer_load_dwordx4 v178, s[28:31], m0 offen offset:3072 sc1 lds
    s_add_u32 m0, m0, 4096
    s_nop 0
    buffer_load_dwordx4 v178, s[28:31], m0 offen offset:0 sc1 lds
    buffer_load_dwordx4 v178, s[28:31], m0 offen offset:1024 sc1 lds
    s_mul_i32 s62, s85, 7
    s_add_u32 s62, s62, 0xfffe4000
    v_add_u32 v178, s62, v176
    s_mul_i32 s62, s40, 4096
    s_add_u32 m0, s62, 135168
    s_waitcnt vmcnt(9)
    buffer_load_dwordx4 v178, s[28:31], m0 offen offset:0 sc1 lds
    s_waitcnt vmcnt(9)
    buffer_load_dwordx4 v178, s[28:31], m0 offen offset:1024 sc1 lds
    s_waitcnt vmcnt(9)
    buffer_load_dwordx4 v178, s[28:31], m0 offen offset:2048 sc1 lds
    s_waitcnt vmcnt(9)
    buffer_load_dwordx4 v178, s[28:31], m0 offen offset:3072 sc1 lds
    s_waitcnt vmcnt(0)
    v_mov_b32 v0, 20
    ds_write_b32 v45, v0
    s_mul_i32 s60, s44, 276480
    s_add_u32 s60, s60, 0x1e00000
    v_add_u32_e64 v176, s60, v2
    s_mov_b32 s62, 122880
    v_add_u32_e64 v178, s62, v176
    s_mul_i32 s62, s40, 5120
    s_add_u32 m0, s62, 143360
    s_nop 0
    buffer_load_dwordx4 v178, s[28:31], m0 offen offset:0 sc1 lds
    buffer_load_dwordx4 v178, s[28:31], m0 offen offset:1024 sc1 lds
    buffer_load_dwordx4 v178, s[28:31], m0 offen offset:2048 sc1 lds
    buffer_load_dwordx4 v178, s[28:31], m0 offen offset:3072 sc1 lds
    s_add_u32 m0, m0, 4096
    s_nop 0
    buffer_load_dwordx4 v178, s[28:31], m0 offen offset:0 sc1 lds
    s_mul_i32 s62, s93, 5
    s_mul_i32 s61, s40, 10240
    s_add_u32 s62, s62, s61
    v_add_u32_e64 v178, s62, v176
    buffer_load_dwordx4 v[96:99], v178, s[28:31], 0 offen offset:0 sc1
    buffer_load_dwordx4 v[100:103], v178, s[28:31], 0 offen offset:1024 sc1
    buffer_load_dwordx4 v[104:107], v178, s[28:31], 0 offen offset:2048 sc1
    buffer_load_dwordx4 v[108:111], v178, s[28:31], 0 offen offset:3072 sc1
    v_add_u32 v178, 4096, v178
    buffer_load_dwordx4 v[112:115], v178, s[28:31], 0 offen offset:0 sc1
    s_waitcnt vmcnt(9)
    buffer_load_dwordx4 v[116:119], v178, s[28:31], 0 offen offset:1024 sc1
    s_waitcnt vmcnt(9)
    buffer_load_dwordx4 v[120:123], v178, s[28:31], 0 offen offset:2048 sc1
    s_waitcnt vmcnt(9)
    buffer_load_dwordx4 v[124:127], v178, s[28:31], 0 offen offset:3072 sc1
    v_add_u32 v178, 4096, v178
    s_waitcnt vmcnt(9)
    buffer_load_dwordx4 v[128:131], v178, s[28:31], 0 offen offset:0 sc1
    s_waitcnt vmcnt(9)
    buffer_load_dwordx4 v[132:135], v178, s[28:31], 0 offen offset:1024 sc1
    s_mov_b32 s60, 0
L167:
    ds_read_b128 v[188:191], v39 offset:0
    s_waitcnt lgkmcnt(0)
    v_min_u32 v188, v188, v189
    v_min3_u32 v46, v188, v190, v191
    v_cmp_gt_u32 vcc, 15, v46
    s_cbranch_vccz L168
    s_sleep 4
    s_add_u32 s60, s60, 1
    s_cmp_lt_u32 s60, 3200000
    s_cbranch_scc1 L167
L168:
    s_mul_i32 s62, s86, 5
    s_add_u32 s62, s62, 0xffffb000
    v_add_u32_e64 v178, s62, v176
    s_mul_i32 s62, s40, 10240
    s_add_u32 m0, s62, 20480
    s_waitcnt vmcnt(9)
    buffer_load_dwordx4 v178, s[28:31], m0 offen offset:0 sc1 lds
    s_waitcnt vmcnt(9)
    buffer_load_dwordx4 v178, s[28:31], m0 offen offset:1024 sc1 lds
    s_waitcnt vmcnt(9)
    buffer_load_dwordx4 v178, s[28:31], m0 offen offset:2048 sc1 lds
    s_waitcnt vmcnt(9)
    buffer_load_dwordx4 v178, s[28:31], m0 offen offset:3072 sc1 lds
    s_add_u32 m0, m0, 4096
    s_waitcnt vmcnt(9)
    buffer_load_dwordx4 v178, s[28:31], m0 offen offset:0 sc1 lds
    s_waitcnt vmcnt(9)
    buffer_load_dwordx4 v178, s[28:31], m0 offen offset:1024 sc1 lds
    s_waitcnt vmcnt(9)
    buffer_load_dwordx4 v178, s[28:31], m0 offen offset:2048 sc1 lds
    s_waitcnt vmcnt(9)
    buffer_load_dwordx4 v178, s[28:31], m0 offen offset:3072 sc1 lds
    s_add_u32 m0, m0, 4096
    s_waitcnt vmcnt(9)
    buffer_load_dwordx4 v178, s[28:31], m0 offen offset:0 sc1 lds
    s_waitcnt vmcnt(9)
    buffer_load_dwordx4 v178, s[28:31], m0 offen offset:1024 sc1 lds
    s_mov_b32 s60, 0
L169:
    ds_read_b128 v[188:191], v39 offset:0
    s_waitcnt lgkmcnt(0)
    v_min_u32_e64 v188, v188, v189
    v_min3_u32 v46, v188, v190, v191
    v_cmp_gt_u32 vcc, 16, v46
    s_cbranch_vccz L170
    s_sleep 4
    s_add_u32 s60, s60, 1
    s_cmp_lt_u32 s60, 3200000
    s_cbranch_scc1 L169
L170:
    s_mul_i32 s62, s87, 5
    s_add_u32 s62, s62, 0xffff6000
    v_add_u32_e64 v178, s62, v176
    s_mul_i32 s62, s40, 10240
    s_add_u32 m0, s62, 40960
    s_waitcnt vmcnt(9)
    buffer_load_dwordx4 v178, s[28:31], m0 offen offset:0 sc1 lds
    s_waitcnt vmcnt(9)
    buffer_load_dwordx4 v178, s[28:31], m0 offen offset:1024 sc1 lds
    s_waitcnt vmcnt(9)
    buffer_load_dwordx4 v178, s[28:31], m0 offen offset:2048 sc1 lds
    s_waitcnt vmcnt(9)
    buffer_load_dwordx4 v178, s[28:31], m0 offen offset:3072 sc1 lds
    s_add_u32 m0, m0, 4096
    s_waitcnt vmcnt(9)
    buffer_load_dwordx4 v178, s[28:31], m0 offen offset:0 sc1 lds
    s_waitcnt vmcnt(9)
    buffer_load_dwordx4 v178, s[28:31], m0 offen offset:1024 sc1 lds
    s_waitcnt vmcnt(9)
    buffer_load_dwordx4 v178, s[28:31], m0 offen offset:2048 sc1 lds
    s_waitcnt vmcnt(9)
    buffer_load_dwordx4 v178, s[28:31], m0 offen offset:3072 sc1 lds
    s_add_u32 m0, m0, 4096
    s_waitcnt vmcnt(9)
    buffer_load_dwordx4 v178, s[28:31], m0 offen offset:0 sc1 lds
    s_waitcnt vmcnt(9)
    buffer_load_dwordx4 v178, s[28:31], m0 offen offset:1024 sc1 lds
    s_mov_b32 s60, 0
L171:
    ds_read_b128 v[188:191], v39 offset:0
    s_waitcnt lgkmcnt(0)
    v_min_u32_e64 v188, v188, v189
    v_min3_u32 v46, v188, v190, v191
    v_cmp_gt_u32 vcc, 17, v46
    s_cbranch_vccz L172
    s_sleep 4
    s_add_u32 s60, s60, 1
    s_cmp_lt_u32 s60, 3200000
    s_cbranch_scc1 L171
L172:
    s_mul_i32 s62, s88, 5
    s_add_u32 s62, s62, 0xffff1000
    v_add_u32_e64 v178, s62, v176
    s_mul_i32 s62, s40, 10240
    s_add_u32 m0, s62, 61440
    s_waitcnt vmcnt(9)
    buffer_load_dwordx4 v178, s[28:31], m0 offen offset:0 sc1 lds
    s_waitcnt vmcnt(9)
    buffer_load_dwordx4 v178, s[28:31], m0 offen offset:1024 sc1 lds
    s_waitcnt vmcnt(9)
    buffer_load_dwordx4 v178, s[28:31], m0 offen offset:2048 sc1 lds
    s_waitcnt vmcnt(9)
    buffer_load_dwordx4 v178, s[28:31], m0 offen offset:3072 sc1 lds
    s_add_u32 m0, m0, 4096
    s_waitcnt vmcnt(9)
    buffer_load_dwordx4 v178, s[28:31], m0 offen offset:0 sc1 lds
    s_waitcnt vmcnt(9)
    buffer_load_dwordx4 v178, s[28:31], m0 offen offset:1024 sc1 lds
    s_waitcnt vmcnt(9)
    buffer_load_dwordx4 v178, s[28:31], m0 offen offset:2048 sc1 lds
    s_waitcnt vmcnt(9)
    buffer_load_dwordx4 v178, s[28:31], m0 offen offset:3072 sc1 lds
    s_add_u32 m0, m0, 4096
    s_waitcnt vmcnt(9)
    buffer_load_dwordx4 v178, s[28:31], m0 offen offset:0 sc1 lds
    s_waitcnt vmcnt(9)
    buffer_load_dwordx4 v178, s[28:31], m0 offen offset:1024 sc1 lds
    s_mul_i32 s62, s89, 5
    s_add_u32 s62, s62, 0xfffec000
    v_add_u32 v178, s62, v176
    s_mul_i32 s62, s40, 10240
    s_add_u32 m0, s62, 81920
    s_waitcnt vmcnt(9)
    buffer_load_dwordx4 v178, s[28:31], m0 offen offset:0 sc1 lds
    s_waitcnt vmcnt(9)
    buffer_load_dwordx4 v178, s[28:31], m0 offen offset:1024 sc1 lds
    s_waitcnt vmcnt(9)
    buffer_load_dwordx4 v178, s[28:31], m0 offen offset:2048 sc1 lds
    s_waitcnt vmcnt(9)
    buffer_load_dwordx4 v178, s[28:31], m0 offen offset:3072 sc1 lds
    s_add_u32 m0, m0, 4096
    s_waitcnt vmcnt(9)
    buffer_load_dwordx4 v178, s[28:31], m0 offen offset:0 sc1 lds
    s_waitcnt vmcnt(9)
    buffer_load_dwordx4 v178, s[28:31], m0 offen offset:1024 sc1 lds
    s_waitcnt vmcnt(9)
    buffer_load_dwordx4 v178, s[28:31], m0 offen offset:2048 sc1 lds
    s_waitcnt vmcnt(9)
    buffer_load_dwordx4 v178, s[28:31], m0 offen offset:3072 sc1 lds
    s_add_u32 m0, m0, 4096
    s_waitcnt vmcnt(9)
    buffer_load_dwordx4 v178, s[28:31], m0 offen offset:0 sc1 lds
    s_waitcnt vmcnt(9)
    buffer_load_dwordx4 v178, s[28:31], m0 offen offset:1024 sc1 lds
    s_mov_b32 s60, 0
L173:
    ds_read_b128 v[188:191], v39 offset:0
    s_waitcnt lgkmcnt(0)
    v_min_u32_e64 v188, v188, v189
    v_min3_u32 v46, v188, v190, v191
    v_cmp_gt_u32 vcc, 18, v46
    s_cbranch_vccz L174
    s_sleep 4
    s_add_u32 s60, s60, 1
    s_cmp_lt_u32 s60, 3200000
    s_cbranch_scc1 L173
L174:
    s_mul_i32 s62, s90, 5
    s_add_u32 s62, s62, 0xfffe7000
    v_add_u32_e64 v178, s62, v176
    s_mul_i32 s62, s40, 10240
    s_add_u32 m0, s62, 102400
    s_waitcnt vmcnt(9)
    buffer_load_dwordx4 v178, s[28:31], m0 offen offset:0 sc1 lds
    s_waitcnt vmcnt(9)
    buffer_load_dwordx4 v178, s[28:31], m0 offen offset:1024 sc1 lds
    s_waitcnt vmcnt(9)
    buffer_load_dwordx4 v178, s[28:31], m0 offen offset:2048 sc1 lds
    s_waitcnt vmcnt(9)
    buffer_load_dwordx4 v178, s[28:31], m0 offen offset:3072 sc1 lds
    s_add_u32 m0, m0, 4096
    s_waitcnt vmcnt(9)
    buffer_load_dwordx4 v178, s[28:31], m0 offen offset:0 sc1 lds
    s_waitcnt vmcnt(9)
    buffer_load_dwordx4 v178, s[28:31], m0 offen offset:1024 sc1 lds
    s_waitcnt vmcnt(9)
    buffer_load_dwordx4 v178, s[28:31], m0 offen offset:2048 sc1 lds
    s_waitcnt vmcnt(9)
    buffer_load_dwordx4 v178, s[28:31], m0 offen offset:3072 sc1 lds
    s_add_u32 m0, m0, 4096
    s_waitcnt vmcnt(9)
    buffer_load_dwordx4 v178, s[28:31], m0 offen offset:0 sc1 lds
    s_waitcnt vmcnt(9)
    buffer_load_dwordx4 v178, s[28:31], m0 offen offset:1024 sc1 lds
    s_waitcnt vmcnt(0)
    v_mov_b32 v0, 25
    ds_write_b32 v45, v0
    s_mov_b32 s60, 0
L175:
    ds_read_b128 v[188:191], v39 offset:0
    s_waitcnt lgkmcnt(0)
    v_min_u32_e64 v188, v188, v189
    v_min3_u32 v46, v188, v190, v191
    v_cmp_gt_u32 vcc, 19, v46
    s_cbranch_vccz L176
    s_sleep 4
    s_add_u32 s60, s60, 1
    s_cmp_lt_u32 s60, 3200000
    s_cbranch_scc1 L175
L176:
    s_mul_i32 s62, s91, 5
    s_add_u32 s62, s62, 0xfffe2000
    v_add_u32_e64 v178, s62, v176
    s_mul_i32 s62, s40, 10240
    s_add_u32 m0, s62, 122880
    s_nop 0
    buffer_load_dwordx4 v178, s[28:31], m0 offen offset:0 sc1 lds
    buffer_load_dwordx4 v178, s[28:31], m0 offen offset:1024 sc1 lds
    buffer_load_dwordx4 v178, s[28:31], m0 offen offset:2048 sc1 lds
    buffer_load_dwordx4 v178, s[28:31], m0 offen offset:3072 sc1 lds
    s_add_u32 m0, m0, 4096
    s_nop 0
    buffer_load_dwordx4 v178, s[28:31], m0 offen offset:0 sc1 lds
    buffer_load_dwordx4 v178, s[28:31], m0 offen offset:1024 sc1 lds
    buffer_load_dwordx4 v178, s[28:31], m0 offen offset:2048 sc1 lds
    buffer_load_dwordx4 v178, s[28:31], m0 offen offset:3072 sc1 lds
    s_add_u32 m0, m0, 4096
    s_nop 0
    buffer_load_dwordx4 v178, s[28:31], m0 offen offset:0 sc1 lds
    buffer_load_dwordx4 v178, s[28:31], m0 offen offset:1024 sc1 lds
    s_mul_i32 s62, s92, 5
    s_add_u32 s62, s62, 0x0
    v_add_u32 v178, s62, v176
    s_mul_i32 s62, s40, 10240
    s_add_u32 m0, s62, 0
    s_nop 0
    buffer_load_dwordx4 v178, s[28:31], m0 offen offset:0 sc1 lds
    buffer_load_dwordx4 v178, s[28:31], m0 offen offset:1024 sc1 lds
    buffer_load_dwordx4 v178, s[28:31], m0 offen offset:2048 sc1 lds
    buffer_load_dwordx4 v178, s[28:31], m0 offen offset:3072 sc1 lds
    s_add_u32 m0, m0, 4096
    s_waitcnt vmcnt(13)
    buffer_load_dwordx4 v178, s[28:31], m0 offen offset:0 sc1 lds
    s_waitcnt vmcnt(13)
    buffer_load_dwordx4 v178, s[28:31], m0 offen offset:1024 sc1 lds
    s_waitcnt vmcnt(13)
    buffer_load_dwordx4 v178, s[28:31], m0 offen offset:2048 sc1 lds
    s_waitcnt vmcnt(13)
    buffer_load_dwordx4 v178, s[28:31], m0 offen offset:3072 sc1 lds
    s_add_u32 m0, m0, 4096
    s_waitcnt vmcnt(13)
    buffer_load_dwordx4 v178, s[28:31], m0 offen offset:0 sc1 lds
    s_waitcnt vmcnt(13)
    buffer_load_dwordx4 v178, s[28:31], m0 offen offset:1024 sc1 lds
    s_waitcnt vmcnt(0)
    v_mov_b32 v0, 27
    ds_write_b32 v45, v0
    s_mov_b32 s60, 0
L177:
    ds_read_b128 v[188:191], v39 offset:0
    s_waitcnt lgkmcnt(0)
    v_min_u32_e64 v188, v188, v189
    v_min3_u32 v46, v188, v190, v191
    v_cmp_gt_u32 vcc, 20, v46
    s_cbranch_vccz L178
    s_sleep 4
    s_add_u32 s60, s60, 1
    s_cmp_lt_u32 s60, 3200000
    s_cbranch_scc1 L177
L178:
    s_mul_i32 s62, s40, 10240
    s_add_u32 s62, s62, 20480
    v_add_u32 v180, s62, v2
    ds_write_b128 v180, v[96:99] offset:0
    ds_write_b128 v180, v[100:103] offset:1024
    ds_write_b128 v180, v[104:107] offset:2048
    ds_write_b128 v180, v[108:111] offset:3072
    ds_write_b128 v180, v[112:115] offset:4096
    ds_write_b128 v180, v[116:119] offset:5120
    ds_write_b128 v180, v[120:123] offset:6144
    ds_write_b128 v180, v[124:127] offset:7168
    ds_write_b128 v180, v[128:131] offset:8192
    ds_write_b128 v180, v[132:135] offset:9216
    v_mov_b32_e64 v0, 28
    ds_write_b32 v45, v0
    s_waitcnt lgkmcnt(0)
    s_mul_i32 s62, s97, 5
    s_mul_i32 s61, s40, 10240
    s_add_u32 s62, s62, s61
    v_add_u32 v178, s62, v176
    buffer_load_dwordx4 v[136:139], v178, s[28:31], 0 offen offset:0 sc1
    buffer_load_dwordx4 v[140:143], v178, s[28:31], 0 offen offset:1024 sc1
    buffer_load_dwordx4 v[144:147], v178, s[28:31], 0 offen offset:2048 sc1
    buffer_load_dwordx4 v[148:151], v178, s[28:31], 0 offen offset:3072 sc1
    v_add_u32 v178, 4096, v178
    buffer_load_dwordx4 v[152:155], v178, s[28:31], 0 offen offset:0 sc1
    buffer_load_dwordx4 v[156:159], v178, s[28:31], 0 offen offset:1024 sc1
    buffer_load_dwordx4 v[160:163], v178, s[28:31], 0 offen offset:2048 sc1
    buffer_load_dwordx4 v[164:167], v178, s[28:31], 0 offen offset:3072 sc1
    v_add_u32 v178, 4096, v178
    buffer_load_dwordx4 v[168:171], v178, s[28:31], 0 offen offset:0 sc1
    buffer_load_dwordx4 v[172:175], v178, s[28:31], 0 offen offset:1024 sc1
    s_mul_i32 s62, s98, 5
    s_mul_i32 s61, s40, 10240
    s_add_u32 s62, s62, s61
    v_add_u32 v178, s62, v176
    s_waitcnt vmcnt(9)
    buffer_load_dwordx4 a[0:3], v178, s[28:31], 0 offen offset:0 sc1
    s_waitcnt vmcnt(9)
    buffer_load_dwordx4 a[4:7], v178, s[28:31], 0 offen offset:1024 sc1
    s_waitcnt vmcnt(9)
    buffer_load_dwordx4 a[8:11], v178, s[28:31], 0 offen offset:2048 sc1
    s_waitcnt vmcnt(9)
    buffer_load_dwordx4 a[12:15], v178, s[28:31], 0 offen offset:3072 sc1
    v_add_u32 v178, 4096, v178
    s_waitcnt vmcnt(9)
    buffer_load_dwordx4 a[16:19], v178, s[28:31], 0 offen offset:0 sc1
    s_waitcnt vmcnt(9)
    buffer_load_dwordx4 a[20:23], v178, s[28:31], 0 offen offset:1024 sc1
    s_waitcnt vmcnt(9)
    buffer_load_dwordx4 a[24:27], v178, s[28:31], 0 offen offset:2048 sc1
    s_waitcnt vmcnt(9)
    buffer_load_dwordx4 a[28:31], v178, s[28:31], 0 offen offset:3072 sc1
    v_add_u32 v178, 4096, v178
    s_waitcnt vmcnt(9)
    buffer_load_dwordx4 a[32:35], v178, s[28:31], 0 offen offset:0 sc1
    s_waitcnt vmcnt(9)
    buffer_load_dwordx4 a[36:39], v178, s[28:31], 0 offen offset:1024 sc1
    s_mov_b32 s60, 0
L179:
    ds_read_b128 v[188:191], v39 offset:0
    s_waitcnt lgkmcnt(0)
    v_min_u32 v188, v188, v189
    v_min3_u32 v46, v188, v190, v191
    v_cmp_gt_u32 vcc, 24, v46
    s_cbranch_vccz L180
    s_sleep 4
    s_add_u32 s60, s60, 1
    s_cmp_lt_u32 s60, 3200000
    s_cbranch_scc1 L179
L180:
    s_mul_i32 s62, s40, 10240
    s_add_u32 s62, s62, 102400
    v_add_u32 v180, s62, v2
    ds_write_b128 v180, v[136:139] offset:0
    ds_write_b128 v180, v[140:143] offset:1024
    ds_write_b128 v180, v[144:147] offset:2048
    ds_write_b128 v180, v[148:151] offset:3072
    ds_write_b128 v180, v[152:155] offset:4096
    ds_write_b128 v180, v[156:159] offset:5120
    ds_write_b128 v180, v[160:163] offset:6144
    ds_write_b128 v180, v[164:167] offset:7168
    ds_write_b128 v180, v[168:171] offset:8192
    ds_write_b128 v180, v[172:175] offset:9216
    v_mov_b32_e64 v0, 32
    ds_write_b32 v45, v0
    s_mov_b32 s60, 0
L181:
    ds_read_b128 v[188:191], v39 offset:0
    s_waitcnt lgkmcnt(0)
    v_min_u32_e64 v188, v188, v189
    v_min3_u32 v46, v188, v190, v191
    v_cmp_gt_u32 vcc, 25, v46
    s_cbranch_vccz L182
    s_sleep 4
    s_add_u32 s60, s60, 1
    s_cmp_lt_u32 s60, 3200000
    s_cbranch_scc1 L181
L182:
    s_waitcnt vmcnt(0)
    s_mul_i32 s62, s40, 10240
    s_add_u32 s62, s62, 122880
    v_add_u32_e64 v180, s62, v2
    ds_write_b128 v180, a[0:3] offset:0
    ds_write_b128 v180, a[4:7] offset:1024
    ds_write_b128 v180, a[8:11] offset:2048
    ds_write_b128 v180, a[12:15] offset:3072
    ds_write_b128 v180, a[16:19] offset:4096
    ds_write_b128 v180, a[20:23] offset:5120
    ds_write_b128 v180, a[24:27] offset:6144
    ds_write_b128 v180, a[28:31] offset:7168
    ds_write_b128 v180, a[32:35] offset:8192
    ds_write_b128 v180, a[36:39] offset:9216
    v_mov_b32_e64 v0, 33
    ds_write_b32 v45, v0
    s_branch L_fin
L133:
    s_sub_u32 s63, s40, 2
    s_mov_b32 s68, 5
    s_mov_b32 s36, s18
    s_mov_b32 s37, s19
    s_mov_b32 s38, 2211840
    s_movk_i32 s67, 1280
    s_mov_b32 s69, 10
    s_movk_i32 s71, 5120
    s_mov_b32 s72, 5
    s_movk_i32 s75, 5120
    s_mov_b32 s73, 0x80000000
    s_lshr_b32 s60, s2, 5
    s_lshl_b32 s60, s60, 3
    s_add_u32 s60, s60, s41
    s_and_b32 s58, s42, 3
    s_cmp_lt_u32 s2, 96
    s_cbranch_scc0 L183
    s_and_b32 s59, s60, 1
    s_lshl_b32 s59, s59, 2
    s_add_u32 s58, s58, s59
    s_lshr_b32 s59, s60, 1
    s_cmp_eq_u32 s59, 10
    s_cselect_b32 s68, 4, 5
    s_cmp_gt_u32 s59, 10
    s_cselect_b32 s68, 0, s68
    s_mul_i32 s70, s58, 276480
    s_add_u32 s70, s70, 0x1e00000
    s_mov_b32 s74, 0x2248000
    s_mul_i32 s61, s59, 25600
    s_branch L185
L183:
    s_cmp_lt_u32 s2, 160
    s_cbranch_scc0 L184
    s_sub_u32 s60, s60, 24
    s_and_b32 s59, s60, 3
    s_lshl_b32 s59, s59, 2
    s_add_u32 s58, s58, s59
    s_lshr_b32 s59, s60, 2
    s_mov_b32 s36, s16
    s_mov_b32 s37, s17
    s_mov_b32 s38, 2211840
    s_movk_i32 s67, 3456
    s_mov_b32 s69, 14
    s_movk_i32 s71, 7168
    s_movk_i32 s75, 7168
    s_mov_b32 s72, 7
    s_mul_i32 s70, s58, 143360
    s_add_u32 s70, s70, 0x1b80000
    s_mov_b32 s73, 0x2150000
    s_mov_b32 s74, 0x2238000
    s_mul_i32 s61, s59, 35840
    s_branch L185
L184:
    s_sub_u32 s60, s60, 40
    s_and_b32 s59, s60, 1
    s_lshl_b32 s59, s59, 2
    s_add_u32 s58, s58, s59
    s_bfe_u32 s59, s60, 0x20001
    s_lshr_b32 s60, s60, 3
    s_mov_b32 s38, 819200
    s_cmp_eq_u32 s60, 1
    s_cselect_b64 s[36:37], s[12:13], s[8:9]
    s_cselect_b32 s73, 0x2140000, s73
    s_cmp_eq_u32 s60, 2
    s_cselect_b64 s[36:37], s[14:15], s[36:37]
    s_lshl_b32 s70, s60, 20
    s_add_u32 s70, s70, 0x1880000
    s_mul_i32 s74, s58, 102400
    s_add_u32 s70, s70, s74
    s_lshl_b32 s74, s60, 15
    s_add_u32 s74, s74, 0x2220000
    s_mul_i32 s75, s59, -15360
    s_add_u32 s75, s75, 66560
    s_mul_i32 s61, s59, 20480
L185:
    s_add_u32 s70, s70, s61
    s_mul_i32 s65, s63, 3
    s_mul_i32 s61, s65, s71
    s_add_u32 s70, s70, s61
    s_sub_u32 s64, s68, 3
    s_cmp_eq_u32 s63, 0
    s_cselect_b32 s64, 3, s64
    s_cselect_b32 s75, s71, s75
    s_cmp_eq_u32 s68, 0
    s_cselect_b32 s64, 0, s64
    s_lshl_b32 s61, s59, 1
    s_add_u32 s61, s61, s63
    s_lshl_b32 s60, s58, 3
    s_add_u32 s60, s60, s61
    s_lshl_b32 s60, s60, 9
    s_add_u32 s73, s73, s60
    s_lshl_b32 s60, s58, 12
    s_add_u32 s74, s74, s60
    s_lshl_b32 s61, s61, 7
    s_add_u32 s74, s74, s61
    s_mul_i32 s60, s59, 5
    s_add_u32 s60, s60, s65
    s_mul_i32 s60, s60, s67
    s_lshl_b32 s60, s60, 5
    s_mul_i32 s61, s58, s69
    s_lshl_b32 s61, s61, 4
    s_add_u32 s60, s60, s61
    v_mov_b32 v51, 0x80000000
    v_lshlrev_b32 v48, 1, v6
    v_xor_b32 v48, v48, v5
    v_mul_u32_u24 v49, s67, v6
    v_lshl_add_u32 v49, v48, 4, v49
    v_add_u32 v49, s60, v49
    v_cmp_gt_u32 vcc, s69, v48
    s_nop 1
    v_cndmask_b32_e64 v52, v51, v49, vcc
    v_lshlrev_b32 v48, 1, v6
    v_or_b32 v48, 8, v48
    v_xor_b32 v48, v48, v5
    v_mul_u32_u24 v49, s67, v6
    v_lshl_add_u32 v49, v48, 4, v49
    v_add_u32 v49, s60, v49
    v_cmp_gt_u32 vcc, s69, v48
    s_nop 1
    v_cndmask_b32_e64 v53, v51, v49, vcc
    s_lshl_b32 s67, s67, 2
    v_lshrrev_b32 v62, 2, v5
    v_and_b32 v60, 3, v1
    v_and_b32 v61, 1, v6
    v_lshlrev_b32 v61, 2, v61
    v_or_b32 v61, v61, v62
    v_lshlrev_b32_e64 v61, 5, v61
    v_lshl_add_u32 v62, v6, 3, v62
    v_lshlrev_b32_e64 v62, 8, v62
    v_mov_b32 v56, 0x3f803f80
    v_mov_b32 v57, 0x3f803f80
    v_mov_b32 v58, 0x3f803f80
    v_mov_b32 v59, 0x3f803f80
    s_waitcnt vmcnt(0) lgkmcnt(0)
    s_barrier
    s_mov_b32 s60, 0
L186:
    ds_read_b64 v[46:47], v39 offset:16
    s_waitcnt lgkmcnt(0)
    v_min_u32 v46, v46, v47
    v_cmp_gt_u32 vcc, 1, v46
    s_cbranch_vccz L187
    s_sleep 1
    s_add_u32 s60, s60, 1
    s_cmp_lt_u32 s60, 3200000
    s_cbranch_scc1 L186
L187:
    s_mul_i32 s60, s65, 8192
    s_add_u32 s66, s60, 114688
    s_cmp_eq_u32 s64, 0
    s_cbranch_scc1 L188
    s_mov_b32 m0, s66
    s_mov_b32 s61, 0
    s_lshl_b32 s59, s64, 1
L189:
    buffer_load_dwordx4 v52, s[36:39], s61 offen nt lds
    s_add_u32 s61, s61, s67
    s_add_u32 m0, m0, 1024
    s_nop 0
    buffer_load_dwordx4 v52, s[36:39], s61 offen nt lds
    s_add_u32 s61, s61, s67
    s_add_u32 m0, m0, 1024
    s_nop 0
    buffer_load_dwordx4 v53, s[36:39], s61 offen nt lds
    s_add_u32 s61, s61, s67
    s_add_u32 m0, m0, 1024
    s_nop 0
    buffer_load_dwordx4 v53, s[36:39], s61 offen nt lds
    s_add_u32 s61, s61, s67
    s_add_u32 m0, m0, 1024
    s_sub_u32 s59, s59, 1
    s_cmp_lg_u32 s59, 0
    s_cbranch_scc1 L189
L188:
    v_and_b32 v48, 3, v1
    s_lshl_b32 s60, s43, 2
    v_add_u32 v49, s60, v48
    s_lshl_b32 s60, s45, 2
    v_add_u32 v50, s60, v48
    v_lshrrev_b32_e64 v48, 2, v1
    v_mov_b32 v63, 0x80000000
    s_lshl_b32 s61, s44, 7
    v_lshlrev_b32 v46, 7, v50
    v_add_u32 v46, 0x2208000, v46
    v_cmp_eq_u32 vcc, 0, v48
    s_nop 1
    v_cndmask_b32_e64 v63, v63, v46, vcc
    v_lshlrev_b32_e64 v46, 7, v50
    v_add_u32 v46, 0x2218000, v46
    v_cmp_eq_u32 vcc, 1, v48
    s_nop 1
    v_cndmask_b32_e64 v63, v63, v46, vcc
    v_lshlrev_b32_e64 v46, 7, v49
    v_add_u32 v46, 0x220c000, v46
    v_cmp_eq_u32 vcc, 2, v48
    s_nop 1
    v_cndmask_b32_e64 v63, v63, v46, vcc
    v_lshlrev_b32_e64 v46, 7, v49
    v_add_u32 v46, 0x2210000, v46
    v_cmp_eq_u32 vcc, 3, v48
    s_nop 1
    v_cndmask_b32_e64 v63, v63, v46, vcc
    v_lshlrev_b32_e64 v46, 7, v49
    v_add_u32 v46, 0x2214000, v46
    v_cmp_eq_u32 vcc, 4, v48
    s_nop 1
    v_cndmask_b32_e64 v63, v63, v46, vcc
    v_lshlrev_b32_e64 v46, 10, v49
    v_add_u32 v46, 0x2100000, v46
    v_add_u32 v46, s61, v46
    v_cmp_eq_u32 vcc, 5, v48
    s_nop 1
    v_cndmask_b32_e64 v63, v63, v46, vcc
    v_lshlrev_b32 v46, 10, v49
    v_add_u32 v46, 0x2120000, v46
    v_add_u32 v46, s61, v46
    v_cmp_eq_u32 vcc, 6, v48
    s_nop 1
    v_cndmask_b32_e64 v63, v63, v46, vcc
    v_lshlrev_b32 v48, 3, v60
    v_xor_b32_e64 v48, v48, v61
    v_add3_u32 v64, v48, v62, s66
    s_add_u32 s60, s70, 0
    s_cmp_gt_u32 s72, 0
    s_cselect_b32 s60, s60, 0x80000000
    v_add_u32 v72, s60, v2
    v_mov_b32 v128, 0
    v_mov_b32 v129, 0
    v_mov_b32 v130, 0
    v_mov_b32 v131, 0
    v_lshlrev_b32 v48, 3, v60
    v_add_u32 v48, 32, v48
    v_xor_b32 v48, v48, v61
    v_add3_u32 v65, v48, v62, s66
    s_add_u32 s60, s70, 1024
    s_cmp_gt_u32 s72, 1
    s_cselect_b32 s60, s60, 0x80000000
    v_add_u32 v73, s60, v2
    v_mov_b32 v132, 0
    v_mov_b32 v133, 0
    v_mov_b32 v134, 0
    v_mov_b32 v135, 0
    v_lshlrev_b32 v48, 3, v60
    v_add_u32 v48, 64, v48
    v_xor_b32_e64 v48, v48, v61
    v_add3_u32 v66, v48, v62, s66
    s_add_u32 s60, s70, 2048
    s_cmp_gt_u32 s72, 2
    s_cselect_b32 s60, s60, 0x80000000
    v_add_u32 v74, s60, v2
    v_mov_b32 v136, 0
    v_mov_b32 v137, 0
    v_mov_b32 v138, 0
    v_mov_b32 v139, 0
    v_lshlrev_b32_e64 v48, 3, v60
    v_add_u32 v48, 96, v48
    v_xor_b32_e64 v48, v48, v61
    v_add3_u32 v67, v48, v62, s66
    s_add_u32 s60, s70, 3072
    s_cmp_gt_u32 s72, 3
    s_cselect_b32 s60, s60, 0x80000000
    v_add_u32 v75, s60, v2
    v_mov_b32 v140, 0
    v_mov_b32 v141, 0
    v_mov_b32 v142, 0
    v_mov_b32 v143, 0
    v_lshlrev_b32_e64 v48, 3, v60
    v_add_u32 v48, 128, v48
    v_xor_b32_e64 v48, v48, v61
    v_add3_u32 v68, v48, v62, s66
    s_add_u32 s60, s70, 4096
    s_cmp_gt_u32 s72, 4
    s_cselect_b32 s60, s60, 0x80000000
    v_add_u32 v76, s60, v2
    v_mov_b32 v144, 0
    v_mov_b32 v145, 0
    v_mov_b32 v146, 0
    v_mov_b32 v147, 0
    v_lshlrev_b32_e64 v48, 3, v60
    v_add_u32 v48, 160, v48
    v_xor_b32_e64 v48, v48, v61
    v_add3_u32 v69, v48, v62, s66
    s_add_u32 s60, s70, 5120
    s_cmp_gt_u32 s72, 5
    s_cselect_b32 s60, s60, 0x80000000
    v_add_u32 v77, s60, v2
    v_mov_b32 v148, 0
    v_mov_b32 v149, 0
    v_mov_b32 v150, 0
    v_mov_b32 v151, 0
    v_lshlrev_b32_e64 v48, 3, v60
    v_add_u32 v48, 192, v48
    v_xor_b32_e64 v48, v48, v61
    v_add3_u32 v70, v48, v62, s66
    s_add_u32 s60, s70, 6144
    s_cmp_gt_u32 s72, 6
    s_cselect_b32 s60, s60, 0x80000000
    v_add_u32 v78, s60, v2
    v_mov_b32 v152, 0
    v_mov_b32 v153, 0
    v_mov_b32 v154, 0
    v_mov_b32 v155, 0
    s_waitcnt vmcnt(0)
    s_waitcnt lgkmcnt(12)
    ds_read_b64_tr_b16 a[0:1], v64 offset:0
    ds_read_b64_tr_b16 a[2:3], v64 offset:1024
    s_waitcnt lgkmcnt(12)
    ds_read_b64_tr_b16 a[4:5], v65 offset:0
    ds_read_b64_tr_b16 a[6:7], v65 offset:1024
    s_waitcnt lgkmcnt(12)
    ds_read_b64_tr_b16 a[8:9], v66 offset:0
    ds_read_b64_tr_b16 a[10:11], v66 offset:1024
    s_waitcnt lgkmcnt(12)
    ds_read_b64_tr_b16 a[12:13], v67 offset:0
    ds_read_b64_tr_b16 a[14:15], v67 offset:1024
    s_waitcnt lgkmcnt(12)
    ds_read_b64_tr_b16 a[16:17], v68 offset:0
    ds_read_b64_tr_b16 a[18:19], v68 offset:1024
    s_waitcnt lgkmcnt(12)
    ds_read_b64_tr_b16 a[20:21], v69 offset:0
    ds_read_b64_tr_b16 a[22:23], v69 offset:1024
    s_waitcnt lgkmcnt(12)
    ds_read_b64_tr_b16 a[24:25], v70 offset:0
    ds_read_b64_tr_b16 a[26:27], v70 offset:1024
    s_waitcnt lgkmcnt(12)
    ds_read_b64_tr_b16 a[28:29], v64 offset:8192
    ds_read_b64_tr_b16 a[30:31], v64 offset:9216
    s_waitcnt lgkmcnt(12)
    ds_read_b64_tr_b16 a[32:33], v65 offset:8192
    ds_read_b64_tr_b16 a[34:35], v65 offset:9216
    s_waitcnt lgkmcnt(12)
    ds_read_b64_tr_b16 a[36:37], v66 offset:8192
    ds_read_b64_tr_b16 a[38:39], v66 offset:9216
    s_waitcnt lgkmcnt(12)
    ds_read_b64_tr_b16 a[40:41], v67 offset:8192
    ds_read_b64_tr_b16 a[42:43], v67 offset:9216
    s_waitcnt lgkmcnt(12)
    ds_read_b64_tr_b16 a[44:45], v68 offset:8192
    ds_read_b64_tr_b16 a[46:47], v68 offset:9216
    s_waitcnt lgkmcnt(12)
    ds_read_b64_tr_b16 a[48:49], v69 offset:8192
    ds_read_b64_tr_b16 a[50:51], v69 offset:9216
    s_waitcnt lgkmcnt(12)
    ds_read_b64_tr_b16 a[52:53], v70 offset:8192
    ds_read_b64_tr_b16 a[54:55], v70 offset:9216
    s_waitcnt lgkmcnt(12)
    ds_read_b64_tr_b16 a[56:57], v64 offset:16384
    ds_read_b64_tr_b16 a[58:59], v64 offset:17408
    s_waitcnt lgkmcnt(12)
    ds_read_b64_tr_b16 a[60:61], v65 offset:16384
    ds_read_b64_tr_b16 a[62:63], v65 offset:17408
    s_waitcnt lgkmcnt(12)
    ds_read_b64_tr_b16 v[160:161], v66 offset:16384
    ds_read_b64_tr_b16 v[162:163], v66 offset:17408
    s_waitcnt lgkmcnt(12)
    ds_read_b64_tr_b16 v[164:165], v67 offset:16384
    ds_read_b64_tr_b16 v[166:167], v67 offset:17408
    s_waitcnt lgkmcnt(12)
    ds_read_b64_tr_b16 v[168:169], v68 offset:16384
    ds_read_b64_tr_b16 v[170:171], v68 offset:17408
    s_waitcnt lgkmcnt(12)
    ds_read_b64_tr_b16 v[172:173], v69 offset:16384
    ds_read_b64_tr_b16 v[174:175], v69 offset:17408
    s_waitcnt lgkmcnt(12)
    ds_read_b64_tr_b16 v[176:177], v70 offset:16384
    ds_read_b64_tr_b16 v[178:179], v70 offset:17408
    s_waitcnt lgkmcnt(0)
    v_mov_b32 v0, 1
    ds_write_b32 v45, v0
    s_mov_b32 s60, 0x9E3779B1
    v_mul_lo_u32 v3, v3, s60
    v_add_u32 v3, 0x7F4A7C15, v3
    s_getreg_b32 s57, hwreg(HW_REG_XCC_ID, 0, 4)
    s_lshl_b32 s57, s57, 8
    s_cmp_lg_u32 s63, 0
    s_cbranch_scc1 L190
    s_mov_b32 s60, 0
L191:
    ds_read_b64 v[46:47], v39 offset:24
    s_waitcnt lgkmcnt(0)
    v_min_u32 v46, v46, v47
    v_cmp_gt_u32 vcc, 1, v46
    s_cbranch_vccz L192
    s_add_u32 s60, s60, 1
    s_cmp_lt_u32 s60, 3200000
    s_cbranch_scc1 L191
L192:
    s_lshl_b32 s60, s41, 12
    s_lshl_b32 s61, s42, 7
    s_add_u32 s60, s60, s61
    s_add_u32 s60, s60, 0x2260000
    v_mov_b32 v48, s60
    v_xor_b32 v49, s57, v3
    s_mov_b64 exec, 1
    buffer_store_dword v49, v48, s[28:31], 0 offen sc1
    s_mov_b64 exec, -1
L190:
    s_sub_u32 s60, s2, 160
    s_cmp_lt_u32 s60, 96
    s_cbranch_scc0 L194
    s_cmp_eq_u32 s64, 0
    s_cbranch_scc1 L194
    buffer_store_dwordx4 a[0:3], v72, s[28:31], 0 offen sc1
    v_add_u32 v72, s75, v72
    v_mfma_f32_16x16x32_bf16 v[128:131], a[0:3], v[56:59], v[128:131]
    buffer_store_dwordx4 a[4:7], v73, s[28:31], 0 offen sc1
    v_add_u32_e64 v73, s75, v73
    v_mfma_f32_16x16x32_bf16 v[132:135], a[4:7], v[56:59], v[132:135]
    buffer_store_dwordx4 a[8:11], v74, s[28:31], 0 offen sc1
    v_add_u32_e64 v74, s75, v74
    v_mfma_f32_16x16x32_bf16 v[136:139], a[8:11], v[56:59], v[136:139]
    buffer_store_dwordx4 a[12:15], v75, s[28:31], 0 offen sc1
    v_add_u32_e64 v75, s75, v75
    v_mfma_f32_16x16x32_bf16 v[140:143], a[12:15], v[56:59], v[140:143]
    buffer_store_dwordx4 a[16:19], v76, s[28:31], 0 offen sc1
    v_add_u32_e64 v76, s75, v76
    v_mfma_f32_16x16x32_bf16 v[144:147], a[16:19], v[56:59], v[144:147]
    s_cmp_lt_u32 s72, 6
    s_cbranch_scc1 L195
    buffer_store_dwordx4 a[20:23], v77, s[28:31], 0 offen sc1
    v_add_u32_e64 v77, s75, v77
    v_mfma_f32_16x16x32_bf16 v[148:151], a[20:23], v[56:59], v[148:151]
    buffer_store_dwordx4 a[24:27], v78, s[28:31], 0 offen sc1
    v_add_u32_e64 v78, s75, v78
    v_mfma_f32_16x16x32_bf16 v[152:155], a[24:27], v[56:59], v[152:155]
L195:
    s_cmp_le_u32 s64, 1
    s_cbranch_scc1 L193
    buffer_store_dwordx4 a[28:31], v72, s[28:31], 0 offen sc1
    v_add_u32_e64 v72, s71, v72
    v_mfma_f32_16x16x32_bf16 v[128:131], a[28:31], v[56:59], v[128:131]
    buffer_store_dwordx4 a[32:35], v73, s[28:31], 0 offen sc1
    v_add_u32_e64 v73, s71, v73
    v_mfma_f32_16x16x32_bf16 v[132:135], a[32:35], v[56:59], v[132:135]
    buffer_store_dwordx4 a[36:39], v74, s[28:31], 0 offen sc1
    v_add_u32_e64 v74, s71, v74
    v_mfma_f32_16x16x32_bf16 v[136:139], a[36:39], v[56:59], v[136:139]
    buffer_store_dwordx4 a[40:43], v75, s[28:31], 0 offen sc1
    v_add_u32_e64 v75, s71, v75
    v_mfma_f32_16x16x32_bf16 v[140:143], a[40:43], v[56:59], v[140:143]
    buffer_store_dwordx4 a[44:47], v76, s[28:31], 0 offen sc1
    v_add_u32_e64 v76, s71, v76
    v_mfma_f32_16x16x32_bf16 v[144:147], a[44:47], v[56:59], v[144:147]
    s_cmp_lt_u32 s72, 6
    s_cbranch_scc1 L196
    buffer_store_dwordx4 a[48:51], v77, s[28:31], 0 offen sc1
    v_add_u32_e64 v77, s71, v77
    v_mfma_f32_16x16x32_bf16 v[148:151], a[48:51], v[56:59], v[148:151]
    buffer_store_dwordx4 a[52:55], v78, s[28:31], 0 offen sc1
    v_add_u32_e64 v78, s71, v78
    v_mfma_f32_16x16x32_bf16 v[152:155], a[52:55], v[56:59], v[152:155]
L196:
    s_cmp_le_u32 s64, 2
    s_cbranch_scc1 L193
    buffer_store_dwordx4 a[56:59], v72, s[28:31], 0 offen sc1
    v_add_u32_e64 v72, s71, v72
    v_mfma_f32_16x16x32_bf16 v[128:131], a[56:59], v[56:59], v[128:131]
    buffer_store_dwordx4 a[60:63], v73, s[28:31], 0 offen sc1
    v_add_u32_e64 v73, s71, v73
    v_mfma_f32_16x16x32_bf16 v[132:135], a[60:63], v[56:59], v[132:135]
    buffer_store_dwordx4 v[160:163], v74, s[28:31], 0 offen sc1
    v_add_u32_e64 v74, s71, v74
    v_mfma_f32_16x16x32_bf16 v[136:139], v[160:163], v[56:59], v[136:139]
    buffer_store_dwordx4 v[164:167], v75, s[28:31], 0 offen sc1
    v_add_u32_e64 v75, s71, v75
    v_mfma_f32_16x16x32_bf16 v[140:143], v[164:167], v[56:59], v[140:143]
    buffer_store_dwordx4 v[168:171], v76, s[28:31], 0 offen sc1
    v_add_u32_e64 v76, s71, v76
    v_mfma_f32_16x16x32_bf16 v[144:147], v[168:171], v[56:59], v[144:147]
    s_cmp_lt_u32 s72, 6
    s_cbranch_scc1 L197
    buffer_store_dwordx4 v[172:175], v77, s[28:31], 0 offen sc1
    v_add_u32_e64 v77, s71, v77
    v_mfma_f32_16x16x32_bf16 v[148:151], v[172:175], v[56:59], v[148:151]
    buffer_store_dwordx4 v[176:179], v78, s[28:31], 0 offen sc1
    v_add_u32_e64 v78, s71, v78
    v_mfma_f32_16x16x32_bf16 v[152:155], v[176:179], v[56:59], v[152:155]
L197:
L193:
    v_lshl_add_u32 v48, v6, 4, s73
    v_cmp_eq_u32 vcc, 0, v5
    s_nop 1
    v_cndmask_b32_e64 v48, v51, v48, vcc
    s_nop 4
    s_cmp_ge_u32 s73, 0x80000000
    s_cbranch_scc1 L198
    buffer_store_dwordx4 v[128:131], v48, s[28:31], 0 offen offset:0 sc1
    buffer_store_dwordx4 v[132:135], v48, s[28:31], 0 offen offset:64 sc1
    buffer_store_dwordx4 v[136:139], v48, s[28:31], 0 offen offset:128 sc1
    buffer_store_dwordx4 v[140:143], v48, s[28:31], 0 offen offset:192 sc1
    buffer_store_dwordx4 v[144:147], v48, s[28:31], 0 offen offset:256 sc1
    buffer_store_dwordx4 v[148:151], v48, s[28:31], 0 offen offset:320 sc1
    buffer_store_dwordx4 v[152:155], v48, s[28:31], 0 offen offset:384 sc1
L198:
    v_mov_b32 v48, s74
    s_waitcnt vmcnt(0)
    s_mov_b64 exec, 1
    buffer_store_dword v3, v48, s[28:31], 0 offen sc1
    s_mov_b64 exec, -1
L194:
    s_cmp_eq_u32 s72, 7
    s_cbranch_scc1 L199
    s_mov_b32 s60, 0
L200:
    ds_read_b64 v[46:47], v39 offset:16
    s_waitcnt lgkmcnt(0)
    v_min_u32 v46, v46, v47
    v_cmp_gt_u32 vcc, 3, v46
    s_cbranch_vccz L201
    s_sleep 2
    s_add_u32 s60, s60, 1
    s_cmp_lt_u32 s60, 3200000
    s_cbranch_scc1 L200
L201:
L199:
    s_sub_u32 s60, s2, 160
    s_cmp_lt_u32 s60, 96
    s_cbranch_scc1 L203
    s_cmp_eq_u32 s64, 0
    s_cbranch_scc1 L203
    s_waitcnt vmcnt(3)
    buffer_store_dwordx4 a[0:3], v72, s[28:31], 0 offen sc1
    v_add_u32_e64 v72, s75, v72
    v_mfma_f32_16x16x32_bf16 v[128:131], a[0:3], v[56:59], v[128:131]
    s_waitcnt vmcnt(3)
    buffer_store_dwordx4 a[4:7], v73, s[28:31], 0 offen sc1
    v_add_u32 v73, s75, v73
    v_mfma_f32_16x16x32_bf16 v[132:135], a[4:7], v[56:59], v[132:135]
    s_waitcnt vmcnt(3)
    buffer_store_dwordx4 a[8:11], v74, s[28:31], 0 offen sc1
    v_add_u32 v74, s75, v74
    v_mfma_f32_16x16x32_bf16 v[136:139], a[8:11], v[56:59], v[136:139]
    s_waitcnt vmcnt(3)
    buffer_store_dwordx4 a[12:15], v75, s[28:31], 0 offen sc1
    v_add_u32 v75, s75, v75
    v_mfma_f32_16x16x32_bf16 v[140:143], a[12:15], v[56:59], v[140:143]
    s_waitcnt vmcnt(3)
    buffer_store_dwordx4 a[16:19], v76, s[28:31], 0 offen sc1
    v_add_u32 v76, s75, v76
    v_mfma_f32_16x16x32_bf16 v[144:147], a[16:19], v[56:59], v[144:147]
    s_cmp_lt_u32 s72, 6
    s_cbranch_scc1 L204
    s_waitcnt vmcnt(3)
    buffer_store_dwordx4 a[20:23], v77, s[28:31], 0 offen sc1
    v_add_u32 v77, s75, v77
    v_mfma_f32_16x16x32_bf16 v[148:151], a[20:23], v[56:59], v[148:151]
    s_waitcnt vmcnt(3)
    buffer_store_dwordx4 a[24:27], v78, s[28:31], 0 offen sc1
    v_add_u32 v78, s75, v78
    v_mfma_f32_16x16x32_bf16 v[152:155], a[24:27], v[56:59], v[152:155]
L204:
    s_cmp_le_u32 s64, 1
    s_cbranch_scc1 L202
    s_waitcnt vmcnt(3)
    buffer_store_dwordx4 a[28:31], v72, s[28:31], 0 offen sc1
    v_add_u32 v72, s71, v72
    v_mfma_f32_16x16x32_bf16 v[128:131], a[28:31], v[56:59], v[128:131]
    s_waitcnt vmcnt(3)
    buffer_store_dwordx4 a[32:35], v73, s[28:31], 0 offen sc1
    v_add_u32 v73, s71, v73
    v_mfma_f32_16x16x32_bf16 v[132:135], a[32:35], v[56:59], v[132:135]
    s_waitcnt vmcnt(3)
    buffer_store_dwordx4 a[36:39], v74, s[28:31], 0 offen sc1
    v_add_u32 v74, s71, v74
    v_mfma_f32_16x16x32_bf16 v[136:139], a[36:39], v[56:59], v[136:139]
    s_waitcnt vmcnt(3)
    buffer_store_dwordx4 a[40:43], v75, s[28:31], 0 offen sc1
    v_add_u32 v75, s71, v75
    v_mfma_f32_16x16x32_bf16 v[140:143], a[40:43], v[56:59], v[140:143]
    s_waitcnt vmcnt(3)
    buffer_store_dwordx4 a[44:47], v76, s[28:31], 0 offen sc1
    v_add_u32 v76, s71, v76
    v_mfma_f32_16x16x32_bf16 v[144:147], a[44:47], v[56:59], v[144:147]
    s_cmp_lt_u32 s72, 6
    s_cbranch_scc1 L205
    s_waitcnt vmcnt(3)
    buffer_store_dwordx4 a[48:51], v77, s[28:31], 0 offen sc1
    v_add_u32 v77, s71, v77
    v_mfma_f32_16x16x32_bf16 v[148:151], a[48:51], v[56:59], v[148:151]
    s_waitcnt vmcnt(3)
    buffer_store_dwordx4 a[52:55], v78, s[28:31], 0 offen sc1
    v_add_u32 v78, s71, v78
    v_mfma_f32_16x16x32_bf16 v[152:155], a[52:55], v[56:59], v[152:155]
L205:
    s_cmp_le_u32 s64, 2
    s_cbranch_scc1 L202
    s_waitcnt vmcnt(3)
    buffer_store_dwordx4 a[56:59], v72, s[28:31], 0 offen sc1
    v_add_u32 v72, s71, v72
    v_mfma_f32_16x16x32_bf16 v[128:131], a[56:59], v[56:59], v[128:131]
    s_waitcnt vmcnt(3)
    buffer_store_dwordx4 a[60:63], v73, s[28:31], 0 offen sc1
    v_add_u32 v73, s71, v73
    v_mfma_f32_16x16x32_bf16 v[132:135], a[60:63], v[56:59], v[132:135]
    s_waitcnt vmcnt(3)
    buffer_store_dwordx4 v[160:163], v74, s[28:31], 0 offen sc1
    v_add_u32 v74, s71, v74
    v_mfma_f32_16x16x32_bf16 v[136:139], v[160:163], v[56:59], v[136:139]
    s_waitcnt vmcnt(3)
    buffer_store_dwordx4 v[164:167], v75, s[28:31], 0 offen sc1
    v_add_u32 v75, s71, v75
    v_mfma_f32_16x16x32_bf16 v[140:143], v[164:167], v[56:59], v[140:143]
    s_waitcnt vmcnt(3)
    buffer_store_dwordx4 v[168:171], v76, s[28:31], 0 offen sc1
    v_add_u32 v76, s71, v76
    v_mfma_f32_16x16x32_bf16 v[144:147], v[168:171], v[56:59], v[144:147]
    s_cmp_lt_u32 s72, 6
    s_cbranch_scc1 L206
    s_waitcnt vmcnt(3)
    buffer_store_dwordx4 v[172:175], v77, s[28:31], 0 offen sc1
    v_add_u32 v77, s71, v77
    v_mfma_f32_16x16x32_bf16 v[148:151], v[172:175], v[56:59], v[148:151]
    s_waitcnt vmcnt(3)
    buffer_store_dwordx4 v[176:179], v78, s[28:31], 0 offen sc1
    v_add_u32 v78, s71, v78
    v_mfma_f32_16x16x32_bf16 v[152:155], v[176:179], v[56:59], v[152:155]
L206:
L202:
    v_lshl_add_u32 v48, v6, 4, s73
    v_cmp_eq_u32 vcc, 0, v5
    s_nop 1
    v_cndmask_b32_e64 v48, v51, v48, vcc
    s_nop 4
    s_cmp_ge_u32 s73, 0x80000000
    s_cbranch_scc1 L207
    buffer_store_dwordx4 v[128:131], v48, s[28:31], 0 offen offset:0 sc1
    buffer_store_dwordx4 v[132:135], v48, s[28:31], 0 offen offset:64 sc1
    buffer_store_dwordx4 v[136:139], v48, s[28:31], 0 offen offset:128 sc1
    buffer_store_dwordx4 v[140:143], v48, s[28:31], 0 offen offset:192 sc1
    buffer_store_dwordx4 v[144:147], v48, s[28:31], 0 offen offset:256 sc1
    buffer_store_dwordx4 v[148:151], v48, s[28:31], 0 offen offset:320 sc1
    buffer_store_dwordx4 v[152:155], v48, s[28:31], 0 offen offset:384 sc1
L207:
    v_mov_b32 v48, s74
    s_waitcnt vmcnt(0)
    s_mov_b64 exec, 1
    buffer_store_dword v3, v48, s[28:31], 0 offen sc1
    s_mov_b64 exec, -1
L203:
    s_mov_b32 s60, 0
L208:
    ds_read_b64 v[46:47], v39 offset:16
    s_waitcnt lgkmcnt(0)
    v_min_u32 v46, v46, v47
    v_cmp_gt_u32 vcc, 6, v46
    s_cbranch_vccz L209
    s_sleep 2
    s_add_u32 s60, s60, 1
    s_cmp_lt_u32 s60, 3200000
    s_cbranch_scc1 L208
L209:
    buffer_load_dword v44, v63, s[28:31], 0 offen sc1
    s_cmp_lg_u32 s63, 0
    s_cbranch_scc1 L210
    s_lshl_b32 s61, s41, 12
    s_add_u32 s61, s61, 0x2260000
    v_and_b32 v48, 31, v1
    v_lshl_add_u32 v48, v48, 7, s61
    s_mov_b32 s60, 0
L211:
    buffer_load_dword v4, v48, s[28:31], 0 offen sc1
    s_waitcnt vmcnt(0)
    v_xor_b32_e64 v0, v4, v3
    v_and_b32 v0, 0xfffff0ff, v0
    v_cmp_ne_u32 vcc, 0, v0
    s_cbranch_vccz L212
    s_sleep 8
    s_add_u32 s60, s60, 1
    s_cmp_lt_u32 s60, 400000
    s_cbranch_scc1 L211
L212:
    v_xor_b32 v48, s57, v3
    v_cmp_ne_u32 vcc, v48, v4
    s_nop 0
    s_cmp_eq_u64 vcc, 0
    s_cselect_b32 s60, 2, 1
    v_mov_b32_e64 v48, s60
    ds_write_b32 v39, v48 offset:32
L210:
    s_mul_i32 s60, s63, 3072
    s_add_u32 s60, s60, 61440
    v_add_u32_e64 v48, s60, v2
    s_mul_i32 s60, s63, 1536
    s_add_u32 s60, s60, 86016
    v_lshl_add_u32 v49, v1, 3, s60
    s_lshl_b32 s61, s44, 12
    s_add_u32 s61, s61, 0x2230000
    v_min_u32 v50, 7, v1
    v_lshl_add_u32 v50, v50, 7, s61
    s_mov_b32 s60, 0
L213:
    buffer_load_dword v4, v50, s[28:31], 0 offen sc1
    s_waitcnt vmcnt(0)
    v_xor_b32 v0, v4, v3
    v_cmp_ne_u32 vcc, 0, v0
    s_cbranch_vccz L214
    s_sleep 8
    s_add_u32 s60, s60, 1
    s_cmp_lt_u32 s60, 400000
    s_cbranch_scc1 L213
L214:
    s_mul_i32 s60, s44, 102400
    s_add_u32 s60, s60, 0x1a80000
    v_add_u32 v176, s60, v2
    s_mov_b32 s60, 0
L215:
    ds_read_b128 v[188:191], v39 offset:0
    s_waitcnt lgkmcnt(0)
    v_min_u32 v188, v188, v189
    v_min3_u32 v46, v188, v190, v191
    v_cmp_gt_u32 vcc, 4, v46
    s_cbranch_vccz L216
    s_sleep 4
    s_add_u32 s60, s60, 1
    s_cmp_lt_u32 s60, 3200000
    s_cbranch_scc1 L215
L216:
    s_setprio 3
    s_mov_b32 s60, 0
L217:
    ds_read_b128 v[188:191], v39 offset:0
    s_waitcnt lgkmcnt(0)
    v_min_u32_e64 v188, v188, v189
    v_min3_u32 v46, v188, v190, v191
    v_cmp_gt_u32 vcc, 5, v46
    s_cbranch_vccz L218
    s_sleep 1
    s_add_u32 s60, s60, 1
    s_cmp_lt_u32 s60, 3200000
    s_cbranch_scc1 L217
L218:
    ds_read_b128 v[80:83], v48 offset:0
    ds_read_b128 v[84:87], v48 offset:1024
    ds_read_b128 v[88:91], v48 offset:2048
    ds_read_b128 v[92:95], v48 offset:6144
    ds_read_b128 v[96:99], v48 offset:7168
    ds_read_b128 v[100:103], v48 offset:8192
    ds_read_b128 v[104:107], v48 offset:12288
    ds_read_b128 v[108:111], v48 offset:13312
    ds_read_b128 v[112:115], v48 offset:14336
    ds_read_b128 v[116:119], v48 offset:18432
    ds_read_b128 v[120:123], v48 offset:19456
    ds_read_b128 v[124:127], v48 offset:20480
    s_waitcnt lgkmcnt(6)
    v_pk_add_f32 v[80:81], v[80:81], v[92:93]
    v_pk_add_f32 v[82:83], v[82:83], v[94:95]
    v_pk_add_f32 v[84:85], v[84:85], v[96:97]
    v_pk_add_f32 v[86:87], v[86:87], v[98:99]
    v_pk_add_f32 v[88:89], v[88:89], v[100:101]
    v_pk_add_f32 v[90:91], v[90:91], v[102:103]
    s_waitcnt lgkmcnt(0)
    v_pk_add_f32 v[104:105], v[104:105], v[116:117]
    v_pk_add_f32 v[106:107], v[106:107], v[118:119]
    v_pk_add_f32 v[108:109], v[108:109], v[120:121]
    v_pk_add_f32 v[110:111], v[110:111], v[122:123]
    v_pk_add_f32 v[112:113], v[112:113], v[124:125]
    v_pk_add_f32 v[114:115], v[114:115], v[126:127]
    v_pk_add_f32 v[80:81], v[80:81], v[104:105]
    v_pk_add_f32 v[82:83], v[82:83], v[106:107]
    v_pk_add_f32 v[84:85], v[84:85], v[108:109]
    v_pk_add_f32 v[86:87], v[86:87], v[110:111]
    v_pk_add_f32 v[88:89], v[88:89], v[112:113]
    v_pk_add_f32 v[90:91], v[90:91], v[114:115]
    v_cvt_pk_bf16_f32 v92, v80, v81
    v_cvt_pk_bf16_f32 v93, v82, v83
    ds_write_b64 v49, v[92:93] offset:0
    v_cvt_pk_bf16_f32 v94, v84, v85
    v_cvt_pk_bf16_f32 v95, v86, v87
    ds_write_b64 v49, v[94:95] offset:512
    v_cvt_pk_bf16_f32 v96, v88, v89
    v_cvt_pk_bf16_f32 v97, v90, v91
    ds_write_b64 v49, v[96:97] offset:1024
    s_mov_b32 s60, 0
L219:
    ds_read_b128 v[188:191], v39 offset:0
    s_waitcnt lgkmcnt(0)
    v_min_u32 v188, v188, v189
    v_min3_u32 v46, v188, v190, v191
    v_cmp_gt_u32 vcc, 6, v46
    s_cbranch_vccz L220
    s_add_u32 s60, s60, 1
    s_cmp_lt_u32 s60, 3200000
    s_cbranch_scc1 L219
L220:
    v_mov_b32_e64 v0, 3
    ds_write_b32 v45, v0
    s_setprio 0
    s_mul_i32 s62, s78, 5
    s_mul_i32 s61, s63, 10240
    s_add_u32 s62, s62, s61
    v_add_u32 v178, s62, v176
    buffer_load_dwordx4 a[0:3], v178, s[28:31], 0 offen offset:0 sc1
    buffer_load_dwordx4 a[4:7], v178, s[28:31], 0 offen offset:1024 sc1
    buffer_load_dwordx4 a[8:11], v178, s[28:31], 0 offen offset:2048 sc1
    buffer_load_dwordx4 a[12:15], v178, s[28:31], 0 offen offset:3072 sc1
    v_add_u32 v178, 4096, v178
    buffer_load_dwordx4 a[16:19], v178, s[28:31], 0 offen offset:0 sc1
    buffer_load_dwordx4 a[20:23], v178, s[28:31], 0 offen offset:1024 sc1
    buffer_load_dwordx4 a[24:27], v178, s[28:31], 0 offen offset:2048 sc1
    buffer_load_dwordx4 a[28:31], v178, s[28:31], 0 offen offset:3072 sc1
    v_add_u32 v178, 4096, v178
    s_waitcnt vmcnt(7)
    buffer_load_dwordx4 a[32:35], v178, s[28:31], 0 offen offset:0 sc1
    s_waitcnt vmcnt(7)
    buffer_load_dwordx4 a[36:39], v178, s[28:31], 0 offen offset:1024 sc1
    s_mul_i32 s62, s79, 5
    s_mul_i32 s61, s63, 10240
    s_add_u32 s62, s62, s61
    v_add_u32 v178, s62, v176
    s_waitcnt vmcnt(7)
    buffer_load_dwordx4 a[40:43], v178, s[28:31], 0 offen offset:0 sc1
    s_waitcnt vmcnt(7)
    buffer_load_dwordx4 a[44:47], v178, s[28:31], 0 offen offset:1024 sc1
    s_waitcnt vmcnt(7)
    buffer_load_dwordx4 a[48:51], v178, s[28:31], 0 offen offset:2048 sc1
    s_waitcnt vmcnt(7)
    buffer_load_dwordx4 a[52:55], v178, s[28:31], 0 offen offset:3072 sc1
    v_add_u32 v178, 4096, v178
    s_waitcnt vmcnt(7)
    buffer_load_dwordx4 a[56:59], v178, s[28:31], 0 offen offset:0 sc1
    s_waitcnt vmcnt(7)
    buffer_load_dwordx4 a[60:63], v178, s[28:31], 0 offen offset:1024 sc1
    s_waitcnt vmcnt(7)
    buffer_load_dwordx4 v[10:13], v178, s[28:31], 0 offen offset:2048 sc1
    s_waitcnt vmcnt(7)
    buffer_load_dwordx4 v[14:17], v178, s[28:31], 0 offen offset:3072 sc1
    v_add_u32 v178, 4096, v178
    s_waitcnt vmcnt(7)
    buffer_load_dwordx4 v[18:21], v178, s[28:31], 0 offen offset:0 sc1
    s_waitcnt vmcnt(7)
    buffer_load_dwordx4 v[22:25], v178, s[28:31], 0 offen offset:1024 sc1
    s_mul_i32 s62, s80, 5
    s_mul_i32 s61, s63, 10240
    s_add_u32 s62, s62, s61
    v_add_u32 v178, s62, v176
    s_waitcnt vmcnt(7)
    buffer_load_dwordx4 v[26:29], v178, s[28:31], 0 offen offset:0 sc1
    s_waitcnt vmcnt(7)
    buffer_load_dwordx4 v[30:33], v178, s[28:31], 0 offen offset:1024 sc1
    s_waitcnt vmcnt(7)
    buffer_load_dwordx4 v[34:37], v178, s[28:31], 0 offen offset:2048 sc1
    s_waitcnt vmcnt(7)
    buffer_load_dwordx4 v[40:43], v178, s[28:31], 0 offen offset:3072 sc1
    v_add_u32 v178, 4096, v178
    s_waitcnt vmcnt(7)
    buffer_load_dwordx4 v[128:131], v178, s[28:31], 0 offen offset:0 sc1
    s_waitcnt vmcnt(7)
    buffer_load_dwordx4 v[132:135], v178, s[28:31], 0 offen offset:1024 sc1
    s_waitcnt vmcnt(7)
    buffer_load_dwordx4 v[136:139], v178, s[28:31], 0 offen offset:2048 sc1
    s_waitcnt vmcnt(7)
    buffer_load_dwordx4 v[140:143], v178, s[28:31], 0 offen offset:3072 sc1
    v_add_u32 v178, 4096, v178
    s_waitcnt vmcnt(7)
    buffer_load_dwordx4 v[144:147], v178, s[28:31], 0 offen offset:0 sc1
    s_waitcnt vmcnt(7)
    buffer_load_dwordx4 v[148:151], v178, s[28:31], 0 offen offset:1024 sc1
    s_cmp_eq_u32 s63, 0
    s_cselect_b32 s60, 7, 21
    s_mov_b32 s61, 0x2248000
    s_cselect_b32 s61, 0x2230000, s61
    s_lshl_b32 s62, s44, 12
    s_add_u32 s61, s61, s62
    v_min_u32_e64 v48, s60, v1
    v_lshl_add_u32 v48, v48, 7, s61
    s_mov_b32 s60, 0
L221:
    buffer_load_dword v4, v48, s[28:31], 0 offen sc1
    s_waitcnt vmcnt(0)
    v_xor_b32 v0, v4, v3
    v_cmp_ne_u32 vcc, 0, v0
    s_cbranch_vccz L222
    s_sleep 8
    s_add_u32 s60, s60, 1
    s_cmp_lt_u32 s60, 400000
    s_cbranch_scc1 L221
L222:
    s_lshl_b32 s61, s46, 12
    s_add_u32 s61, s61, 0x2238000
    v_min_u32 v48, 7, v1
    v_lshl_add_u32 v48, v48, 7, s61
    s_mov_b32 s60, 0
L223:
    buffer_load_dword v4, v48, s[28:31], 0 offen sc1
    s_waitcnt vmcnt(0)
    v_xor_b32 v0, v4, v3
    v_cmp_ne_u32 vcc, 0, v0
    s_cbranch_vccz L224
    s_sleep 8
    s_add_u32 s60, s60, 1
    s_cmp_lt_u32 s60, 400000
    s_cbranch_scc1 L223
L224:
    v_mov_b32_e64 v0, 4
    ds_write_b32 v45, v0
    s_waitcnt vmcnt(0)
    s_mov_b32 s60, 0
L225:
    ds_read_b128 v[188:191], v39 offset:0
    s_waitcnt lgkmcnt(0)
    v_min_u32 v188, v188, v189
    v_min3_u32 v46, v188, v190, v191
    v_cmp_gt_u32 vcc, 8, v46
    s_cbranch_vccz L226
    s_sleep 4
    s_add_u32 s60, s60, 1
    s_cmp_lt_u32 s60, 3200000
    s_cbranch_scc1 L225
L226:
    buffer_load_dword v44, v63, s[28:31], 0 offen sc1
    s_lshl_b32 s60, s44, 12
    s_lshl_b32 s61, s63, 8
    s_add_u32 s60, s60, s61
    s_add_u32 s60, s60, 0x2140000
    v_lshl_add_u32 v48, v1, 2, s60
    buffer_load_dword v52, v48, s[28:31], 0 offen offset:0 sc1
    buffer_load_dword v53, v48, s[28:31], 0 offen offset:512 sc1
    buffer_load_dword v54, v48, s[28:31], 0 offen offset:1024 sc1
    buffer_load_dword v55, v48, s[28:31], 0 offen offset:1536 sc1
    buffer_load_dword v56, v48, s[28:31], 0 offen offset:2048 sc1
    buffer_load_dword v57, v48, s[28:31], 0 offen offset:2560 sc1
    buffer_load_dword v58, v48, s[28:31], 0 offen offset:3072 sc1
    buffer_load_dword v59, v48, s[28:31], 0 offen offset:3584 sc1
    s_add_u32 s61, s61, 162880
    v_lshl_add_u32 v49, v1, 2, s61
    s_waitcnt vmcnt(0)
    v_add_f32 v52, v52, v56
    v_add_f32 v53, v53, v57
    v_add_f32 v54, v54, v58
    v_add_f32 v55, v55, v59
    v_add_f32 v52, v52, v54
    v_add_f32 v53, v53, v55
    v_add_f32 v52, v52, v53
    s_cmp_eq_u32 s63, 0
    s_cselect_b64 exec, -1, 0xffff
    ds_write_b32 v49, v52
    s_mov_b64 exec, -1
    v_mov_b32_e64 v0, 5
    ds_write_b32 v45, v0
    s_lshl_b32 s60, s46, 12
    s_lshl_b32 s61, s63, 8
    s_add_u32 s60, s60, s61
    s_add_u32 s60, s60, 0x2150000
    v_lshl_add_u32 v48, v1, 2, s60
    buffer_load_dword v52, v48, s[28:31], 0 offen offset:0 sc1
    buffer_load_dword v53, v48, s[28:31], 0 offen offset:512 sc1
    buffer_load_dword v54, v48, s[28:31], 0 offen offset:1024 sc1
    buffer_load_dword v55, v48, s[28:31], 0 offen offset:1536 sc1
    buffer_load_dword v56, v48, s[28:31], 0 offen offset:2048 sc1
    buffer_load_dword v57, v48, s[28:31], 0 offen offset:2560 sc1
    buffer_load_dword v58, v48, s[28:31], 0 offen offset:3072 sc1
    buffer_load_dword v59, v48, s[28:31], 0 offen offset:3584 sc1
    s_add_u32 s61, s61, 163264
    v_lshl_add_u32 v49, v1, 2, s61
    s_waitcnt vmcnt(0)
    v_add_f32 v52, v52, v56
    v_add_f32 v53, v53, v57
    v_add_f32 v54, v54, v58
    v_add_f32 v55, v55, v59
    v_add_f32 v52, v52, v54
    v_add_f32 v53, v53, v55
    v_add_f32 v52, v52, v53
    s_cmp_eq_u32 s63, 0
    s_cselect_b32 exec_hi, -1, 0xffff
    ds_write_b32 v49, v52
    s_mov_b64 exec, -1
    v_mov_b32 v0, 6
    ds_write_b32 v45, v0
    s_mul_i32 s60, s46, 143360
    s_add_u32 s60, s60, 0x1b80000
    v_add_u32 v176, s60, v2
    s_mov_b32 s60, 0
L229:
    ds_read_b128 v[188:191], v39 offset:0
    s_waitcnt lgkmcnt(0)
    v_min_u32 v188, v188, v189
    v_min3_u32 v46, v188, v190, v191
    v_cmp_gt_u32 vcc, 10, v46
    s_cbranch_vccz L230
    s_sleep 4
    s_add_u32 s60, s60, 1
    s_cmp_lt_u32 s60, 3200000
    s_cbranch_scc1 L229
L230:
    buffer_load_dword v44, v63, s[28:31], 0 offen sc1
    s_mov_b32 s60, 0
L231:
    ds_read_b128 v[188:191], v39 offset:0
    s_waitcnt lgkmcnt(0)
    v_min_u32 v188, v188, v189
    v_min3_u32 v46, v188, v190, v191
    v_cmp_gt_u32 vcc, 11, v46
    s_cbranch_vccz L232
    s_sleep 1
    s_add_u32 s60, s60, 1
    s_cmp_lt_u32 s60, 3200000
    s_cbranch_scc1 L231
L232:
    s_mul_i32 s62, s63, 10240
    s_add_u32 s62, s62, 0
    v_add_u32_e64 v180, s62, v2
    ds_write_b128 v180, a[0:3] offset:0
    ds_write_b128 v180, a[4:7] offset:1024
    ds_write_b128 v180, a[8:11] offset:2048
    ds_write_b128 v180, a[12:15] offset:3072
    ds_write_b128 v180, a[16:19] offset:4096
    ds_write_b128 v180, a[20:23] offset:5120
    ds_write_b128 v180, a[24:27] offset:6144
    ds_write_b128 v180, a[28:31] offset:7168
    ds_write_b128 v180, a[32:35] offset:8192
    ds_write_b128 v180, a[36:39] offset:9216
    v_mov_b32_e64 v0, 7
    ds_write_b32 v45, v0
    s_mul_i32 s62, s63, 10240
    s_add_u32 s62, s62, 102400
    v_add_u32_e64 v180, s62, v2
    ds_write_b128 v180, a[40:43] offset:0
    ds_write_b128 v180, a[44:47] offset:1024
    ds_write_b128 v180, a[48:51] offset:2048
    s_waitcnt lgkmcnt(8)
    ds_write_b128 v180, a[52:55] offset:3072
    ds_write_b128 v180, a[56:59] offset:4096
    ds_write_b128 v180, a[60:63] offset:5120
    ds_write_b128 v180, v[10:13] offset:6144
    ds_write_b128 v180, v[14:17] offset:7168
    ds_write_b128 v180, v[18:21] offset:8192
    s_waitcnt lgkmcnt(8)
    ds_write_b128 v180, v[22:25] offset:9216
    v_mov_b32_e64 v0, 8
    ds_write_b32 v45, v0
    s_mul_i32 s62, s63, 10240
    s_add_u32 s62, s62, 122880
    v_add_u32_e64 v180, s62, v2
    ds_write_b128 v180, v[26:29] offset:0
    ds_write_b128 v180, v[30:33] offset:1024
    ds_write_b128 v180, v[34:37] offset:2048
    ds_write_b128 v180, v[40:43] offset:3072
    s_waitcnt lgkmcnt(8)
    ds_write_b128 v180, v[128:131] offset:4096
    ds_write_b128 v180, v[132:135] offset:5120
    ds_write_b128 v180, v[136:139] offset:6144
    ds_write_b128 v180, v[140:143] offset:7168
    ds_write_b128 v180, v[144:147] offset:8192
    ds_write_b128 v180, v[148:151] offset:9216
    v_mov_b32 v0, 9
    ds_write_b32 v45, v0
    s_mov_b32 s60, 0
L233:
    ds_read_b128 v[188:191], v39 offset:0
    s_waitcnt lgkmcnt(0)
    v_min_u32_e64 v188, v188, v189
    v_min3_u32 v46, v188, v190, v191
    v_cmp_gt_u32 vcc, 12, v46
    s_cbranch_vccz L234
    s_sleep 4
    s_add_u32 s60, s60, 1
    s_cmp_lt_u32 s60, 3200000
    s_cbranch_scc1 L233
L234:
    buffer_load_dword v44, v63, s[28:31], 0 offen sc1
    s_mul_i32 s60, s44, 276480
    s_add_u32 s60, s60, 0x1e00000
    v_add_u32 v176, s60, v2
    s_mov_b32 s60, 0
L235:
    ds_read_b128 v[188:191], v39 offset:0
    s_waitcnt lgkmcnt(0)
    v_min_u32_e64 v188, v188, v189
    v_min3_u32 v46, v188, v190, v191
    v_cmp_gt_u32 vcc, 13, v46
    s_cbranch_vccz L236
    s_sleep 4
    s_add_u32 s60, s60, 1
    s_cmp_lt_u32 s60, 3200000
    s_cbranch_scc1 L235
L236:
    s_mov_b32 s60, 0
L237:
    ds_read_b128 v[188:191], v39 offset:0
    s_waitcnt lgkmcnt(0)
    v_min_u32 v188, v188, v189
    v_min3_u32 v46, v188, v190, v191
    v_cmp_gt_u32 vcc, 16, v46
    s_cbranch_vccz L238
    s_sleep 4
    s_add_u32 s60, s60, 1
    s_cmp_lt_u32 s60, 3200000
    s_cbranch_scc1 L237
L238:
    s_mul_i32 s62, s94, 5
    s_mul_i32 s61, s63, 10240
    s_add_u32 s62, s62, s61
    v_add_u32 v178, s62, v176
    buffer_load_dwordx4 v[152:155], v178, s[28:31], 0 offen offset:0 sc1
    buffer_load_dwordx4 v[156:159], v178, s[28:31], 0 offen offset:1024 sc1
    buffer_load_dwordx4 v[160:163], v178, s[28:31], 0 offen offset:2048 sc1
    buffer_load_dwordx4 v[164:167], v178, s[28:31], 0 offen offset:3072 sc1
    v_add_u32 v178, 4096, v178
    buffer_load_dwordx4 v[168:171], v178, s[28:31], 0 offen offset:0 sc1
    buffer_load_dwordx4 v[172:175], v178, s[28:31], 0 offen offset:1024 sc1
    buffer_load_dwordx4 v[64:67], v178, s[28:31], 0 offen offset:2048 sc1
    buffer_load_dwordx4 v[68:71], v178, s[28:31], 0 offen offset:3072 sc1
    v_add_u32 v178, 4096, v178
    s_waitcnt vmcnt(9)
    buffer_load_dwordx4 v[72:75], v178, s[28:31], 0 offen offset:0 sc1
    s_waitcnt vmcnt(9)
    buffer_load_dwordx4 v[76:79], v178, s[28:31], 0 offen offset:1024 sc1
    s_mul_i32 s62, s95, 5
    s_mul_i32 s61, s63, 10240
    s_add_u32 s62, s62, s61
    v_add_u32 v178, s62, v176
    s_waitcnt vmcnt(9)
    buffer_load_dwordx4 v[80:83], v178, s[28:31], 0 offen offset:0 sc1
    s_waitcnt vmcnt(9)
    buffer_load_dwordx4 v[84:87], v178, s[28:31], 0 offen offset:1024 sc1
    s_waitcnt vmcnt(9)
    buffer_load_dwordx4 v[88:91], v178, s[28:31], 0 offen offset:2048 sc1
    s_waitcnt vmcnt(9)
    buffer_load_dwordx4 v[92:95], v178, s[28:31], 0 offen offset:3072 sc1
    v_add_u32 v178, 4096, v178
    s_waitcnt vmcnt(9)
    buffer_load_dwordx4 v[96:99], v178, s[28:31], 0 offen offset:0 sc1
    s_waitcnt vmcnt(9)
    buffer_load_dwordx4 v[100:103], v178, s[28:31], 0 offen offset:1024 sc1
    s_waitcnt vmcnt(9)
    buffer_load_dwordx4 v[104:107], v178, s[28:31], 0 offen offset:2048 sc1
    s_waitcnt vmcnt(9)
    buffer_load_dwordx4 v[108:111], v178, s[28:31], 0 offen offset:3072 sc1
    v_add_u32 v178, 4096, v178
    s_waitcnt vmcnt(9)
    buffer_load_dwordx4 v[112:115], v178, s[28:31], 0 offen offset:0 sc1
    s_waitcnt vmcnt(9)
    buffer_load_dwordx4 v[116:119], v178, s[28:31], 0 offen offset:1024 sc1
    s_mul_i32 s62, s96, 5
    s_mul_i32 s61, s63, 10240
    s_add_u32 s62, s62, s61
    v_add_u32 v178, s62, v176
    s_waitcnt vmcnt(9)
    buffer_load_dwordx4 v[120:123], v178, s[28:31], 0 offen offset:0 sc1
    s_waitcnt vmcnt(9)
    buffer_load_dwordx4 v[124:127], v178, s[28:31], 0 offen offset:1024 sc1
    s_waitcnt vmcnt(9)
    buffer_load_dwordx4 a[0:3], v178, s[28:31], 0 offen offset:2048 sc1
    s_waitcnt vmcnt(9)
    buffer_load_dwordx4 a[4:7], v178, s[28:31], 0 offen offset:3072 sc1
    v_add_u32 v178, 4096, v178
    s_waitcnt vmcnt(9)
    buffer_load_dwordx4 a[8:11], v178, s[28:31], 0 offen offset:0 sc1
    s_waitcnt vmcnt(9)
    buffer_load_dwordx4 a[12:15], v178, s[28:31], 0 offen offset:1024 sc1
    s_waitcnt vmcnt(9)
    buffer_load_dwordx4 a[16:19], v178, s[28:31], 0 offen offset:2048 sc1
    s_waitcnt vmcnt(9)
    buffer_load_dwordx4 a[20:23], v178, s[28:31], 0 offen offset:3072 sc1
    v_add_u32 v178, 4096, v178
    s_waitcnt vmcnt(9)
    buffer_load_dwordx4 a[24:27], v178, s[28:31], 0 offen offset:0 sc1
    s_waitcnt vmcnt(9)
    buffer_load_dwordx4 a[28:31], v178, s[28:31], 0 offen offset:1024 sc1
    s_waitcnt vmcnt(0)
    s_or_b32 s60, s2, s63
    s_cmp_lg_u32 s60, 0
    s_cbranch_scc1 L239
    v_lshlrev_b32_e64 v48, 7, v1
    v_add_u32 v48, 0x2260000, v48
    s_mov_b32 s60, 0
L240:
    buffer_load_dword v4, v48, s[28:31], 0 offen sc1
    s_waitcnt vmcnt(0)
    v_xor_b32_e64 v0, v4, v3
    v_and_b32 v0, 0xfffff0ff, v0
    v_cmp_ne_u32 vcc, 0, v0
    s_cbranch_vccz L241
    s_sleep 8
    s_add_u32 s60, s60, 1
    s_cmp_lt_u32 s60, 400000
    s_cbranch_scc1 L240
L241:
    v_add_u32 v48, 8192, v48
    s_mov_b32 s60, 0
L242:
    buffer_load_dword v4, v48, s[28:31], 0 offen sc1
    s_waitcnt vmcnt(0)
    v_xor_b32 v0, v4, v3
    v_and_b32 v0, 0xfffff0ff, v0
    v_cmp_ne_u32 vcc, 0, v0
    s_cbranch_vccz L243
    s_sleep 8
    s_add_u32 s60, s60, 1
    s_cmp_lt_u32 s60, 400000
    s_cbranch_scc1 L242
L243:
    v_add_u32 v48, 8192, v48
    s_mov_b32 s60, 0
L244:
    buffer_load_dword v4, v48, s[28:31], 0 offen sc1
    s_waitcnt vmcnt(0)
    v_xor_b32 v0, v4, v3
    v_and_b32 v0, 0xfffff0ff, v0
    v_cmp_ne_u32 vcc, 0, v0
    s_cbranch_vccz L245
    s_sleep 8
    s_add_u32 s60, s60, 1
    s_cmp_lt_u32 s60, 400000
    s_cbranch_scc1 L244
L245:
    v_add_u32 v48, 8192, v48
    s_mov_b32 s60, 0
L246:
    buffer_load_dword v4, v48, s[28:31], 0 offen sc1
    s_waitcnt vmcnt(0)
    v_xor_b32 v0, v4, v3
    v_and_b32 v0, 0xfffff0ff, v0
    v_cmp_ne_u32 vcc, 0, v0
    s_cbranch_vccz L247
    s_sleep 8
    s_add_u32 s60, s60, 1
    s_cmp_lt_u32 s60, 400000
    s_cbranch_scc1 L246
L247:
    v_add_u32 v48, 8192, v48
    v_mov_b32 v48, 0x2300000
    s_mov_b64 exec, 1
    buffer_store_dword v3, v48, s[28:31], 0 offen sc1
    s_mov_b64 exec, -1
L239:
    s_mov_b32 s60, 0
L248:
    ds_read_b128 v[188:191], v39 offset:0
    s_waitcnt lgkmcnt(0)
    v_min_u32 v188, v188, v189
    v_min3_u32 v46, v188, v190, v191
    v_cmp_gt_u32 vcc, 21, v46
    s_cbranch_vccz L249
    s_sleep 4
    s_add_u32 s60, s60, 1
    s_cmp_lt_u32 s60, 3200000
    s_cbranch_scc1 L248
L249:
    s_mul_i32 s62, s63, 10240
    s_add_u32 s62, s62, 40960
    v_add_u32 v180, s62, v2
    ds_write_b128 v180, v[152:155] offset:0
    ds_write_b128 v180, v[156:159] offset:1024
    ds_write_b128 v180, v[160:163] offset:2048
    ds_write_b128 v180, v[164:167] offset:3072
    ds_write_b128 v180, v[168:171] offset:4096
    ds_write_b128 v180, v[172:175] offset:5120
    ds_write_b128 v180, v[64:67] offset:6144
    ds_write_b128 v180, v[68:71] offset:7168
    ds_write_b128 v180, v[72:75] offset:8192
    ds_write_b128 v180, v[76:79] offset:9216
    v_mov_b32_e64 v0, 11
    ds_write_b32 v45, v0
    s_mov_b32 s60, 0
L250:
    ds_read_b128 v[188:191], v39 offset:0
    s_waitcnt lgkmcnt(0)
    v_min_u32_e64 v188, v188, v189
    v_min3_u32 v46, v188, v190, v191
    v_cmp_gt_u32 vcc, 22, v46
    s_cbranch_vccz L251
    s_sleep 4
    s_add_u32 s60, s60, 1
    s_cmp_lt_u32 s60, 3200000
    s_cbranch_scc1 L250
L251:
    s_mul_i32 s62, s63, 10240
    s_add_u32 s62, s62, 61440
    v_add_u32 v180, s62, v2
    ds_write_b128 v180, v[80:83] offset:0
    ds_write_b128 v180, v[84:87] offset:1024
    ds_write_b128 v180, v[88:91] offset:2048
    ds_write_b128 v180, v[92:95] offset:3072
    ds_write_b128 v180, v[96:99] offset:4096
    ds_write_b128 v180, v[100:103] offset:5120
    ds_write_b128 v180, v[104:107] offset:6144
    ds_write_b128 v180, v[108:111] offset:7168
    ds_write_b128 v180, v[112:115] offset:8192
    ds_write_b128 v180, v[116:119] offset:9216
    v_mov_b32_e64 v0, 12
    ds_write_b32 v45, v0
    s_mov_b32 s60, 0
L252:
    ds_read_b128 v[188:191], v39 offset:0
    s_waitcnt lgkmcnt(0)
    v_min_u32_e64 v188, v188, v189
    v_min3_u32 v46, v188, v190, v191
    v_cmp_gt_u32 vcc, 23, v46
    s_cbranch_vccz L253
    s_sleep 4
    s_add_u32 s60, s60, 1
    s_cmp_lt_u32 s60, 3200000
    s_cbranch_scc1 L252
L253:
    s_mul_i32 s62, s63, 10240
    s_add_u32 s62, s62, 81920
    v_add_u32 v180, s62, v2
    ds_write_b128 v180, v[120:123] offset:0
    ds_write_b128 v180, v[124:127] offset:1024
    ds_write_b128 v180, a[0:3] offset:2048
    ds_write_b128 v180, a[4:7] offset:3072
    ds_write_b128 v180, a[8:11] offset:4096
    ds_write_b128 v180, a[12:15] offset:5120
    ds_write_b128 v180, a[16:19] offset:6144
    ds_write_b128 v180, a[20:23] offset:7168
    ds_write_b128 v180, a[24:27] offset:8192
    ds_write_b128 v180, a[28:31] offset:9216
    v_mov_b32_e64 v0, 13
    ds_write_b32 v45, v0
L_fin:
L_done:
    s_endpgm
L_end:
.fill 300, 4, 0xBF800000
.section .rodata,"a"
.p2align 6
.amdhsa_kernel sequential_preLN__sliding_local_dilated__mixer_s_mlp__prompt_kernel
  .amdhsa_next_free_vgpr 256
  .amdhsa_next_free_sgpr 102
  .amdhsa_accum_offset 192
  .amdhsa_group_segment_fixed_size 0
  .amdhsa_kernarg_size 88
  .amdhsa_user_sgpr_count 2
  .amdhsa_user_sgpr_kernarg_segment_ptr 1
  .amdhsa_system_sgpr_workgroup_id_x 1
.end_amdhsa_kernel
```
